```python
import torch

def _softmax(x, axis=-1):
    return torch.softmax(x, dim=axis)

def _gelu(x):
    return torch.nn.functional.gelu(x, approximate='tanh')

def _silu(x):
    return torch.nn.functional.silu(x)

def _sigmoid(x):
    return torch.sigmoid(x)

def _layernorm(x, axis=-1, eps=1e-05):
    m = x.mean(dim=axis, keepdim=True)
    v = x.var(dim=axis, keepdim=True, unbiased=False)
    return (x - m) / torch.sqrt(v + eps)

def _scatter_add(tgt, idx, src, axis=0):
    return tgt.clone().index_add_(axis, idx, src)

def _segment_sum(src, seg, n):
    out = torch.zeros((n,) + src.shape[1:], dtype=src.dtype)
    return out.index_add_(0, seg, src)

def _pad(x, pw):
    flat = tuple((v for pair in reversed(pw) for v in pair))
    return torch.nn.functional.pad(x, flat)
kernel_name = 'parallel_sum__memory_aug_recurrent_mem_tr__glu_gated_bilinear__prompt'

def setup_inputs():

    _w = lambda a: (lambda t: t.to(torch.bfloat16) if t.is_floating_point() else t)(torch.as_tensor(a))

    def _A_setup():
        B, S, Dm = (1, 2048, 512)
        H, Dh = (32, 128)
        M, seg = (8, 32)
        seg = min(seg, S)
        S = S // seg * seg
        return {'x': _w((lambda *s: torch.randn(*s, dtype=torch.bfloat16) * 0.05)(B, S, Dm)), 'mem0': _w((lambda *s: torch.randn(*s, dtype=torch.bfloat16) * 0.2)(B, M, Dm)), 'Wq': _w((lambda *s: torch.randn(*s, dtype=torch.bfloat16) * 1.6)(Dm, H, Dh) * Dm ** (-0.5)), 'Wk': _w((lambda *s: torch.randn(*s, dtype=torch.bfloat16) * 1.6)(Dm, H, Dh) * Dm ** (-0.5)), 'Wv': _w((lambda *s: torch.randn(*s, dtype=torch.bfloat16) * 0.2)(Dm, H, Dh) * Dm ** (-0.5)), 'Wo': _w((lambda *s: torch.randn(*s, dtype=torch.bfloat16) * 0.2)(H, Dh, Dm) * (H * Dh) ** (-0.5)), 'seg_len': seg}
    _A_in = _A_setup()

    def _B_setup():
        B, S, D, F = (1, 2048, 512, 1376)
        return {'x': _w((lambda *s: torch.randn(*s, dtype=torch.bfloat16) * 0.05)(B, S, D)), 'w_gate': _w((lambda *s: torch.randn(*s, dtype=torch.bfloat16) * 0.2)(D, F) * D ** (-0.5)), 'w_up': _w((lambda *s: torch.randn(*s, dtype=torch.bfloat16) * 0.2)(D, F) * D ** (-0.5)), 'w_down': _w((lambda *s: torch.randn(*s, dtype=torch.bfloat16) * 0.2)(F, D) * F ** (-0.5))}
    _B_in = _B_setup()
    return {'A_x': _A_in['x'], 'A_mem0': _A_in['mem0'], 'A_Wq': _A_in['Wq'], 'A_Wk': _A_in['Wk'], 'A_Wv': _A_in['Wv'], 'A_Wo': _A_in['Wo'], 'A_seg_len': _A_in['seg_len'], 'B_x': _B_in['x'], 'B_w_gate': _B_in['w_gate'], 'B_w_up': _B_in['w_up'], 'B_w_down': _B_in['w_down']}

def reference(A_x, A_mem0, A_Wq, A_Wk, A_Wv, A_Wo, A_seg_len, B_x, B_w_gate, B_w_up, B_w_down):

    def _A_ref(x, mem0, Wq, Wk, Wv, Wo, seg_len):
        B, S, Dm = x.shape
        H, Dh = (Wq.shape[1], Wq.shape[2])
        M = mem0.shape[1]
        scale = Dh ** (-0.5)
        n_seg = S // seg_len
        L = M + seg_len
        idx = torch.arange(L)
        mask = (idx[:, None] < M) | (idx[:, None] >= idx[None, :])
        mem = mem0
        outs = []
        for s in range(n_seg):
            xs = x[:, s * seg_len:(s + 1) * seg_len, :].clone()
            h = torch.concatenate([mem, xs], axis=1)
            q = torch.einsum('btd,dhe->bhte', h, Wq)
            k = torch.einsum('btd,dhe->bhte', h, Wk)
            v = torch.einsum('btd,dhe->bhte', h, Wv)
            scores = torch.einsum('bhqe,bhke->bhqk', q, k) * scale
            scores = torch.where(mask[None, None], scores, -1000000000.0)
            p = _softmax(scores, axis=-1)
            o = torch.einsum('bhqk,bhke->bhqe', p, v)
            o = torch.einsum('bhte,hed->btd', o, Wo)
            mem = o[:, :M, :].clone()
            outs.append(o[:, M:, :])
        return torch.concatenate(outs, axis=1)

    def _B_ref(x, w_gate, w_up, w_down):
        g = torch.einsum('bsd,df->bsf', x, w_gate)
        u = torch.einsum('bsd,df->bsf', x, w_up)
        h = g * u
        return torch.einsum('bsf,fd->bsd', h, w_down)
    x = A_x
    xn = _layernorm(x, axis=-1)
    return x + _A_ref(xn, A_mem0, A_Wq, A_Wk, A_Wv, A_Wo, A_seg_len) + _B_ref(xn, B_w_gate, B_w_up, B_w_down)
```

```asm
; @launch grid=(256,1,1) block=(256,1,1) lds=163840
.amdgcn_target "amdgcn-amd-amdhsa--gfx950"
.text
.globl parallel_sum__memory_aug_recurrent_mem_tr__glu_gated_bilinear__prompt_kernel
.p2align 8
.type parallel_sum__memory_aug_recurrent_mem_tr__glu_gated_bilinear__prompt_kernel,@function
parallel_sum__memory_aug_recurrent_mem_tr__glu_gated_bilinear__prompt_kernel:
    s_cmp_ge_u32 s2, 256
    s_cbranch_scc1 EXIT
    s_load_dwordx2 s[4:5], s[0:1], 104
    s_mov_b32 s6, 0x10000000
    s_mov_b32 s7, 0x20000
    s_load_dwordx2 s[8:9], s[0:1], 0
    s_mov_b32 s10, 0x200000
    s_mov_b32 s11, 0x20000
    s_load_dwordx2 s[16:17], s[0:1], 96
    s_mov_b32 s18, 0x100
    s_mov_b32 s19, 0x20000
    s_getreg_b32 s26, hwreg(HW_REG_XCC_ID,0,4)
    s_and_b32 s26, s26, 7
    v_lshrrev_b32 v1, 6, v0
    v_and_b32 v0, 63, v0
    v_readfirstlane_b32 s20, v1
    s_waitcnt lgkmcnt(0)
    s_lshl_b32 s23, s2, 3
    s_lshl_b32 s24, s20, 1
    s_add_u32 s23, s23, s24
    s_lshl_b32 s23, s23, 10
    v_lshlrev_b32 v4, 4, v0
    buffer_load_dwordx4 v[10:13], v4, s[8:11], s23 offen
    buffer_load_dwordx4 v[14:17], v4, s[8:11], s23 offen offset:1024
    s_cmp_eq_u32 s20, 0
    s_cbranch_scc0 NOTICKET
    s_lshl_b32 s23, s26, 3
    s_lshl_b64 s[24:25], 1, s23
    s_mov_b64 s[28:29], exec
    s_mov_b64 exec, 1
    v_mov_b32 v2, s24
    v_mov_b32 v3, s25
    v_mov_b32 v5, 0
    buffer_atomic_add_x2 v[2:3], v5, s[16:19], 0 offen sc0 sc1
    s_mov_b64 exec, s[28:29]
    s_waitcnt vmcnt(1)
    s_branch LNGO
NOTICKET:
    s_waitcnt vmcnt(0)
LNGO:
    v_lshlrev_b32 v20, 16, v10
    v_and_b32 v21, 0xffff0000, v10
    v_lshlrev_b32 v22, 16, v11
    v_and_b32 v23, 0xffff0000, v11
    v_lshlrev_b32 v24, 16, v12
    v_and_b32 v25, 0xffff0000, v12
    v_lshlrev_b32 v26, 16, v13
    v_and_b32 v27, 0xffff0000, v13
    v_lshlrev_b32 v28, 16, v14
    v_and_b32 v29, 0xffff0000, v14
    v_lshlrev_b32 v30, 16, v15
    v_and_b32 v31, 0xffff0000, v15
    v_lshlrev_b32 v32, 16, v16
    v_and_b32 v33, 0xffff0000, v16
    v_lshlrev_b32 v34, 16, v17
    v_and_b32 v35, 0xffff0000, v17
    v_add_f32 v36, v20, v21
    v_add_f32 v36, v36, v22
    v_add_f32 v36, v36, v23
    v_add_f32 v36, v36, v24
    v_add_f32 v36, v36, v25
    v_add_f32 v36, v36, v26
    v_add_f32 v36, v36, v27
    v_add_f32 v37, v28, v29
    v_add_f32 v37, v37, v30
    v_add_f32 v37, v37, v31
    v_add_f32 v37, v37, v32
    v_add_f32 v37, v37, v33
    v_add_f32 v37, v37, v34
    v_add_f32 v37, v37, v35
    v_add_f32_dpp v36, v36, v36 row_ror:8 row_mask:0xf bank_mask:0xf
    s_nop 0
    v_add_f32_dpp v37, v37, v37 row_ror:8 row_mask:0xf bank_mask:0xf
    s_nop 0
    v_add_f32_dpp v36, v36, v36 row_ror:4 row_mask:0xf bank_mask:0xf
    s_nop 0
    v_add_f32_dpp v37, v37, v37 row_ror:4 row_mask:0xf bank_mask:0xf
    s_nop 0
    v_add_f32_dpp v36, v36, v36 row_ror:2 row_mask:0xf bank_mask:0xf
    s_nop 0
    v_add_f32_dpp v37, v37, v37 row_ror:2 row_mask:0xf bank_mask:0xf
    s_nop 0
    v_add_f32_dpp v36, v36, v36 row_ror:1 row_mask:0xf bank_mask:0xf
    s_nop 0
    v_add_f32_dpp v37, v37, v37 row_ror:1 row_mask:0xf bank_mask:0xf
    v_mov_b32 v38, v36
    v_mov_b32 v39, v37
    s_nop 0
    v_permlane16_swap_b32 v36, v38
    s_nop 0
    v_permlane16_swap_b32 v37, v39
    v_add_f32 v36, v36, v38
    v_add_f32 v37, v37, v39
    v_mov_b32 v38, v36
    v_mov_b32 v39, v37
    s_nop 0
    v_permlane32_swap_b32 v36, v38
    s_nop 0
    v_permlane32_swap_b32 v37, v39
    v_add_f32 v36, v36, v38
    v_add_f32 v37, v37, v39
    v_mul_f32 v36, 0x3b000000, v36
    v_mul_f32 v37, 0x3b000000, v37
    v_sub_f32 v42, v20, v36
    v_mul_f32 v40, v42, v42
    v_sub_f32 v42, v21, v36
    v_fmac_f32 v40, v42, v42
    v_sub_f32 v42, v22, v36
    v_fmac_f32 v40, v42, v42
    v_sub_f32 v42, v23, v36
    v_fmac_f32 v40, v42, v42
    v_sub_f32 v42, v24, v36
    v_fmac_f32 v40, v42, v42
    v_sub_f32 v42, v25, v36
    v_fmac_f32 v40, v42, v42
    v_sub_f32 v42, v26, v36
    v_fmac_f32 v40, v42, v42
    v_sub_f32 v42, v27, v36
    v_fmac_f32 v40, v42, v42
    v_sub_f32 v42, v28, v37
    v_mul_f32 v41, v42, v42
    v_sub_f32 v42, v29, v37
    v_fmac_f32 v41, v42, v42
    v_sub_f32 v42, v30, v37
    v_fmac_f32 v41, v42, v42
    v_sub_f32 v42, v31, v37
    v_fmac_f32 v41, v42, v42
    v_sub_f32 v42, v32, v37
    v_fmac_f32 v41, v42, v42
    v_sub_f32 v42, v33, v37
    v_fmac_f32 v41, v42, v42
    v_sub_f32 v42, v34, v37
    v_fmac_f32 v41, v42, v42
    v_sub_f32 v42, v35, v37
    v_fmac_f32 v41, v42, v42
    v_add_f32_dpp v40, v40, v40 row_ror:8 row_mask:0xf bank_mask:0xf
    s_nop 0
    v_add_f32_dpp v41, v41, v41 row_ror:8 row_mask:0xf bank_mask:0xf
    s_nop 0
    v_add_f32_dpp v40, v40, v40 row_ror:4 row_mask:0xf bank_mask:0xf
    s_nop 0
    v_add_f32_dpp v41, v41, v41 row_ror:4 row_mask:0xf bank_mask:0xf
    s_nop 0
    v_add_f32_dpp v40, v40, v40 row_ror:2 row_mask:0xf bank_mask:0xf
    s_nop 0
    v_add_f32_dpp v41, v41, v41 row_ror:2 row_mask:0xf bank_mask:0xf
    s_nop 0
    v_add_f32_dpp v40, v40, v40 row_ror:1 row_mask:0xf bank_mask:0xf
    s_nop 0
    v_add_f32_dpp v41, v41, v41 row_ror:1 row_mask:0xf bank_mask:0xf
    v_mov_b32 v38, v40
    v_mov_b32 v39, v41
    s_nop 0
    v_permlane16_swap_b32 v40, v38
    s_nop 0
    v_permlane16_swap_b32 v41, v39
    v_add_f32 v40, v40, v38
    v_add_f32 v41, v41, v39
    v_mov_b32 v38, v40
    v_mov_b32 v39, v41
    s_nop 0
    v_permlane32_swap_b32 v40, v38
    s_nop 0
    v_permlane32_swap_b32 v41, v39
    v_add_f32 v40, v40, v38
    v_add_f32 v41, v41, v39
    v_mul_f32 v40, 0x3b000000, v40
    v_cvt_pk_bf16_f32 v40, v40, v40
    v_and_b32 v40, 0xffff0000, v40
    v_add_f32 v40, 0x3727c5ac, v40
    v_cvt_pk_bf16_f32 v40, v40, v40
    v_and_b32 v40, 0xffff0000, v40
    v_sqrt_f32 v40, v40
    s_nop 0
    v_cvt_pk_bf16_f32 v40, v40, v40
    v_and_b32 v40, 0xffff0000, v40
    v_rcp_f32 v40, v40
    v_cvt_pk_bf16_f32 v36, v36, v36
    v_and_b32 v36, 0xffff0000, v36
    v_sub_f32 v20, v20, v36
    v_sub_f32 v21, v21, v36
    v_cvt_pk_bf16_f32 v42, v20, v21
    v_lshlrev_b32 v20, 16, v42
    v_and_b32 v21, 0xffff0000, v42
    v_mul_f32 v20, v20, v40
    v_mul_f32 v21, v21, v40
    v_cvt_pk_bf16_f32 v10, v20, v21
    v_sub_f32 v22, v22, v36
    v_sub_f32 v23, v23, v36
    v_cvt_pk_bf16_f32 v42, v22, v23
    v_lshlrev_b32 v22, 16, v42
    v_and_b32 v23, 0xffff0000, v42
    v_mul_f32 v22, v22, v40
    v_mul_f32 v23, v23, v40
    v_cvt_pk_bf16_f32 v11, v22, v23
    v_sub_f32 v24, v24, v36
    v_sub_f32 v25, v25, v36
    v_cvt_pk_bf16_f32 v42, v24, v25
    v_lshlrev_b32 v24, 16, v42
    v_and_b32 v25, 0xffff0000, v42
    v_mul_f32 v24, v24, v40
    v_mul_f32 v25, v25, v40
    v_cvt_pk_bf16_f32 v12, v24, v25
    v_sub_f32 v26, v26, v36
    v_sub_f32 v27, v27, v36
    v_cvt_pk_bf16_f32 v42, v26, v27
    v_lshlrev_b32 v26, 16, v42
    v_and_b32 v27, 0xffff0000, v42
    v_mul_f32 v26, v26, v40
    v_mul_f32 v27, v27, v40
    v_cvt_pk_bf16_f32 v13, v26, v27
    v_mul_f32 v41, 0x3b000000, v41
    v_cvt_pk_bf16_f32 v41, v41, v41
    v_and_b32 v41, 0xffff0000, v41
    v_add_f32 v41, 0x3727c5ac, v41
    v_cvt_pk_bf16_f32 v41, v41, v41
    v_and_b32 v41, 0xffff0000, v41
    v_sqrt_f32 v41, v41
    s_nop 0
    v_cvt_pk_bf16_f32 v41, v41, v41
    v_and_b32 v41, 0xffff0000, v41
    v_rcp_f32 v41, v41
    v_cvt_pk_bf16_f32 v37, v37, v37
    v_and_b32 v37, 0xffff0000, v37
    v_sub_f32 v28, v28, v37
    v_sub_f32 v29, v29, v37
    v_cvt_pk_bf16_f32 v42, v28, v29
    v_lshlrev_b32 v28, 16, v42
    v_and_b32 v29, 0xffff0000, v42
    v_mul_f32 v28, v28, v41
    v_mul_f32 v29, v29, v41
    v_cvt_pk_bf16_f32 v14, v28, v29
    v_sub_f32 v30, v30, v37
    v_sub_f32 v31, v31, v37
    v_cvt_pk_bf16_f32 v42, v30, v31
    v_lshlrev_b32 v30, 16, v42
    v_and_b32 v31, 0xffff0000, v42
    v_mul_f32 v30, v30, v41
    v_mul_f32 v31, v31, v41
    v_cvt_pk_bf16_f32 v15, v30, v31
    v_sub_f32 v32, v32, v37
    v_sub_f32 v33, v33, v37
    v_cvt_pk_bf16_f32 v42, v32, v33
    v_lshlrev_b32 v32, 16, v42
    v_and_b32 v33, 0xffff0000, v42
    v_mul_f32 v32, v32, v41
    v_mul_f32 v33, v33, v41
    v_cvt_pk_bf16_f32 v16, v32, v33
    v_sub_f32 v34, v34, v37
    v_sub_f32 v35, v35, v37
    v_cvt_pk_bf16_f32 v42, v34, v35
    v_lshlrev_b32 v34, 16, v42
    v_and_b32 v35, 0xffff0000, v42
    v_mul_f32 v34, v34, v41
    v_mul_f32 v35, v35, v41
    v_cvt_pk_bf16_f32 v17, v34, v35
    v_lshrrev_b32 v5, 2, v0
    v_lshlrev_b32 v5, 9, v5
    v_and_b32 v6, 1, v0
    v_lshl_add_u32 v5, v6, 8, v5
    v_bfe_u32 v6, v0, 1, 1
    v_lshl_add_u32 v5, v6, 3, v5
    s_lshl_b32 s23, s20, 5
    s_add_u32 s23, s23, 0x24000
    v_add_u32 v5, s23, v5
    ds_write_b64 v5, v[10:11] offset:0
    ds_write_b64 v5, v[12:13] offset:128
    ds_write_b64 v5, v[14:15] offset:16
    ds_write_b64 v5, v[16:17] offset:144
    s_cmp_eq_u32 s20, 0
    s_cbranch_scc0 NOTK2
    s_waitcnt vmcnt(0)
    v_mov_b32 v5, 0x26000
    s_mov_b64 exec, 1
    ds_write_b64 v5, v[2:3]
    s_mov_b64 exec, s[28:29]
NOTK2:
    s_waitcnt lgkmcnt(0)
    s_barrier
    s_lshl_b32 s23, s20, 6
    v_add_u32 v6, s23, v0
    v_lshlrev_b32 v5, 4, v6
    v_add_u32 v5, 0x24000, v5
    ds_read_b128 v[10:13], v5
    ds_read_b128 v[14:17], v5 offset:4096
    v_mov_b32 v7, 0x26000
    v_mov_b32 v126, 0
    ds_read_b64 v[2:3], v7
    v_lshrrev_b32 v7, 3, v6
    v_lshlrev_b32 v7, 8, v7
    v_and_b32 v8, 7, v6
    v_lshl_add_u32 v7, v8, 4, v7
    s_lshr_b32 s23, s2, 1
    s_lshl_b32 s23, s23, 14
    s_and_b32 s24, s2, 1
    s_lshl_b32 s24, s24, 7
    s_add_u32 s23, s23, s24
    s_add_u32 s23, s23, 0x100000
    s_add_u32 s24, s23, 8192
    s_waitcnt lgkmcnt(0)
    buffer_store_dwordx4 v[10:13], v7, s[4:7], s23 offen sc1
    buffer_store_dwordx4 v[14:17], v7, s[4:7], s24 offen sc1
    v_readfirstlane_b32 s28, v2
    v_readfirstlane_b32 s29, v3
    v_sad_u8 v8, v2, 0, 0
    v_sad_u8 v8, v3, 0, v8
    s_lshl_b32 s23, s26, 3
    s_lshr_b64 s[30:31], s[28:29], s23
    s_and_b32 s30, s30, 0xff
    v_readfirstlane_b32 s27, v8
    s_lshr_b64 s[32:33], s[28:29], 56
    s_and_b32 s32, s32, 0xff
    s_min_u32 s32, s32, 32
    s_sub_u32 s22, s27, s32
    s_cmp_eq_u32 s27, 0
    s_cbranch_scc0 NOCLR
    s_cmp_eq_u32 s20, 0
    s_cbranch_scc0 NOCLR
    v_mov_b32 v20, 0
    v_mov_b32 v21, 0
    v_mov_b32 v22, 0
    v_mov_b32 v23, 0
    v_lshlrev_b32 v5, 4, v0
    s_mov_b32 s23, 0
    buffer_store_dwordx4 v[20:23], v5, s[4:7], s23 offen offset:0 sc1
    buffer_store_dwordx4 v[20:23], v5, s[4:7], s23 offen offset:1024 sc1
    buffer_store_dwordx4 v[20:23], v5, s[4:7], s23 offen offset:2048 sc1
    buffer_store_dwordx4 v[20:23], v5, s[4:7], s23 offen offset:3072 sc1
    s_mov_b32 s23, 4096
    buffer_store_dwordx4 v[20:23], v5, s[4:7], s23 offen offset:0 sc1
    buffer_store_dwordx4 v[20:23], v5, s[4:7], s23 offen offset:1024 sc1
    buffer_store_dwordx4 v[20:23], v5, s[4:7], s23 offen offset:2048 sc1
    buffer_store_dwordx4 v[20:23], v5, s[4:7], s23 offen offset:3072 sc1
    s_mov_b32 s23, 8192
    buffer_store_dwordx4 v[20:23], v5, s[4:7], s23 offen offset:0 sc1
    buffer_store_dwordx4 v[20:23], v5, s[4:7], s23 offen offset:1024 sc1
    buffer_store_dwordx4 v[20:23], v5, s[4:7], s23 offen offset:2048 sc1
    buffer_store_dwordx4 v[20:23], v5, s[4:7], s23 offen offset:3072 sc1
    s_mov_b32 s23, 12288
    buffer_store_dwordx4 v[20:23], v5, s[4:7], s23 offen offset:0 sc1
    buffer_store_dwordx4 v[20:23], v5, s[4:7], s23 offen offset:1024 sc1
    buffer_store_dwordx4 v[20:23], v5, s[4:7], s23 offen offset:2048 sc1
    buffer_store_dwordx4 v[20:23], v5, s[4:7], s23 offen offset:3072 sc1
    s_mov_b32 s23, 16384
    buffer_store_dwordx4 v[20:23], v5, s[4:7], s23 offen offset:0 sc1
    buffer_store_dwordx4 v[20:23], v5, s[4:7], s23 offen offset:1024 sc1
    buffer_store_dwordx4 v[20:23], v5, s[4:7], s23 offen offset:2048 sc1
    buffer_store_dwordx4 v[20:23], v5, s[4:7], s23 offen offset:3072 sc1
    s_mov_b32 s23, 20480
    buffer_store_dwordx4 v[20:23], v5, s[4:7], s23 offen offset:0 sc1
    buffer_store_dwordx4 v[20:23], v5, s[4:7], s23 offen offset:1024 sc1
    buffer_store_dwordx4 v[20:23], v5, s[4:7], s23 offen offset:2048 sc1
    buffer_store_dwordx4 v[20:23], v5, s[4:7], s23 offen offset:3072 sc1
    s_mov_b32 s23, 24576
    buffer_store_dwordx4 v[20:23], v5, s[4:7], s23 offen offset:0 sc1
    buffer_store_dwordx4 v[20:23], v5, s[4:7], s23 offen offset:1024 sc1
    buffer_store_dwordx4 v[20:23], v5, s[4:7], s23 offen offset:2048 sc1
    buffer_store_dwordx4 v[20:23], v5, s[4:7], s23 offen offset:3072 sc1
    s_mov_b32 s23, 28672
    buffer_store_dwordx4 v[20:23], v5, s[4:7], s23 offen offset:0 sc1
    buffer_store_dwordx4 v[20:23], v5, s[4:7], s23 offen offset:1024 sc1
    buffer_store_dwordx4 v[20:23], v5, s[4:7], s23 offen offset:2048 sc1
    buffer_store_dwordx4 v[20:23], v5, s[4:7], s23 offen offset:3072 sc1
    s_mov_b32 s23, 32768
    buffer_store_dwordx4 v[20:23], v5, s[4:7], s23 offen offset:0 sc1
    buffer_store_dwordx4 v[20:23], v5, s[4:7], s23 offen offset:1024 sc1
    buffer_store_dwordx4 v[20:23], v5, s[4:7], s23 offen offset:2048 sc1
    buffer_store_dwordx4 v[20:23], v5, s[4:7], s23 offen offset:3072 sc1
    s_mov_b32 s23, 36864
    buffer_store_dwordx4 v[20:23], v5, s[4:7], s23 offen offset:0 sc1
    buffer_store_dwordx4 v[20:23], v5, s[4:7], s23 offen offset:1024 sc1
    buffer_store_dwordx4 v[20:23], v5, s[4:7], s23 offen offset:2048 sc1
    buffer_store_dwordx4 v[20:23], v5, s[4:7], s23 offen offset:3072 sc1
    s_waitcnt vmcnt(0)
    v_mov_b32 v5, 128
    v_mov_b32 v20, 1
    buffer_store_dword v20, v5, s[16:19], 0 offen sc1
NOCLR:
    s_cmp_eq_u32 s26, 7
    s_cbranch_scc0 NOTCHAIN
    s_cmp_lt_u32 s30, 32
    s_cbranch_scc0 NOTCHAIN
    s_mov_b32 s21, s30
    s_mov_b32 s66, 1
    s_branch ROLE_CHAIN
NOTCHAIN:
    s_waitcnt vmcnt(0)
    s_barrier
    v_readfirstlane_b32 s24, v126
    s_cmp_eq_u32 s24, 0
    s_cbranch_scc0 INITE_2
    s_mov_b32 s23, 32768
    v_mov_b32 v2, 128
INITW_1:
    buffer_load_dword v3, v2, s[16:19], 0 offen sc1
    s_waitcnt vmcnt(0)
    v_readfirstlane_b32 s24, v3
    s_sub_u32 s23, s23, 1
    s_cbranch_scc1 INITE_2
    s_cmp_eq_u32 s24, 0
    s_cbranch_scc0 INITE_2
    s_sleep 2
    s_branch INITW_1
INITE_2:
    s_cmp_eq_u32 s20, 0
    s_cbranch_scc0 NOLNF
    s_lshl_b32 s23, s2, 2
    v_mov_b32 v5, s23
    v_mov_b32 v10, 1
    buffer_store_dword v10, v5, s[4:7], 0 offen sc1
NOLNF:
    s_sub_u32 s21, s22, 0
    s_cmp_lt_u32 s22, 32
    s_cbranch_scc1 ROLE_K
    s_sub_u32 s21, s22, 32
    s_cmp_lt_u32 s22, 64
    s_cbranch_scc1 ROLE_V
    s_sub_u32 s21, s22, 64
    s_cmp_lt_u32 s22, 86
    s_cbranch_scc1 ROLE_UP
    s_sub_u32 s21, s22, 86
    s_cmp_lt_u32 s22, 118
    s_cbranch_scc1 ROLE_QA
    s_sub_u32 s21, s22, 118
    s_cmp_lt_u32 s22, 134
    s_cbranch_scc1 ROLE_DN
    s_sub_u32 s21, s22, 134
    s_cmp_lt_u32 s22, 166
    s_cbranch_scc1 ROLE_OUT
    s_sub_u32 s21, s22, 166
    s_cmp_lt_u32 s22, 182
    s_cbranch_scc1 ROLE_FIN
    s_sub_u32 s21, s22, 182
    s_branch ROLE_SPARE
ROLE_K:
    s_load_dwordx2 s[8:9], s[0:1], 24
    s_mov_b32 s10, 0x400000
    s_mov_b32 s11, 0x20000
    s_waitcnt lgkmcnt(0)
    s_lshl_b32 s30, s21, 8
    v_lshrrev_b32 v2, 4, v0
    s_and_b32 s23, s20, 1
    s_lshl_b32 s23, s23, 2
    v_add_u32 v3, s23, v2
    v_lshlrev_b32 v3, 1, v3
    v_and_b32 v4, 15, v0
    v_xor_b32 v4, v4, v3
    v_lshlrev_b32 v4, 4, v4
    s_mov_b32 s23, 8192
    v_mul_lo_u32 v2, v2, s23
    v_add_u32 v2, v2, v4
    s_mul_i32 s24, s20, 32768
    s_add_u32 s24, s24, s30
    s_lshl_b32 s25, s20, 10
    s_mov_b32 s27, 32
DMA_3:
    s_mov_b32 m0, s25
    s_add_u32 s25, s25, 4096
    buffer_load_dwordx4 v2, s[8:11], s24 offen lds
    s_add_u32 s24, s24, 131072
    s_sub_u32 s27, s27, 1
    s_cmp_lg_u32 s27, 0
    s_cbranch_scc1 DMA_3
    v_bfe_u32 v2, v0, 2, 2
    v_lshrrev_b32 v3, 4, v0
    v_lshl_add_u32 v4, v3, 2, v2
    v_lshlrev_b32 v5, 8, v4
    v_and_b32 v4, 7, v4
    v_lshlrev_b32 v4, 1, v4
    v_and_b32 v6, 1, v0
    v_lshl_add_u32 v5, v6, 3, v5
    v_bfe_u32 v6, v0, 1, 1
    v_add_u32 v7, 0, v6
    v_xor_b32 v7, v7, v4
    v_lshl_add_u32 v16, v7, 4, v5
    v_add_u32 v24, 0x10000, v16
    v_add_u32 v7, 2, v6
    v_xor_b32 v7, v7, v4
    v_lshl_add_u32 v17, v7, 4, v5
    v_add_u32 v25, 0x10000, v17
    v_add_u32 v7, 4, v6
    v_xor_b32 v7, v7, v4
    v_lshl_add_u32 v18, v7, 4, v5
    v_add_u32 v26, 0x10000, v18
    v_add_u32 v7, 6, v6
    v_xor_b32 v7, v7, v4
    v_lshl_add_u32 v19, v7, 4, v5
    v_add_u32 v27, 0x10000, v19
    v_add_u32 v7, 8, v6
    v_xor_b32 v7, v7, v4
    v_lshl_add_u32 v20, v7, 4, v5
    v_add_u32 v28, 0x10000, v20
    v_add_u32 v7, 10, v6
    v_xor_b32 v7, v7, v4
    v_lshl_add_u32 v21, v7, 4, v5
    v_add_u32 v29, 0x10000, v21
    v_add_u32 v7, 12, v6
    v_xor_b32 v7, v7, v4
    v_lshl_add_u32 v22, v7, 4, v5
    v_add_u32 v30, 0x10000, v22
    v_add_u32 v7, 14, v6
    v_xor_b32 v7, v7, v4
    v_lshl_add_u32 v23, v7, 4, v5
    v_add_u32 v31, 0x10000, v23
    s_lshl_b32 s23, s21, 7
    s_lshl_b32 s24, s20, 2
    s_add_u32 s23, s23, s24
    s_add_u32 s23, s23, 0x1000
    v_mov_b32 v8, s23
    v_lshlrev_b32 v9, 4, v0
    s_waitcnt vmcnt(0)
    s_barrier
    s_lshl_b32 s23, s21, 12
    s_lshl_b32 s24, s20, 10
    s_add_u32 s23, s23, s24
    s_add_u32 s23, s23, 0x77c0000
    v_mov_b32 v40, -1
    v_mov_b32 v41, -1
    v_mov_b32 v42, -1
    v_mov_b32 v43, -1
    buffer_store_dwordx4 v[40:43], v9, s[4:7], s23 offen sc1
    s_add_u32 s23, s23, 0x20000
    buffer_store_dwordx4 v[40:43], v9, s[4:7], s23 offen sc1
    s_add_u32 s23, s23, 0x7e0000
    buffer_store_dwordx4 v[40:43], v9, s[4:7], s23 offen sc1
    s_add_u32 s23, s23, 0x20000
    buffer_store_dwordx4 v[40:43], v9, s[4:7], s23 offen sc1
    s_mov_b32 s31, s20
    s_mov_b32 s32, 0
K_LOOP:
    v_and_b32 v2, 3, v0
    v_lshlrev_b32 v2, 2, v2
    s_lshl_b32 s23, s31, 4
    s_mov_b32 s24, 32768
WLN_4:
    buffer_load_dword v3, v2, s[4:7], s23 offen sc1
    s_waitcnt vmcnt(0)
    v_cmp_eq_u32 vcc, 0, v3
    s_sub_u32 s24, s24, 1
    s_cbranch_scc1 WLNE_5
    s_nop 2
    s_cbranch_vccz WLNE_5
    s_sleep 1
    s_branch WLN_4
WLNE_5:
    s_lshl_b32 s33, s31, 15
    s_add_u32 s33, s33, 0x100000
    buffer_load_dwordx4 a[0:3], v9, s[4:7], s33 offen offset:0
    buffer_load_dwordx4 a[4:7], v9, s[4:7], s33 offen offset:1024
    buffer_load_dwordx4 a[8:11], v9, s[4:7], s33 offen offset:2048
    buffer_load_dwordx4 a[12:15], v9, s[4:7], s33 offen offset:3072
    s_add_u32 s33, s33, 4096
    buffer_load_dwordx4 a[16:19], v9, s[4:7], s33 offen offset:0
    buffer_load_dwordx4 a[20:23], v9, s[4:7], s33 offen offset:1024
    buffer_load_dwordx4 a[24:27], v9, s[4:7], s33 offen offset:2048
    buffer_load_dwordx4 a[28:31], v9, s[4:7], s33 offen offset:3072
    s_add_u32 s33, s33, 4096
    buffer_load_dwordx4 a[32:35], v9, s[4:7], s33 offen offset:0
    buffer_load_dwordx4 a[36:39], v9, s[4:7], s33 offen offset:1024
    buffer_load_dwordx4 a[40:43], v9, s[4:7], s33 offen offset:2048
    buffer_load_dwordx4 a[44:47], v9, s[4:7], s33 offen offset:3072
    s_add_u32 s33, s33, 4096
    buffer_load_dwordx4 a[48:51], v9, s[4:7], s33 offen offset:0
    buffer_load_dwordx4 a[52:55], v9, s[4:7], s33 offen offset:1024
    buffer_load_dwordx4 a[56:59], v9, s[4:7], s33 offen offset:2048
    buffer_load_dwordx4 a[60:63], v9, s[4:7], s33 offen offset:3072
    s_add_u32 s33, s33, 4096
    buffer_load_dwordx4 a[64:67], v9, s[4:7], s33 offen offset:0
    buffer_load_dwordx4 a[68:71], v9, s[4:7], s33 offen offset:1024
    buffer_load_dwordx4 a[72:75], v9, s[4:7], s33 offen offset:2048
    buffer_load_dwordx4 a[76:79], v9, s[4:7], s33 offen offset:3072
    s_add_u32 s33, s33, 4096
    buffer_load_dwordx4 a[80:83], v9, s[4:7], s33 offen offset:0
    buffer_load_dwordx4 a[84:87], v9, s[4:7], s33 offen offset:1024
    buffer_load_dwordx4 a[88:91], v9, s[4:7], s33 offen offset:2048
    buffer_load_dwordx4 a[92:95], v9, s[4:7], s33 offen offset:3072
    s_add_u32 s33, s33, 4096
    buffer_load_dwordx4 a[96:99], v9, s[4:7], s33 offen offset:0
    buffer_load_dwordx4 a[100:103], v9, s[4:7], s33 offen offset:1024
    buffer_load_dwordx4 a[104:107], v9, s[4:7], s33 offen offset:2048
    buffer_load_dwordx4 a[108:111], v9, s[4:7], s33 offen offset:3072
    s_add_u32 s33, s33, 4096
    buffer_load_dwordx4 a[112:115], v9, s[4:7], s33 offen offset:0
    buffer_load_dwordx4 a[116:119], v9, s[4:7], s33 offen offset:1024
    buffer_load_dwordx4 a[120:123], v9, s[4:7], s33 offen offset:2048
    buffer_load_dwordx4 a[124:127], v9, s[4:7], s33 offen offset:3072
    s_waitcnt vmcnt(0)
    ds_read_b64_tr_b16 v[32:33], v16 offset:0
    ds_read_b64_tr_b16 v[34:35], v16 offset:4096
    ds_read_b64_tr_b16 v[36:37], v17 offset:0
    ds_read_b64_tr_b16 v[38:39], v17 offset:4096
    ds_read_b64_tr_b16 v[40:41], v18 offset:0
    ds_read_b64_tr_b16 v[42:43], v18 offset:4096
    s_waitcnt lgkmcnt(4)
    v_mfma_f32_16x16x32_bf16 v[64:67], v[32:35], a[0:3], 0
    v_mfma_f32_16x16x32_bf16 v[96:99], v[32:35], a[64:67], 0
    ds_read_b64_tr_b16 v[44:45], v19 offset:0
    ds_read_b64_tr_b16 v[46:47], v19 offset:4096
    s_waitcnt lgkmcnt(4)
    v_mfma_f32_16x16x32_bf16 v[68:71], v[36:39], a[0:3], 0
    v_mfma_f32_16x16x32_bf16 v[100:103], v[36:39], a[64:67], 0
    ds_read_b64_tr_b16 v[32:33], v20 offset:0
    ds_read_b64_tr_b16 v[34:35], v20 offset:4096
    s_waitcnt lgkmcnt(4)
    v_mfma_f32_16x16x32_bf16 v[72:75], v[40:43], a[0:3], 0
    v_mfma_f32_16x16x32_bf16 v[104:107], v[40:43], a[64:67], 0
    ds_read_b64_tr_b16 v[36:37], v21 offset:0
    ds_read_b64_tr_b16 v[38:39], v21 offset:4096
    s_waitcnt lgkmcnt(4)
    v_mfma_f32_16x16x32_bf16 v[76:79], v[44:47], a[0:3], 0
    v_mfma_f32_16x16x32_bf16 v[108:111], v[44:47], a[64:67], 0
    ds_read_b64_tr_b16 v[40:41], v22 offset:0
    ds_read_b64_tr_b16 v[42:43], v22 offset:4096
    s_waitcnt lgkmcnt(4)
    v_mfma_f32_16x16x32_bf16 v[80:83], v[32:35], a[0:3], 0
    v_mfma_f32_16x16x32_bf16 v[112:115], v[32:35], a[64:67], 0
    ds_read_b64_tr_b16 v[44:45], v23 offset:0
    ds_read_b64_tr_b16 v[46:47], v23 offset:4096
    s_waitcnt lgkmcnt(4)
    v_mfma_f32_16x16x32_bf16 v[84:87], v[36:39], a[0:3], 0
    v_mfma_f32_16x16x32_bf16 v[116:119], v[36:39], a[64:67], 0
    ds_read_b64_tr_b16 v[32:33], v16 offset:8192
    ds_read_b64_tr_b16 v[34:35], v16 offset:12288
    s_waitcnt lgkmcnt(4)
    v_mfma_f32_16x16x32_bf16 v[88:91], v[40:43], a[0:3], 0
    v_mfma_f32_16x16x32_bf16 v[120:123], v[40:43], a[64:67], 0
    ds_read_b64_tr_b16 v[36:37], v17 offset:8192
    ds_read_b64_tr_b16 v[38:39], v17 offset:12288
    s_waitcnt lgkmcnt(4)
    v_mfma_f32_16x16x32_bf16 v[92:95], v[44:47], a[0:3], 0
    v_mfma_f32_16x16x32_bf16 v[124:127], v[44:47], a[64:67], 0
    ds_read_b64_tr_b16 v[40:41], v18 offset:8192
    ds_read_b64_tr_b16 v[42:43], v18 offset:12288
    s_waitcnt lgkmcnt(4)
    v_mfma_f32_16x16x32_bf16 v[64:67], v[32:35], a[4:7], v[64:67]
    v_mfma_f32_16x16x32_bf16 v[96:99], v[32:35], a[68:71], v[96:99]
    ds_read_b64_tr_b16 v[44:45], v19 offset:8192
    ds_read_b64_tr_b16 v[46:47], v19 offset:12288
    s_waitcnt lgkmcnt(4)
    v_mfma_f32_16x16x32_bf16 v[68:71], v[36:39], a[4:7], v[68:71]
    v_mfma_f32_16x16x32_bf16 v[100:103], v[36:39], a[68:71], v[100:103]
    ds_read_b64_tr_b16 v[32:33], v20 offset:8192
    ds_read_b64_tr_b16 v[34:35], v20 offset:12288
    s_waitcnt lgkmcnt(4)
    v_mfma_f32_16x16x32_bf16 v[72:75], v[40:43], a[4:7], v[72:75]
    v_mfma_f32_16x16x32_bf16 v[104:107], v[40:43], a[68:71], v[104:107]
    ds_read_b64_tr_b16 v[36:37], v21 offset:8192
    ds_read_b64_tr_b16 v[38:39], v21 offset:12288
    s_waitcnt lgkmcnt(4)
    v_mfma_f32_16x16x32_bf16 v[76:79], v[44:47], a[4:7], v[76:79]
    v_mfma_f32_16x16x32_bf16 v[108:111], v[44:47], a[68:71], v[108:111]
    ds_read_b64_tr_b16 v[40:41], v22 offset:8192
    ds_read_b64_tr_b16 v[42:43], v22 offset:12288
    s_waitcnt lgkmcnt(4)
    v_mfma_f32_16x16x32_bf16 v[80:83], v[32:35], a[4:7], v[80:83]
    v_mfma_f32_16x16x32_bf16 v[112:115], v[32:35], a[68:71], v[112:115]
    ds_read_b64_tr_b16 v[44:45], v23 offset:8192
    ds_read_b64_tr_b16 v[46:47], v23 offset:12288
    s_waitcnt lgkmcnt(4)
    v_mfma_f32_16x16x32_bf16 v[84:87], v[36:39], a[4:7], v[84:87]
    v_mfma_f32_16x16x32_bf16 v[116:119], v[36:39], a[68:71], v[116:119]
    ds_read_b64_tr_b16 v[32:33], v16 offset:16384
    ds_read_b64_tr_b16 v[34:35], v16 offset:20480
    s_waitcnt lgkmcnt(4)
    v_mfma_f32_16x16x32_bf16 v[88:91], v[40:43], a[4:7], v[88:91]
    v_mfma_f32_16x16x32_bf16 v[120:123], v[40:43], a[68:71], v[120:123]
    ds_read_b64_tr_b16 v[36:37], v17 offset:16384
    ds_read_b64_tr_b16 v[38:39], v17 offset:20480
    s_waitcnt lgkmcnt(4)
    v_mfma_f32_16x16x32_bf16 v[92:95], v[44:47], a[4:7], v[92:95]
    v_mfma_f32_16x16x32_bf16 v[124:127], v[44:47], a[68:71], v[124:127]
    ds_read_b64_tr_b16 v[40:41], v18 offset:16384
    ds_read_b64_tr_b16 v[42:43], v18 offset:20480
    s_waitcnt lgkmcnt(4)
    v_mfma_f32_16x16x32_bf16 v[64:67], v[32:35], a[8:11], v[64:67]
    v_mfma_f32_16x16x32_bf16 v[96:99], v[32:35], a[72:75], v[96:99]
    ds_read_b64_tr_b16 v[44:45], v19 offset:16384
    ds_read_b64_tr_b16 v[46:47], v19 offset:20480
    s_waitcnt lgkmcnt(4)
    v_mfma_f32_16x16x32_bf16 v[68:71], v[36:39], a[8:11], v[68:71]
    v_mfma_f32_16x16x32_bf16 v[100:103], v[36:39], a[72:75], v[100:103]
    ds_read_b64_tr_b16 v[32:33], v20 offset:16384
    ds_read_b64_tr_b16 v[34:35], v20 offset:20480
    s_waitcnt lgkmcnt(4)
    v_mfma_f32_16x16x32_bf16 v[72:75], v[40:43], a[8:11], v[72:75]
    v_mfma_f32_16x16x32_bf16 v[104:107], v[40:43], a[72:75], v[104:107]
    ds_read_b64_tr_b16 v[36:37], v21 offset:16384
    ds_read_b64_tr_b16 v[38:39], v21 offset:20480
    s_waitcnt lgkmcnt(4)
    v_mfma_f32_16x16x32_bf16 v[76:79], v[44:47], a[8:11], v[76:79]
    v_mfma_f32_16x16x32_bf16 v[108:111], v[44:47], a[72:75], v[108:111]
    ds_read_b64_tr_b16 v[40:41], v22 offset:16384
    ds_read_b64_tr_b16 v[42:43], v22 offset:20480
    s_waitcnt lgkmcnt(4)
    v_mfma_f32_16x16x32_bf16 v[80:83], v[32:35], a[8:11], v[80:83]
    v_mfma_f32_16x16x32_bf16 v[112:115], v[32:35], a[72:75], v[112:115]
    ds_read_b64_tr_b16 v[44:45], v23 offset:16384
    ds_read_b64_tr_b16 v[46:47], v23 offset:20480
    s_waitcnt lgkmcnt(4)
    v_mfma_f32_16x16x32_bf16 v[84:87], v[36:39], a[8:11], v[84:87]
    v_mfma_f32_16x16x32_bf16 v[116:119], v[36:39], a[72:75], v[116:119]
    ds_read_b64_tr_b16 v[32:33], v16 offset:24576
    ds_read_b64_tr_b16 v[34:35], v16 offset:28672
    s_waitcnt lgkmcnt(4)
    v_mfma_f32_16x16x32_bf16 v[88:91], v[40:43], a[8:11], v[88:91]
    v_mfma_f32_16x16x32_bf16 v[120:123], v[40:43], a[72:75], v[120:123]
    ds_read_b64_tr_b16 v[36:37], v17 offset:24576
    ds_read_b64_tr_b16 v[38:39], v17 offset:28672
    s_waitcnt lgkmcnt(4)
    v_mfma_f32_16x16x32_bf16 v[92:95], v[44:47], a[8:11], v[92:95]
    v_mfma_f32_16x16x32_bf16 v[124:127], v[44:47], a[72:75], v[124:127]
    ds_read_b64_tr_b16 v[40:41], v18 offset:24576
    ds_read_b64_tr_b16 v[42:43], v18 offset:28672
    s_waitcnt lgkmcnt(4)
    v_mfma_f32_16x16x32_bf16 v[64:67], v[32:35], a[12:15], v[64:67]
    v_mfma_f32_16x16x32_bf16 v[96:99], v[32:35], a[76:79], v[96:99]
    ds_read_b64_tr_b16 v[44:45], v19 offset:24576
    ds_read_b64_tr_b16 v[46:47], v19 offset:28672
    s_waitcnt lgkmcnt(4)
    v_mfma_f32_16x16x32_bf16 v[68:71], v[36:39], a[12:15], v[68:71]
    v_mfma_f32_16x16x32_bf16 v[100:103], v[36:39], a[76:79], v[100:103]
    ds_read_b64_tr_b16 v[32:33], v20 offset:24576
    ds_read_b64_tr_b16 v[34:35], v20 offset:28672
    s_waitcnt lgkmcnt(4)
    v_mfma_f32_16x16x32_bf16 v[72:75], v[40:43], a[12:15], v[72:75]
    v_mfma_f32_16x16x32_bf16 v[104:107], v[40:43], a[76:79], v[104:107]
    ds_read_b64_tr_b16 v[36:37], v21 offset:24576
    ds_read_b64_tr_b16 v[38:39], v21 offset:28672
    s_waitcnt lgkmcnt(4)
    v_mfma_f32_16x16x32_bf16 v[76:79], v[44:47], a[12:15], v[76:79]
    v_mfma_f32_16x16x32_bf16 v[108:111], v[44:47], a[76:79], v[108:111]
    ds_read_b64_tr_b16 v[40:41], v22 offset:24576
    ds_read_b64_tr_b16 v[42:43], v22 offset:28672
    s_waitcnt lgkmcnt(4)
    v_mfma_f32_16x16x32_bf16 v[80:83], v[32:35], a[12:15], v[80:83]
    v_mfma_f32_16x16x32_bf16 v[112:115], v[32:35], a[76:79], v[112:115]
    ds_read_b64_tr_b16 v[44:45], v23 offset:24576
    ds_read_b64_tr_b16 v[46:47], v23 offset:28672
    s_waitcnt lgkmcnt(4)
    v_mfma_f32_16x16x32_bf16 v[84:87], v[36:39], a[12:15], v[84:87]
    v_mfma_f32_16x16x32_bf16 v[116:119], v[36:39], a[76:79], v[116:119]
    ds_read_b64_tr_b16 v[32:33], v16 offset:32768
    ds_read_b64_tr_b16 v[34:35], v16 offset:36864
    s_waitcnt lgkmcnt(4)
    v_mfma_f32_16x16x32_bf16 v[88:91], v[40:43], a[12:15], v[88:91]
    v_mfma_f32_16x16x32_bf16 v[120:123], v[40:43], a[76:79], v[120:123]
    ds_read_b64_tr_b16 v[36:37], v17 offset:32768
    ds_read_b64_tr_b16 v[38:39], v17 offset:36864
    s_waitcnt lgkmcnt(4)
    v_mfma_f32_16x16x32_bf16 v[92:95], v[44:47], a[12:15], v[92:95]
    v_mfma_f32_16x16x32_bf16 v[124:127], v[44:47], a[76:79], v[124:127]
    ds_read_b64_tr_b16 v[40:41], v18 offset:32768
    ds_read_b64_tr_b16 v[42:43], v18 offset:36864
    s_waitcnt lgkmcnt(4)
    v_mfma_f32_16x16x32_bf16 v[64:67], v[32:35], a[16:19], v[64:67]
    v_mfma_f32_16x16x32_bf16 v[96:99], v[32:35], a[80:83], v[96:99]
    ds_read_b64_tr_b16 v[44:45], v19 offset:32768
    ds_read_b64_tr_b16 v[46:47], v19 offset:36864
    s_waitcnt lgkmcnt(4)
    v_mfma_f32_16x16x32_bf16 v[68:71], v[36:39], a[16:19], v[68:71]
    v_mfma_f32_16x16x32_bf16 v[100:103], v[36:39], a[80:83], v[100:103]
    ds_read_b64_tr_b16 v[32:33], v20 offset:32768
    ds_read_b64_tr_b16 v[34:35], v20 offset:36864
    s_waitcnt lgkmcnt(4)
    v_mfma_f32_16x16x32_bf16 v[72:75], v[40:43], a[16:19], v[72:75]
    v_mfma_f32_16x16x32_bf16 v[104:107], v[40:43], a[80:83], v[104:107]
    ds_read_b64_tr_b16 v[36:37], v21 offset:32768
    ds_read_b64_tr_b16 v[38:39], v21 offset:36864
    s_waitcnt lgkmcnt(4)
    v_mfma_f32_16x16x32_bf16 v[76:79], v[44:47], a[16:19], v[76:79]
    v_mfma_f32_16x16x32_bf16 v[108:111], v[44:47], a[80:83], v[108:111]
    ds_read_b64_tr_b16 v[40:41], v22 offset:32768
    ds_read_b64_tr_b16 v[42:43], v22 offset:36864
    s_waitcnt lgkmcnt(4)
    v_mfma_f32_16x16x32_bf16 v[80:83], v[32:35], a[16:19], v[80:83]
    v_mfma_f32_16x16x32_bf16 v[112:115], v[32:35], a[80:83], v[112:115]
    ds_read_b64_tr_b16 v[44:45], v23 offset:32768
    ds_read_b64_tr_b16 v[46:47], v23 offset:36864
    s_waitcnt lgkmcnt(4)
    v_mfma_f32_16x16x32_bf16 v[84:87], v[36:39], a[16:19], v[84:87]
    v_mfma_f32_16x16x32_bf16 v[116:119], v[36:39], a[80:83], v[116:119]
    ds_read_b64_tr_b16 v[32:33], v16 offset:40960
    ds_read_b64_tr_b16 v[34:35], v16 offset:45056
    s_waitcnt lgkmcnt(4)
    v_mfma_f32_16x16x32_bf16 v[88:91], v[40:43], a[16:19], v[88:91]
    v_mfma_f32_16x16x32_bf16 v[120:123], v[40:43], a[80:83], v[120:123]
    ds_read_b64_tr_b16 v[36:37], v17 offset:40960
    ds_read_b64_tr_b16 v[38:39], v17 offset:45056
    s_waitcnt lgkmcnt(4)
    v_mfma_f32_16x16x32_bf16 v[92:95], v[44:47], a[16:19], v[92:95]
    v_mfma_f32_16x16x32_bf16 v[124:127], v[44:47], a[80:83], v[124:127]
    ds_read_b64_tr_b16 v[40:41], v18 offset:40960
    ds_read_b64_tr_b16 v[42:43], v18 offset:45056
    s_waitcnt lgkmcnt(4)
    v_mfma_f32_16x16x32_bf16 v[64:67], v[32:35], a[20:23], v[64:67]
    v_mfma_f32_16x16x32_bf16 v[96:99], v[32:35], a[84:87], v[96:99]
    ds_read_b64_tr_b16 v[44:45], v19 offset:40960
    ds_read_b64_tr_b16 v[46:47], v19 offset:45056
    s_waitcnt lgkmcnt(4)
    v_mfma_f32_16x16x32_bf16 v[68:71], v[36:39], a[20:23], v[68:71]
    v_mfma_f32_16x16x32_bf16 v[100:103], v[36:39], a[84:87], v[100:103]
    ds_read_b64_tr_b16 v[32:33], v20 offset:40960
    ds_read_b64_tr_b16 v[34:35], v20 offset:45056
    s_waitcnt lgkmcnt(4)
    v_mfma_f32_16x16x32_bf16 v[72:75], v[40:43], a[20:23], v[72:75]
    v_mfma_f32_16x16x32_bf16 v[104:107], v[40:43], a[84:87], v[104:107]
    ds_read_b64_tr_b16 v[36:37], v21 offset:40960
    ds_read_b64_tr_b16 v[38:39], v21 offset:45056
    s_waitcnt lgkmcnt(4)
    v_mfma_f32_16x16x32_bf16 v[76:79], v[44:47], a[20:23], v[76:79]
    v_mfma_f32_16x16x32_bf16 v[108:111], v[44:47], a[84:87], v[108:111]
    ds_read_b64_tr_b16 v[40:41], v22 offset:40960
    ds_read_b64_tr_b16 v[42:43], v22 offset:45056
    s_waitcnt lgkmcnt(4)
    v_mfma_f32_16x16x32_bf16 v[80:83], v[32:35], a[20:23], v[80:83]
    v_mfma_f32_16x16x32_bf16 v[112:115], v[32:35], a[84:87], v[112:115]
    ds_read_b64_tr_b16 v[44:45], v23 offset:40960
    ds_read_b64_tr_b16 v[46:47], v23 offset:45056
    s_waitcnt lgkmcnt(4)
    v_mfma_f32_16x16x32_bf16 v[84:87], v[36:39], a[20:23], v[84:87]
    v_mfma_f32_16x16x32_bf16 v[116:119], v[36:39], a[84:87], v[116:119]
    ds_read_b64_tr_b16 v[32:33], v16 offset:49152
    ds_read_b64_tr_b16 v[34:35], v16 offset:53248
    s_waitcnt lgkmcnt(4)
    v_mfma_f32_16x16x32_bf16 v[88:91], v[40:43], a[20:23], v[88:91]
    v_mfma_f32_16x16x32_bf16 v[120:123], v[40:43], a[84:87], v[120:123]
    ds_read_b64_tr_b16 v[36:37], v17 offset:49152
    ds_read_b64_tr_b16 v[38:39], v17 offset:53248
    s_waitcnt lgkmcnt(4)
    v_mfma_f32_16x16x32_bf16 v[92:95], v[44:47], a[20:23], v[92:95]
    v_mfma_f32_16x16x32_bf16 v[124:127], v[44:47], a[84:87], v[124:127]
    ds_read_b64_tr_b16 v[40:41], v18 offset:49152
    ds_read_b64_tr_b16 v[42:43], v18 offset:53248
    s_waitcnt lgkmcnt(4)
    v_mfma_f32_16x16x32_bf16 v[64:67], v[32:35], a[24:27], v[64:67]
    v_mfma_f32_16x16x32_bf16 v[96:99], v[32:35], a[88:91], v[96:99]
    ds_read_b64_tr_b16 v[44:45], v19 offset:49152
    ds_read_b64_tr_b16 v[46:47], v19 offset:53248
    s_waitcnt lgkmcnt(4)
    v_mfma_f32_16x16x32_bf16 v[68:71], v[36:39], a[24:27], v[68:71]
    v_mfma_f32_16x16x32_bf16 v[100:103], v[36:39], a[88:91], v[100:103]
    ds_read_b64_tr_b16 v[32:33], v20 offset:49152
    ds_read_b64_tr_b16 v[34:35], v20 offset:53248
    s_waitcnt lgkmcnt(4)
    v_mfma_f32_16x16x32_bf16 v[72:75], v[40:43], a[24:27], v[72:75]
    v_mfma_f32_16x16x32_bf16 v[104:107], v[40:43], a[88:91], v[104:107]
    ds_read_b64_tr_b16 v[36:37], v21 offset:49152
    ds_read_b64_tr_b16 v[38:39], v21 offset:53248
    s_waitcnt lgkmcnt(4)
    v_mfma_f32_16x16x32_bf16 v[76:79], v[44:47], a[24:27], v[76:79]
    v_mfma_f32_16x16x32_bf16 v[108:111], v[44:47], a[88:91], v[108:111]
    ds_read_b64_tr_b16 v[40:41], v22 offset:49152
    ds_read_b64_tr_b16 v[42:43], v22 offset:53248
    s_waitcnt lgkmcnt(4)
    v_mfma_f32_16x16x32_bf16 v[80:83], v[32:35], a[24:27], v[80:83]
    v_mfma_f32_16x16x32_bf16 v[112:115], v[32:35], a[88:91], v[112:115]
    ds_read_b64_tr_b16 v[44:45], v23 offset:49152
    ds_read_b64_tr_b16 v[46:47], v23 offset:53248
    s_waitcnt lgkmcnt(4)
    v_mfma_f32_16x16x32_bf16 v[84:87], v[36:39], a[24:27], v[84:87]
    v_mfma_f32_16x16x32_bf16 v[116:119], v[36:39], a[88:91], v[116:119]
    ds_read_b64_tr_b16 v[32:33], v16 offset:57344
    ds_read_b64_tr_b16 v[34:35], v16 offset:61440
    s_waitcnt lgkmcnt(4)
    v_mfma_f32_16x16x32_bf16 v[88:91], v[40:43], a[24:27], v[88:91]
    v_mfma_f32_16x16x32_bf16 v[120:123], v[40:43], a[88:91], v[120:123]
    ds_read_b64_tr_b16 v[36:37], v17 offset:57344
    ds_read_b64_tr_b16 v[38:39], v17 offset:61440
    s_waitcnt lgkmcnt(4)
    v_mfma_f32_16x16x32_bf16 v[92:95], v[44:47], a[24:27], v[92:95]
    v_mfma_f32_16x16x32_bf16 v[124:127], v[44:47], a[88:91], v[124:127]
    ds_read_b64_tr_b16 v[40:41], v18 offset:57344
    ds_read_b64_tr_b16 v[42:43], v18 offset:61440
    s_waitcnt lgkmcnt(4)
    v_mfma_f32_16x16x32_bf16 v[64:67], v[32:35], a[28:31], v[64:67]
    v_mfma_f32_16x16x32_bf16 v[96:99], v[32:35], a[92:95], v[96:99]
    ds_read_b64_tr_b16 v[44:45], v19 offset:57344
    ds_read_b64_tr_b16 v[46:47], v19 offset:61440
    s_waitcnt lgkmcnt(4)
    v_mfma_f32_16x16x32_bf16 v[68:71], v[36:39], a[28:31], v[68:71]
    v_mfma_f32_16x16x32_bf16 v[100:103], v[36:39], a[92:95], v[100:103]
    ds_read_b64_tr_b16 v[32:33], v20 offset:57344
    ds_read_b64_tr_b16 v[34:35], v20 offset:61440
    s_waitcnt lgkmcnt(4)
    v_mfma_f32_16x16x32_bf16 v[72:75], v[40:43], a[28:31], v[72:75]
    v_mfma_f32_16x16x32_bf16 v[104:107], v[40:43], a[92:95], v[104:107]
    ds_read_b64_tr_b16 v[36:37], v21 offset:57344
    ds_read_b64_tr_b16 v[38:39], v21 offset:61440
    s_waitcnt lgkmcnt(4)
    v_mfma_f32_16x16x32_bf16 v[76:79], v[44:47], a[28:31], v[76:79]
    v_mfma_f32_16x16x32_bf16 v[108:111], v[44:47], a[92:95], v[108:111]
    ds_read_b64_tr_b16 v[40:41], v22 offset:57344
    ds_read_b64_tr_b16 v[42:43], v22 offset:61440
    s_waitcnt lgkmcnt(4)
    v_mfma_f32_16x16x32_bf16 v[80:83], v[32:35], a[28:31], v[80:83]
    v_mfma_f32_16x16x32_bf16 v[112:115], v[32:35], a[92:95], v[112:115]
    ds_read_b64_tr_b16 v[44:45], v23 offset:57344
    ds_read_b64_tr_b16 v[46:47], v23 offset:61440
    s_waitcnt lgkmcnt(4)
    v_mfma_f32_16x16x32_bf16 v[84:87], v[36:39], a[28:31], v[84:87]
    v_mfma_f32_16x16x32_bf16 v[116:119], v[36:39], a[92:95], v[116:119]
    ds_read_b64_tr_b16 v[32:33], v24 offset:0
    ds_read_b64_tr_b16 v[34:35], v24 offset:4096
    s_waitcnt lgkmcnt(4)
    v_mfma_f32_16x16x32_bf16 v[88:91], v[40:43], a[28:31], v[88:91]
    v_mfma_f32_16x16x32_bf16 v[120:123], v[40:43], a[92:95], v[120:123]
    ds_read_b64_tr_b16 v[36:37], v25 offset:0
    ds_read_b64_tr_b16 v[38:39], v25 offset:4096
    s_waitcnt lgkmcnt(4)
    v_mfma_f32_16x16x32_bf16 v[92:95], v[44:47], a[28:31], v[92:95]
    v_mfma_f32_16x16x32_bf16 v[124:127], v[44:47], a[92:95], v[124:127]
    ds_read_b64_tr_b16 v[40:41], v26 offset:0
    ds_read_b64_tr_b16 v[42:43], v26 offset:4096
    s_waitcnt lgkmcnt(4)
    v_mfma_f32_16x16x32_bf16 v[64:67], v[32:35], a[32:35], v[64:67]
    v_mfma_f32_16x16x32_bf16 v[96:99], v[32:35], a[96:99], v[96:99]
    ds_read_b64_tr_b16 v[44:45], v27 offset:0
    ds_read_b64_tr_b16 v[46:47], v27 offset:4096
    s_waitcnt lgkmcnt(4)
    v_mfma_f32_16x16x32_bf16 v[68:71], v[36:39], a[32:35], v[68:71]
    v_mfma_f32_16x16x32_bf16 v[100:103], v[36:39], a[96:99], v[100:103]
    ds_read_b64_tr_b16 v[32:33], v28 offset:0
    ds_read_b64_tr_b16 v[34:35], v28 offset:4096
    s_waitcnt lgkmcnt(4)
    v_mfma_f32_16x16x32_bf16 v[72:75], v[40:43], a[32:35], v[72:75]
    v_mfma_f32_16x16x32_bf16 v[104:107], v[40:43], a[96:99], v[104:107]
    ds_read_b64_tr_b16 v[36:37], v29 offset:0
    ds_read_b64_tr_b16 v[38:39], v29 offset:4096
    s_waitcnt lgkmcnt(4)
    v_mfma_f32_16x16x32_bf16 v[76:79], v[44:47], a[32:35], v[76:79]
    v_mfma_f32_16x16x32_bf16 v[108:111], v[44:47], a[96:99], v[108:111]
    ds_read_b64_tr_b16 v[40:41], v30 offset:0
    ds_read_b64_tr_b16 v[42:43], v30 offset:4096
    s_waitcnt lgkmcnt(4)
    v_mfma_f32_16x16x32_bf16 v[80:83], v[32:35], a[32:35], v[80:83]
    v_mfma_f32_16x16x32_bf16 v[112:115], v[32:35], a[96:99], v[112:115]
    ds_read_b64_tr_b16 v[44:45], v31 offset:0
    ds_read_b64_tr_b16 v[46:47], v31 offset:4096
    s_waitcnt lgkmcnt(4)
    v_mfma_f32_16x16x32_bf16 v[84:87], v[36:39], a[32:35], v[84:87]
    v_mfma_f32_16x16x32_bf16 v[116:119], v[36:39], a[96:99], v[116:119]
    ds_read_b64_tr_b16 v[32:33], v24 offset:8192
    ds_read_b64_tr_b16 v[34:35], v24 offset:12288
    s_waitcnt lgkmcnt(4)
    v_mfma_f32_16x16x32_bf16 v[88:91], v[40:43], a[32:35], v[88:91]
    v_mfma_f32_16x16x32_bf16 v[120:123], v[40:43], a[96:99], v[120:123]
    ds_read_b64_tr_b16 v[36:37], v25 offset:8192
    ds_read_b64_tr_b16 v[38:39], v25 offset:12288
    s_waitcnt lgkmcnt(4)
    v_mfma_f32_16x16x32_bf16 v[92:95], v[44:47], a[32:35], v[92:95]
    v_mfma_f32_16x16x32_bf16 v[124:127], v[44:47], a[96:99], v[124:127]
    ds_read_b64_tr_b16 v[40:41], v26 offset:8192
    ds_read_b64_tr_b16 v[42:43], v26 offset:12288
    s_waitcnt lgkmcnt(4)
    v_mfma_f32_16x16x32_bf16 v[64:67], v[32:35], a[36:39], v[64:67]
    v_mfma_f32_16x16x32_bf16 v[96:99], v[32:35], a[100:103], v[96:99]
    ds_read_b64_tr_b16 v[44:45], v27 offset:8192
    ds_read_b64_tr_b16 v[46:47], v27 offset:12288
    s_waitcnt lgkmcnt(4)
    v_mfma_f32_16x16x32_bf16 v[68:71], v[36:39], a[36:39], v[68:71]
    v_mfma_f32_16x16x32_bf16 v[100:103], v[36:39], a[100:103], v[100:103]
    ds_read_b64_tr_b16 v[32:33], v28 offset:8192
    ds_read_b64_tr_b16 v[34:35], v28 offset:12288
    s_waitcnt lgkmcnt(4)
    v_mfma_f32_16x16x32_bf16 v[72:75], v[40:43], a[36:39], v[72:75]
    v_mfma_f32_16x16x32_bf16 v[104:107], v[40:43], a[100:103], v[104:107]
    ds_read_b64_tr_b16 v[36:37], v29 offset:8192
    ds_read_b64_tr_b16 v[38:39], v29 offset:12288
    s_waitcnt lgkmcnt(4)
    v_mfma_f32_16x16x32_bf16 v[76:79], v[44:47], a[36:39], v[76:79]
    v_mfma_f32_16x16x32_bf16 v[108:111], v[44:47], a[100:103], v[108:111]
    ds_read_b64_tr_b16 v[40:41], v30 offset:8192
    ds_read_b64_tr_b16 v[42:43], v30 offset:12288
    s_waitcnt lgkmcnt(4)
    v_mfma_f32_16x16x32_bf16 v[80:83], v[32:35], a[36:39], v[80:83]
    v_mfma_f32_16x16x32_bf16 v[112:115], v[32:35], a[100:103], v[112:115]
    ds_read_b64_tr_b16 v[44:45], v31 offset:8192
    ds_read_b64_tr_b16 v[46:47], v31 offset:12288
    s_waitcnt lgkmcnt(4)
    v_mfma_f32_16x16x32_bf16 v[84:87], v[36:39], a[36:39], v[84:87]
    v_mfma_f32_16x16x32_bf16 v[116:119], v[36:39], a[100:103], v[116:119]
    ds_read_b64_tr_b16 v[32:33], v24 offset:16384
    ds_read_b64_tr_b16 v[34:35], v24 offset:20480
    s_waitcnt lgkmcnt(4)
    v_mfma_f32_16x16x32_bf16 v[88:91], v[40:43], a[36:39], v[88:91]
    v_mfma_f32_16x16x32_bf16 v[120:123], v[40:43], a[100:103], v[120:123]
    ds_read_b64_tr_b16 v[36:37], v25 offset:16384
    ds_read_b64_tr_b16 v[38:39], v25 offset:20480
    s_waitcnt lgkmcnt(4)
    v_mfma_f32_16x16x32_bf16 v[92:95], v[44:47], a[36:39], v[92:95]
    v_mfma_f32_16x16x32_bf16 v[124:127], v[44:47], a[100:103], v[124:127]
    ds_read_b64_tr_b16 v[40:41], v26 offset:16384
    ds_read_b64_tr_b16 v[42:43], v26 offset:20480
    s_waitcnt lgkmcnt(4)
    v_mfma_f32_16x16x32_bf16 v[64:67], v[32:35], a[40:43], v[64:67]
    v_mfma_f32_16x16x32_bf16 v[96:99], v[32:35], a[104:107], v[96:99]
    ds_read_b64_tr_b16 v[44:45], v27 offset:16384
    ds_read_b64_tr_b16 v[46:47], v27 offset:20480
    s_waitcnt lgkmcnt(4)
    v_mfma_f32_16x16x32_bf16 v[68:71], v[36:39], a[40:43], v[68:71]
    v_mfma_f32_16x16x32_bf16 v[100:103], v[36:39], a[104:107], v[100:103]
    ds_read_b64_tr_b16 v[32:33], v28 offset:16384
    ds_read_b64_tr_b16 v[34:35], v28 offset:20480
    s_waitcnt lgkmcnt(4)
    v_mfma_f32_16x16x32_bf16 v[72:75], v[40:43], a[40:43], v[72:75]
    v_mfma_f32_16x16x32_bf16 v[104:107], v[40:43], a[104:107], v[104:107]
    ds_read_b64_tr_b16 v[36:37], v29 offset:16384
    ds_read_b64_tr_b16 v[38:39], v29 offset:20480
    s_waitcnt lgkmcnt(4)
    v_mfma_f32_16x16x32_bf16 v[76:79], v[44:47], a[40:43], v[76:79]
    v_mfma_f32_16x16x32_bf16 v[108:111], v[44:47], a[104:107], v[108:111]
    ds_read_b64_tr_b16 v[40:41], v30 offset:16384
    ds_read_b64_tr_b16 v[42:43], v30 offset:20480
    s_waitcnt lgkmcnt(4)
    v_mfma_f32_16x16x32_bf16 v[80:83], v[32:35], a[40:43], v[80:83]
    v_mfma_f32_16x16x32_bf16 v[112:115], v[32:35], a[104:107], v[112:115]
    ds_read_b64_tr_b16 v[44:45], v31 offset:16384
    ds_read_b64_tr_b16 v[46:47], v31 offset:20480
    s_waitcnt lgkmcnt(4)
    v_mfma_f32_16x16x32_bf16 v[84:87], v[36:39], a[40:43], v[84:87]
    v_mfma_f32_16x16x32_bf16 v[116:119], v[36:39], a[104:107], v[116:119]
    ds_read_b64_tr_b16 v[32:33], v24 offset:24576
    ds_read_b64_tr_b16 v[34:35], v24 offset:28672
    s_waitcnt lgkmcnt(4)
    v_mfma_f32_16x16x32_bf16 v[88:91], v[40:43], a[40:43], v[88:91]
    v_mfma_f32_16x16x32_bf16 v[120:123], v[40:43], a[104:107], v[120:123]
    ds_read_b64_tr_b16 v[36:37], v25 offset:24576
    ds_read_b64_tr_b16 v[38:39], v25 offset:28672
    s_waitcnt lgkmcnt(4)
    v_mfma_f32_16x16x32_bf16 v[92:95], v[44:47], a[40:43], v[92:95]
    v_mfma_f32_16x16x32_bf16 v[124:127], v[44:47], a[104:107], v[124:127]
    ds_read_b64_tr_b16 v[40:41], v26 offset:24576
    ds_read_b64_tr_b16 v[42:43], v26 offset:28672
    s_waitcnt lgkmcnt(4)
    v_mfma_f32_16x16x32_bf16 v[64:67], v[32:35], a[44:47], v[64:67]
    v_mfma_f32_16x16x32_bf16 v[96:99], v[32:35], a[108:111], v[96:99]
    ds_read_b64_tr_b16 v[44:45], v27 offset:24576
    ds_read_b64_tr_b16 v[46:47], v27 offset:28672
    s_waitcnt lgkmcnt(4)
    v_mfma_f32_16x16x32_bf16 v[68:71], v[36:39], a[44:47], v[68:71]
    v_mfma_f32_16x16x32_bf16 v[100:103], v[36:39], a[108:111], v[100:103]
    ds_read_b64_tr_b16 v[32:33], v28 offset:24576
    ds_read_b64_tr_b16 v[34:35], v28 offset:28672
    s_waitcnt lgkmcnt(4)
    v_mfma_f32_16x16x32_bf16 v[72:75], v[40:43], a[44:47], v[72:75]
    v_mfma_f32_16x16x32_bf16 v[104:107], v[40:43], a[108:111], v[104:107]
    ds_read_b64_tr_b16 v[36:37], v29 offset:24576
    ds_read_b64_tr_b16 v[38:39], v29 offset:28672
    s_waitcnt lgkmcnt(4)
    v_mfma_f32_16x16x32_bf16 v[76:79], v[44:47], a[44:47], v[76:79]
    v_mfma_f32_16x16x32_bf16 v[108:111], v[44:47], a[108:111], v[108:111]
    ds_read_b64_tr_b16 v[40:41], v30 offset:24576
    ds_read_b64_tr_b16 v[42:43], v30 offset:28672
    s_waitcnt lgkmcnt(4)
    v_mfma_f32_16x16x32_bf16 v[80:83], v[32:35], a[44:47], v[80:83]
    v_mfma_f32_16x16x32_bf16 v[112:115], v[32:35], a[108:111], v[112:115]
    ds_read_b64_tr_b16 v[44:45], v31 offset:24576
    ds_read_b64_tr_b16 v[46:47], v31 offset:28672
    s_waitcnt lgkmcnt(4)
    v_mfma_f32_16x16x32_bf16 v[84:87], v[36:39], a[44:47], v[84:87]
    v_mfma_f32_16x16x32_bf16 v[116:119], v[36:39], a[108:111], v[116:119]
    ds_read_b64_tr_b16 v[32:33], v24 offset:32768
    ds_read_b64_tr_b16 v[34:35], v24 offset:36864
    s_waitcnt lgkmcnt(4)
    v_mfma_f32_16x16x32_bf16 v[88:91], v[40:43], a[44:47], v[88:91]
    v_mfma_f32_16x16x32_bf16 v[120:123], v[40:43], a[108:111], v[120:123]
    ds_read_b64_tr_b16 v[36:37], v25 offset:32768
    ds_read_b64_tr_b16 v[38:39], v25 offset:36864
    s_waitcnt lgkmcnt(4)
    v_mfma_f32_16x16x32_bf16 v[92:95], v[44:47], a[44:47], v[92:95]
    v_mfma_f32_16x16x32_bf16 v[124:127], v[44:47], a[108:111], v[124:127]
    ds_read_b64_tr_b16 v[40:41], v26 offset:32768
    ds_read_b64_tr_b16 v[42:43], v26 offset:36864
    s_waitcnt lgkmcnt(4)
    v_mfma_f32_16x16x32_bf16 v[64:67], v[32:35], a[48:51], v[64:67]
    v_mfma_f32_16x16x32_bf16 v[96:99], v[32:35], a[112:115], v[96:99]
    ds_read_b64_tr_b16 v[44:45], v27 offset:32768
    ds_read_b64_tr_b16 v[46:47], v27 offset:36864
    s_waitcnt lgkmcnt(4)
    v_mfma_f32_16x16x32_bf16 v[68:71], v[36:39], a[48:51], v[68:71]
    v_mfma_f32_16x16x32_bf16 v[100:103], v[36:39], a[112:115], v[100:103]
    ds_read_b64_tr_b16 v[32:33], v28 offset:32768
    ds_read_b64_tr_b16 v[34:35], v28 offset:36864
    s_waitcnt lgkmcnt(4)
    v_mfma_f32_16x16x32_bf16 v[72:75], v[40:43], a[48:51], v[72:75]
    v_mfma_f32_16x16x32_bf16 v[104:107], v[40:43], a[112:115], v[104:107]
    ds_read_b64_tr_b16 v[36:37], v29 offset:32768
    ds_read_b64_tr_b16 v[38:39], v29 offset:36864
    s_waitcnt lgkmcnt(4)
    v_mfma_f32_16x16x32_bf16 v[76:79], v[44:47], a[48:51], v[76:79]
    v_mfma_f32_16x16x32_bf16 v[108:111], v[44:47], a[112:115], v[108:111]
    ds_read_b64_tr_b16 v[40:41], v30 offset:32768
    ds_read_b64_tr_b16 v[42:43], v30 offset:36864
    s_waitcnt lgkmcnt(4)
    v_mfma_f32_16x16x32_bf16 v[80:83], v[32:35], a[48:51], v[80:83]
    v_mfma_f32_16x16x32_bf16 v[112:115], v[32:35], a[112:115], v[112:115]
    ds_read_b64_tr_b16 v[44:45], v31 offset:32768
    ds_read_b64_tr_b16 v[46:47], v31 offset:36864
    s_waitcnt lgkmcnt(4)
    v_mfma_f32_16x16x32_bf16 v[84:87], v[36:39], a[48:51], v[84:87]
    v_mfma_f32_16x16x32_bf16 v[116:119], v[36:39], a[112:115], v[116:119]
    ds_read_b64_tr_b16 v[32:33], v24 offset:40960
    ds_read_b64_tr_b16 v[34:35], v24 offset:45056
    s_waitcnt lgkmcnt(4)
    v_mfma_f32_16x16x32_bf16 v[88:91], v[40:43], a[48:51], v[88:91]
    v_mfma_f32_16x16x32_bf16 v[120:123], v[40:43], a[112:115], v[120:123]
    ds_read_b64_tr_b16 v[36:37], v25 offset:40960
    ds_read_b64_tr_b16 v[38:39], v25 offset:45056
    s_waitcnt lgkmcnt(4)
    v_mfma_f32_16x16x32_bf16 v[92:95], v[44:47], a[48:51], v[92:95]
    v_mfma_f32_16x16x32_bf16 v[124:127], v[44:47], a[112:115], v[124:127]
    ds_read_b64_tr_b16 v[40:41], v26 offset:40960
    ds_read_b64_tr_b16 v[42:43], v26 offset:45056
    s_waitcnt lgkmcnt(4)
    v_mfma_f32_16x16x32_bf16 v[64:67], v[32:35], a[52:55], v[64:67]
    v_mfma_f32_16x16x32_bf16 v[96:99], v[32:35], a[116:119], v[96:99]
    ds_read_b64_tr_b16 v[44:45], v27 offset:40960
    ds_read_b64_tr_b16 v[46:47], v27 offset:45056
    s_waitcnt lgkmcnt(4)
    v_mfma_f32_16x16x32_bf16 v[68:71], v[36:39], a[52:55], v[68:71]
    v_mfma_f32_16x16x32_bf16 v[100:103], v[36:39], a[116:119], v[100:103]
    ds_read_b64_tr_b16 v[32:33], v28 offset:40960
    ds_read_b64_tr_b16 v[34:35], v28 offset:45056
    s_waitcnt lgkmcnt(4)
    v_mfma_f32_16x16x32_bf16 v[72:75], v[40:43], a[52:55], v[72:75]
    v_mfma_f32_16x16x32_bf16 v[104:107], v[40:43], a[116:119], v[104:107]
    ds_read_b64_tr_b16 v[36:37], v29 offset:40960
    ds_read_b64_tr_b16 v[38:39], v29 offset:45056
    s_waitcnt lgkmcnt(4)
    v_mfma_f32_16x16x32_bf16 v[76:79], v[44:47], a[52:55], v[76:79]
    v_mfma_f32_16x16x32_bf16 v[108:111], v[44:47], a[116:119], v[108:111]
    ds_read_b64_tr_b16 v[40:41], v30 offset:40960
    ds_read_b64_tr_b16 v[42:43], v30 offset:45056
    s_waitcnt lgkmcnt(4)
    v_mfma_f32_16x16x32_bf16 v[80:83], v[32:35], a[52:55], v[80:83]
    v_mfma_f32_16x16x32_bf16 v[112:115], v[32:35], a[116:119], v[112:115]
    ds_read_b64_tr_b16 v[44:45], v31 offset:40960
    ds_read_b64_tr_b16 v[46:47], v31 offset:45056
    s_waitcnt lgkmcnt(4)
    v_mfma_f32_16x16x32_bf16 v[84:87], v[36:39], a[52:55], v[84:87]
    v_mfma_f32_16x16x32_bf16 v[116:119], v[36:39], a[116:119], v[116:119]
    ds_read_b64_tr_b16 v[32:33], v24 offset:49152
    ds_read_b64_tr_b16 v[34:35], v24 offset:53248
    s_waitcnt lgkmcnt(4)
    v_mfma_f32_16x16x32_bf16 v[88:91], v[40:43], a[52:55], v[88:91]
    v_mfma_f32_16x16x32_bf16 v[120:123], v[40:43], a[116:119], v[120:123]
    ds_read_b64_tr_b16 v[36:37], v25 offset:49152
    ds_read_b64_tr_b16 v[38:39], v25 offset:53248
    s_waitcnt lgkmcnt(4)
    v_mfma_f32_16x16x32_bf16 v[92:95], v[44:47], a[52:55], v[92:95]
    v_mfma_f32_16x16x32_bf16 v[124:127], v[44:47], a[116:119], v[124:127]
    ds_read_b64_tr_b16 v[40:41], v26 offset:49152
    ds_read_b64_tr_b16 v[42:43], v26 offset:53248
    s_waitcnt lgkmcnt(4)
    v_mfma_f32_16x16x32_bf16 v[64:67], v[32:35], a[56:59], v[64:67]
    v_mfma_f32_16x16x32_bf16 v[96:99], v[32:35], a[120:123], v[96:99]
    ds_read_b64_tr_b16 v[44:45], v27 offset:49152
    ds_read_b64_tr_b16 v[46:47], v27 offset:53248
    s_waitcnt lgkmcnt(4)
    v_mfma_f32_16x16x32_bf16 v[68:71], v[36:39], a[56:59], v[68:71]
    v_mfma_f32_16x16x32_bf16 v[100:103], v[36:39], a[120:123], v[100:103]
    ds_read_b64_tr_b16 v[32:33], v28 offset:49152
    ds_read_b64_tr_b16 v[34:35], v28 offset:53248
    s_waitcnt lgkmcnt(4)
    v_mfma_f32_16x16x32_bf16 v[72:75], v[40:43], a[56:59], v[72:75]
    v_mfma_f32_16x16x32_bf16 v[104:107], v[40:43], a[120:123], v[104:107]
    ds_read_b64_tr_b16 v[36:37], v29 offset:49152
    ds_read_b64_tr_b16 v[38:39], v29 offset:53248
    s_waitcnt lgkmcnt(4)
    v_mfma_f32_16x16x32_bf16 v[76:79], v[44:47], a[56:59], v[76:79]
    v_mfma_f32_16x16x32_bf16 v[108:111], v[44:47], a[120:123], v[108:111]
    ds_read_b64_tr_b16 v[40:41], v30 offset:49152
    ds_read_b64_tr_b16 v[42:43], v30 offset:53248
    s_waitcnt lgkmcnt(4)
    v_mfma_f32_16x16x32_bf16 v[80:83], v[32:35], a[56:59], v[80:83]
    v_mfma_f32_16x16x32_bf16 v[112:115], v[32:35], a[120:123], v[112:115]
    ds_read_b64_tr_b16 v[44:45], v31 offset:49152
    ds_read_b64_tr_b16 v[46:47], v31 offset:53248
    s_waitcnt lgkmcnt(4)
    v_mfma_f32_16x16x32_bf16 v[84:87], v[36:39], a[56:59], v[84:87]
    v_mfma_f32_16x16x32_bf16 v[116:119], v[36:39], a[120:123], v[116:119]
    ds_read_b64_tr_b16 v[32:33], v24 offset:57344
    ds_read_b64_tr_b16 v[34:35], v24 offset:61440
    s_waitcnt lgkmcnt(4)
    v_mfma_f32_16x16x32_bf16 v[88:91], v[40:43], a[56:59], v[88:91]
    v_mfma_f32_16x16x32_bf16 v[120:123], v[40:43], a[120:123], v[120:123]
    ds_read_b64_tr_b16 v[36:37], v25 offset:57344
    ds_read_b64_tr_b16 v[38:39], v25 offset:61440
    s_waitcnt lgkmcnt(4)
    v_mfma_f32_16x16x32_bf16 v[92:95], v[44:47], a[56:59], v[92:95]
    v_mfma_f32_16x16x32_bf16 v[124:127], v[44:47], a[120:123], v[124:127]
    ds_read_b64_tr_b16 v[40:41], v26 offset:57344
    ds_read_b64_tr_b16 v[42:43], v26 offset:61440
    s_waitcnt lgkmcnt(4)
    v_mfma_f32_16x16x32_bf16 v[64:67], v[32:35], a[60:63], v[64:67]
    v_mfma_f32_16x16x32_bf16 v[96:99], v[32:35], a[124:127], v[96:99]
    ds_read_b64_tr_b16 v[44:45], v27 offset:57344
    ds_read_b64_tr_b16 v[46:47], v27 offset:61440
    s_waitcnt lgkmcnt(4)
    v_mfma_f32_16x16x32_bf16 v[68:71], v[36:39], a[60:63], v[68:71]
    v_mfma_f32_16x16x32_bf16 v[100:103], v[36:39], a[124:127], v[100:103]
    ds_read_b64_tr_b16 v[32:33], v28 offset:57344
    ds_read_b64_tr_b16 v[34:35], v28 offset:61440
    s_waitcnt lgkmcnt(4)
    v_mfma_f32_16x16x32_bf16 v[72:75], v[40:43], a[60:63], v[72:75]
    v_mfma_f32_16x16x32_bf16 v[104:107], v[40:43], a[124:127], v[104:107]
    ds_read_b64_tr_b16 v[36:37], v29 offset:57344
    ds_read_b64_tr_b16 v[38:39], v29 offset:61440
    s_waitcnt lgkmcnt(4)
    v_mfma_f32_16x16x32_bf16 v[76:79], v[44:47], a[60:63], v[76:79]
    v_mfma_f32_16x16x32_bf16 v[108:111], v[44:47], a[124:127], v[108:111]
    ds_read_b64_tr_b16 v[40:41], v30 offset:57344
    ds_read_b64_tr_b16 v[42:43], v30 offset:61440
    s_waitcnt lgkmcnt(4)
    v_mfma_f32_16x16x32_bf16 v[80:83], v[32:35], a[60:63], v[80:83]
    v_mfma_f32_16x16x32_bf16 v[112:115], v[32:35], a[124:127], v[112:115]
    ds_read_b64_tr_b16 v[44:45], v31 offset:57344
    ds_read_b64_tr_b16 v[46:47], v31 offset:61440
    s_waitcnt lgkmcnt(4)
    v_mfma_f32_16x16x32_bf16 v[84:87], v[36:39], a[60:63], v[84:87]
    v_mfma_f32_16x16x32_bf16 v[116:119], v[36:39], a[124:127], v[116:119]
    s_waitcnt lgkmcnt(2)
    v_mfma_f32_16x16x32_bf16 v[88:91], v[40:43], a[60:63], v[88:91]
    v_mfma_f32_16x16x32_bf16 v[120:123], v[40:43], a[124:127], v[120:123]
    s_waitcnt lgkmcnt(0)
    v_mfma_f32_16x16x32_bf16 v[92:95], v[44:47], a[60:63], v[92:95]
    v_mfma_f32_16x16x32_bf16 v[124:127], v[44:47], a[124:127], v[124:127]
    s_lshl_b32 s33, s31, 18
    s_lshl_b32 s34, s21, 13
    s_add_u32 s33, s33, s34
    s_add_u32 s33, s33, 0x1000000
    v_cvt_pk_bf16_f32 v40, v64, v65
    v_cvt_pk_bf16_f32 v41, v66, v67
    v_cvt_pk_bf16_f32 v42, v68, v69
    v_cvt_pk_bf16_f32 v43, v70, v71
    buffer_store_dwordx4 v[40:43], v9, s[4:7], s33 offen offset:0 sc1
    v_cvt_pk_bf16_f32 v44, v72, v73
    v_cvt_pk_bf16_f32 v45, v74, v75
    v_cvt_pk_bf16_f32 v46, v76, v77
    v_cvt_pk_bf16_f32 v47, v78, v79
    buffer_store_dwordx4 v[44:47], v9, s[4:7], s33 offen offset:1024 sc1
    v_cvt_pk_bf16_f32 v48, v80, v81
    v_cvt_pk_bf16_f32 v49, v82, v83
    v_cvt_pk_bf16_f32 v50, v84, v85
    v_cvt_pk_bf16_f32 v51, v86, v87
    buffer_store_dwordx4 v[48:51], v9, s[4:7], s33 offen offset:2048 sc1
    v_cvt_pk_bf16_f32 v52, v88, v89
    v_cvt_pk_bf16_f32 v53, v90, v91
    v_cvt_pk_bf16_f32 v54, v92, v93
    v_cvt_pk_bf16_f32 v55, v94, v95
    buffer_store_dwordx4 v[52:55], v9, s[4:7], s33 offen offset:3072 sc1
    v_cvt_pk_bf16_f32 v40, v96, v97
    v_cvt_pk_bf16_f32 v41, v98, v99
    v_cvt_pk_bf16_f32 v42, v100, v101
    v_cvt_pk_bf16_f32 v43, v102, v103
    s_add_u32 s33, s33, 4096
    buffer_store_dwordx4 v[40:43], v9, s[4:7], s33 offen offset:0 sc1
    v_cvt_pk_bf16_f32 v44, v104, v105
    v_cvt_pk_bf16_f32 v45, v106, v107
    v_cvt_pk_bf16_f32 v46, v108, v109
    v_cvt_pk_bf16_f32 v47, v110, v111
    buffer_store_dwordx4 v[44:47], v9, s[4:7], s33 offen offset:1024 sc1
    v_cvt_pk_bf16_f32 v48, v112, v113
    v_cvt_pk_bf16_f32 v49, v114, v115
    v_cvt_pk_bf16_f32 v50, v116, v117
    v_cvt_pk_bf16_f32 v51, v118, v119
    buffer_store_dwordx4 v[48:51], v9, s[4:7], s33 offen offset:2048 sc1
    v_cvt_pk_bf16_f32 v52, v120, v121
    v_cvt_pk_bf16_f32 v53, v122, v123
    v_cvt_pk_bf16_f32 v54, v124, v125
    v_cvt_pk_bf16_f32 v55, v126, v127
    buffer_store_dwordx4 v[52:55], v9, s[4:7], s33 offen offset:3072 sc1
    s_add_u32 s32, s32, 1
    s_waitcnt vmcnt(0)
    v_mov_b32 v3, s32
    s_mov_b64 exec, 1
    buffer_store_dword v3, v8, s[4:7], 0 offen sc1
    s_mov_b64 exec, -1
    s_add_u32 s31, s31, 4
    s_cmp_lt_u32 s31, 64
    s_cbranch_scc1 K_LOOP
    s_endpgm
ROLE_V:
    s_load_dwordx2 s[8:9], s[0:1], 32
    s_mov_b32 s10, 0x400000
    s_mov_b32 s11, 0x20000
    s_waitcnt lgkmcnt(0)
    s_lshl_b32 s30, s21, 8
    v_lshrrev_b32 v2, 4, v0
    s_and_b32 s23, s20, 1
    s_lshl_b32 s23, s23, 2
    v_add_u32 v3, s23, v2
    v_lshlrev_b32 v3, 1, v3
    v_and_b32 v4, 15, v0
    v_xor_b32 v4, v4, v3
    v_lshlrev_b32 v4, 4, v4
    s_mov_b32 s23, 8192
    v_mul_lo_u32 v2, v2, s23
    v_add_u32 v2, v2, v4
    s_mul_i32 s24, s20, 32768
    s_add_u32 s24, s24, s30
    s_lshl_b32 s25, s20, 10
    s_mov_b32 s27, 32
DMA_6:
    s_mov_b32 m0, s25
    s_add_u32 s25, s25, 4096
    buffer_load_dwordx4 v2, s[8:11], s24 offen lds
    s_add_u32 s24, s24, 131072
    s_sub_u32 s27, s27, 1
    s_cmp_lg_u32 s27, 0
    s_cbranch_scc1 DMA_6
    v_bfe_u32 v2, v0, 2, 2
    v_lshrrev_b32 v3, 4, v0
    v_lshl_add_u32 v4, v3, 2, v2
    v_lshlrev_b32 v5, 8, v4
    v_and_b32 v4, 7, v4
    v_lshlrev_b32 v4, 1, v4
    v_and_b32 v6, 1, v0
    v_lshl_add_u32 v5, v6, 3, v5
    v_bfe_u32 v6, v0, 1, 1
    v_add_u32 v7, 0, v6
    v_xor_b32 v7, v7, v4
    v_lshl_add_u32 v16, v7, 4, v5
    v_add_u32 v24, 0x10000, v16
    v_add_u32 v7, 2, v6
    v_xor_b32 v7, v7, v4
    v_lshl_add_u32 v17, v7, 4, v5
    v_add_u32 v25, 0x10000, v17
    v_add_u32 v7, 4, v6
    v_xor_b32 v7, v7, v4
    v_lshl_add_u32 v18, v7, 4, v5
    v_add_u32 v26, 0x10000, v18
    v_add_u32 v7, 6, v6
    v_xor_b32 v7, v7, v4
    v_lshl_add_u32 v19, v7, 4, v5
    v_add_u32 v27, 0x10000, v19
    v_add_u32 v7, 8, v6
    v_xor_b32 v7, v7, v4
    v_lshl_add_u32 v20, v7, 4, v5
    v_add_u32 v28, 0x10000, v20
    v_add_u32 v7, 10, v6
    v_xor_b32 v7, v7, v4
    v_lshl_add_u32 v21, v7, 4, v5
    v_add_u32 v29, 0x10000, v21
    v_add_u32 v7, 12, v6
    v_xor_b32 v7, v7, v4
    v_lshl_add_u32 v22, v7, 4, v5
    v_add_u32 v30, 0x10000, v22
    v_add_u32 v7, 14, v6
    v_xor_b32 v7, v7, v4
    v_lshl_add_u32 v23, v7, 4, v5
    v_add_u32 v31, 0x10000, v23
    s_lshl_b32 s23, s21, 7
    s_lshl_b32 s24, s20, 2
    s_add_u32 s23, s23, s24
    s_add_u32 s23, s23, 0x2000
    v_mov_b32 v8, s23
    v_lshlrev_b32 v9, 4, v0
    s_waitcnt vmcnt(0)
    s_barrier
    s_mov_b32 s31, s20
    s_mov_b32 s32, 0
V_LOOP:
    v_and_b32 v2, 3, v0
    v_lshlrev_b32 v2, 2, v2
    s_lshl_b32 s23, s31, 4
    s_mov_b32 s24, 32768
WLN_7:
    buffer_load_dword v3, v2, s[4:7], s23 offen sc1
    s_waitcnt vmcnt(0)
    v_cmp_eq_u32 vcc, 0, v3
    s_sub_u32 s24, s24, 1
    s_cbranch_scc1 WLNE_8
    s_nop 2
    s_cbranch_vccz WLNE_8
    s_sleep 1
    s_branch WLN_7
WLNE_8:
    s_lshl_b32 s33, s31, 15
    s_add_u32 s33, s33, 0x100000
    buffer_load_dwordx4 a[0:3], v9, s[4:7], s33 offen offset:0
    buffer_load_dwordx4 a[4:7], v9, s[4:7], s33 offen offset:1024
    buffer_load_dwordx4 a[8:11], v9, s[4:7], s33 offen offset:2048
    buffer_load_dwordx4 a[12:15], v9, s[4:7], s33 offen offset:3072
    s_add_u32 s33, s33, 4096
    buffer_load_dwordx4 a[16:19], v9, s[4:7], s33 offen offset:0
    buffer_load_dwordx4 a[20:23], v9, s[4:7], s33 offen offset:1024
    buffer_load_dwordx4 a[24:27], v9, s[4:7], s33 offen offset:2048
    buffer_load_dwordx4 a[28:31], v9, s[4:7], s33 offen offset:3072
    s_add_u32 s33, s33, 4096
    buffer_load_dwordx4 a[32:35], v9, s[4:7], s33 offen offset:0
    buffer_load_dwordx4 a[36:39], v9, s[4:7], s33 offen offset:1024
    buffer_load_dwordx4 a[40:43], v9, s[4:7], s33 offen offset:2048
    buffer_load_dwordx4 a[44:47], v9, s[4:7], s33 offen offset:3072
    s_add_u32 s33, s33, 4096
    buffer_load_dwordx4 a[48:51], v9, s[4:7], s33 offen offset:0
    buffer_load_dwordx4 a[52:55], v9, s[4:7], s33 offen offset:1024
    buffer_load_dwordx4 a[56:59], v9, s[4:7], s33 offen offset:2048
    buffer_load_dwordx4 a[60:63], v9, s[4:7], s33 offen offset:3072
    s_add_u32 s33, s33, 4096
    buffer_load_dwordx4 a[64:67], v9, s[4:7], s33 offen offset:0
    buffer_load_dwordx4 a[68:71], v9, s[4:7], s33 offen offset:1024
    buffer_load_dwordx4 a[72:75], v9, s[4:7], s33 offen offset:2048
    buffer_load_dwordx4 a[76:79], v9, s[4:7], s33 offen offset:3072
    s_add_u32 s33, s33, 4096
    buffer_load_dwordx4 a[80:83], v9, s[4:7], s33 offen offset:0
    buffer_load_dwordx4 a[84:87], v9, s[4:7], s33 offen offset:1024
    buffer_load_dwordx4 a[88:91], v9, s[4:7], s33 offen offset:2048
    buffer_load_dwordx4 a[92:95], v9, s[4:7], s33 offen offset:3072
    s_add_u32 s33, s33, 4096
    buffer_load_dwordx4 a[96:99], v9, s[4:7], s33 offen offset:0
    buffer_load_dwordx4 a[100:103], v9, s[4:7], s33 offen offset:1024
    buffer_load_dwordx4 a[104:107], v9, s[4:7], s33 offen offset:2048
    buffer_load_dwordx4 a[108:111], v9, s[4:7], s33 offen offset:3072
    s_add_u32 s33, s33, 4096
    buffer_load_dwordx4 a[112:115], v9, s[4:7], s33 offen offset:0
    buffer_load_dwordx4 a[116:119], v9, s[4:7], s33 offen offset:1024
    buffer_load_dwordx4 a[120:123], v9, s[4:7], s33 offen offset:2048
    buffer_load_dwordx4 a[124:127], v9, s[4:7], s33 offen offset:3072
    s_waitcnt vmcnt(0)
    ds_read_b64_tr_b16 v[32:33], v16 offset:0
    ds_read_b64_tr_b16 v[34:35], v16 offset:4096
    ds_read_b64_tr_b16 v[36:37], v17 offset:0
    ds_read_b64_tr_b16 v[38:39], v17 offset:4096
    ds_read_b64_tr_b16 v[40:41], v18 offset:0
    ds_read_b64_tr_b16 v[42:43], v18 offset:4096
    s_waitcnt lgkmcnt(4)
    v_mfma_f32_16x16x32_bf16 v[64:67], a[0:3], v[32:35], 0
    v_mfma_f32_16x16x32_bf16 v[96:99], a[64:67], v[32:35], 0
    ds_read_b64_tr_b16 v[44:45], v19 offset:0
    ds_read_b64_tr_b16 v[46:47], v19 offset:4096
    s_waitcnt lgkmcnt(4)
    v_mfma_f32_16x16x32_bf16 v[68:71], a[0:3], v[36:39], 0
    v_mfma_f32_16x16x32_bf16 v[100:103], a[64:67], v[36:39], 0
    ds_read_b64_tr_b16 v[32:33], v20 offset:0
    ds_read_b64_tr_b16 v[34:35], v20 offset:4096
    s_waitcnt lgkmcnt(4)
    v_mfma_f32_16x16x32_bf16 v[72:75], a[0:3], v[40:43], 0
    v_mfma_f32_16x16x32_bf16 v[104:107], a[64:67], v[40:43], 0
    ds_read_b64_tr_b16 v[36:37], v21 offset:0
    ds_read_b64_tr_b16 v[38:39], v21 offset:4096
    s_waitcnt lgkmcnt(4)
    v_mfma_f32_16x16x32_bf16 v[76:79], a[0:3], v[44:47], 0
    v_mfma_f32_16x16x32_bf16 v[108:111], a[64:67], v[44:47], 0
    ds_read_b64_tr_b16 v[40:41], v22 offset:0
    ds_read_b64_tr_b16 v[42:43], v22 offset:4096
    s_waitcnt lgkmcnt(4)
    v_mfma_f32_16x16x32_bf16 v[80:83], a[0:3], v[32:35], 0
    v_mfma_f32_16x16x32_bf16 v[112:115], a[64:67], v[32:35], 0
    ds_read_b64_tr_b16 v[44:45], v23 offset:0
    ds_read_b64_tr_b16 v[46:47], v23 offset:4096
    s_waitcnt lgkmcnt(4)
    v_mfma_f32_16x16x32_bf16 v[84:87], a[0:3], v[36:39], 0
    v_mfma_f32_16x16x32_bf16 v[116:119], a[64:67], v[36:39], 0
    ds_read_b64_tr_b16 v[32:33], v16 offset:8192
    ds_read_b64_tr_b16 v[34:35], v16 offset:12288
    s_waitcnt lgkmcnt(4)
    v_mfma_f32_16x16x32_bf16 v[88:91], a[0:3], v[40:43], 0
    v_mfma_f32_16x16x32_bf16 v[120:123], a[64:67], v[40:43], 0
    ds_read_b64_tr_b16 v[36:37], v17 offset:8192
    ds_read_b64_tr_b16 v[38:39], v17 offset:12288
    s_waitcnt lgkmcnt(4)
    v_mfma_f32_16x16x32_bf16 v[92:95], a[0:3], v[44:47], 0
    v_mfma_f32_16x16x32_bf16 v[124:127], a[64:67], v[44:47], 0
    ds_read_b64_tr_b16 v[40:41], v18 offset:8192
    ds_read_b64_tr_b16 v[42:43], v18 offset:12288
    s_waitcnt lgkmcnt(4)
    v_mfma_f32_16x16x32_bf16 v[64:67], a[4:7], v[32:35], v[64:67]
    v_mfma_f32_16x16x32_bf16 v[96:99], a[68:71], v[32:35], v[96:99]
    ds_read_b64_tr_b16 v[44:45], v19 offset:8192
    ds_read_b64_tr_b16 v[46:47], v19 offset:12288
    s_waitcnt lgkmcnt(4)
    v_mfma_f32_16x16x32_bf16 v[68:71], a[4:7], v[36:39], v[68:71]
    v_mfma_f32_16x16x32_bf16 v[100:103], a[68:71], v[36:39], v[100:103]
    ds_read_b64_tr_b16 v[32:33], v20 offset:8192
    ds_read_b64_tr_b16 v[34:35], v20 offset:12288
    s_waitcnt lgkmcnt(4)
    v_mfma_f32_16x16x32_bf16 v[72:75], a[4:7], v[40:43], v[72:75]
    v_mfma_f32_16x16x32_bf16 v[104:107], a[68:71], v[40:43], v[104:107]
    ds_read_b64_tr_b16 v[36:37], v21 offset:8192
    ds_read_b64_tr_b16 v[38:39], v21 offset:12288
    s_waitcnt lgkmcnt(4)
    v_mfma_f32_16x16x32_bf16 v[76:79], a[4:7], v[44:47], v[76:79]
    v_mfma_f32_16x16x32_bf16 v[108:111], a[68:71], v[44:47], v[108:111]
    ds_read_b64_tr_b16 v[40:41], v22 offset:8192
    ds_read_b64_tr_b16 v[42:43], v22 offset:12288
    s_waitcnt lgkmcnt(4)
    v_mfma_f32_16x16x32_bf16 v[80:83], a[4:7], v[32:35], v[80:83]
    v_mfma_f32_16x16x32_bf16 v[112:115], a[68:71], v[32:35], v[112:115]
    ds_read_b64_tr_b16 v[44:45], v23 offset:8192
    ds_read_b64_tr_b16 v[46:47], v23 offset:12288
    s_waitcnt lgkmcnt(4)
    v_mfma_f32_16x16x32_bf16 v[84:87], a[4:7], v[36:39], v[84:87]
    v_mfma_f32_16x16x32_bf16 v[116:119], a[68:71], v[36:39], v[116:119]
    ds_read_b64_tr_b16 v[32:33], v16 offset:16384
    ds_read_b64_tr_b16 v[34:35], v16 offset:20480
    s_waitcnt lgkmcnt(4)
    v_mfma_f32_16x16x32_bf16 v[88:91], a[4:7], v[40:43], v[88:91]
    v_mfma_f32_16x16x32_bf16 v[120:123], a[68:71], v[40:43], v[120:123]
    ds_read_b64_tr_b16 v[36:37], v17 offset:16384
    ds_read_b64_tr_b16 v[38:39], v17 offset:20480
    s_waitcnt lgkmcnt(4)
    v_mfma_f32_16x16x32_bf16 v[92:95], a[4:7], v[44:47], v[92:95]
    v_mfma_f32_16x16x32_bf16 v[124:127], a[68:71], v[44:47], v[124:127]
    ds_read_b64_tr_b16 v[40:41], v18 offset:16384
    ds_read_b64_tr_b16 v[42:43], v18 offset:20480
    s_waitcnt lgkmcnt(4)
    v_mfma_f32_16x16x32_bf16 v[64:67], a[8:11], v[32:35], v[64:67]
    v_mfma_f32_16x16x32_bf16 v[96:99], a[72:75], v[32:35], v[96:99]
    ds_read_b64_tr_b16 v[44:45], v19 offset:16384
    ds_read_b64_tr_b16 v[46:47], v19 offset:20480
    s_waitcnt lgkmcnt(4)
    v_mfma_f32_16x16x32_bf16 v[68:71], a[8:11], v[36:39], v[68:71]
    v_mfma_f32_16x16x32_bf16 v[100:103], a[72:75], v[36:39], v[100:103]
    ds_read_b64_tr_b16 v[32:33], v20 offset:16384
    ds_read_b64_tr_b16 v[34:35], v20 offset:20480
    s_waitcnt lgkmcnt(4)
    v_mfma_f32_16x16x32_bf16 v[72:75], a[8:11], v[40:43], v[72:75]
    v_mfma_f32_16x16x32_bf16 v[104:107], a[72:75], v[40:43], v[104:107]
    ds_read_b64_tr_b16 v[36:37], v21 offset:16384
    ds_read_b64_tr_b16 v[38:39], v21 offset:20480
    s_waitcnt lgkmcnt(4)
    v_mfma_f32_16x16x32_bf16 v[76:79], a[8:11], v[44:47], v[76:79]
    v_mfma_f32_16x16x32_bf16 v[108:111], a[72:75], v[44:47], v[108:111]
    ds_read_b64_tr_b16 v[40:41], v22 offset:16384
    ds_read_b64_tr_b16 v[42:43], v22 offset:20480
    s_waitcnt lgkmcnt(4)
    v_mfma_f32_16x16x32_bf16 v[80:83], a[8:11], v[32:35], v[80:83]
    v_mfma_f32_16x16x32_bf16 v[112:115], a[72:75], v[32:35], v[112:115]
    ds_read_b64_tr_b16 v[44:45], v23 offset:16384
    ds_read_b64_tr_b16 v[46:47], v23 offset:20480
    s_waitcnt lgkmcnt(4)
    v_mfma_f32_16x16x32_bf16 v[84:87], a[8:11], v[36:39], v[84:87]
    v_mfma_f32_16x16x32_bf16 v[116:119], a[72:75], v[36:39], v[116:119]
    ds_read_b64_tr_b16 v[32:33], v16 offset:24576
    ds_read_b64_tr_b16 v[34:35], v16 offset:28672
    s_waitcnt lgkmcnt(4)
    v_mfma_f32_16x16x32_bf16 v[88:91], a[8:11], v[40:43], v[88:91]
    v_mfma_f32_16x16x32_bf16 v[120:123], a[72:75], v[40:43], v[120:123]
    ds_read_b64_tr_b16 v[36:37], v17 offset:24576
    ds_read_b64_tr_b16 v[38:39], v17 offset:28672
    s_waitcnt lgkmcnt(4)
    v_mfma_f32_16x16x32_bf16 v[92:95], a[8:11], v[44:47], v[92:95]
    v_mfma_f32_16x16x32_bf16 v[124:127], a[72:75], v[44:47], v[124:127]
    ds_read_b64_tr_b16 v[40:41], v18 offset:24576
    ds_read_b64_tr_b16 v[42:43], v18 offset:28672
    s_waitcnt lgkmcnt(4)
    v_mfma_f32_16x16x32_bf16 v[64:67], a[12:15], v[32:35], v[64:67]
    v_mfma_f32_16x16x32_bf16 v[96:99], a[76:79], v[32:35], v[96:99]
    ds_read_b64_tr_b16 v[44:45], v19 offset:24576
    ds_read_b64_tr_b16 v[46:47], v19 offset:28672
    s_waitcnt lgkmcnt(4)
    v_mfma_f32_16x16x32_bf16 v[68:71], a[12:15], v[36:39], v[68:71]
    v_mfma_f32_16x16x32_bf16 v[100:103], a[76:79], v[36:39], v[100:103]
    ds_read_b64_tr_b16 v[32:33], v20 offset:24576
    ds_read_b64_tr_b16 v[34:35], v20 offset:28672
    s_waitcnt lgkmcnt(4)
    v_mfma_f32_16x16x32_bf16 v[72:75], a[12:15], v[40:43], v[72:75]
    v_mfma_f32_16x16x32_bf16 v[104:107], a[76:79], v[40:43], v[104:107]
    ds_read_b64_tr_b16 v[36:37], v21 offset:24576
    ds_read_b64_tr_b16 v[38:39], v21 offset:28672
    s_waitcnt lgkmcnt(4)
    v_mfma_f32_16x16x32_bf16 v[76:79], a[12:15], v[44:47], v[76:79]
    v_mfma_f32_16x16x32_bf16 v[108:111], a[76:79], v[44:47], v[108:111]
    ds_read_b64_tr_b16 v[40:41], v22 offset:24576
    ds_read_b64_tr_b16 v[42:43], v22 offset:28672
    s_waitcnt lgkmcnt(4)
    v_mfma_f32_16x16x32_bf16 v[80:83], a[12:15], v[32:35], v[80:83]
    v_mfma_f32_16x16x32_bf16 v[112:115], a[76:79], v[32:35], v[112:115]
    ds_read_b64_tr_b16 v[44:45], v23 offset:24576
    ds_read_b64_tr_b16 v[46:47], v23 offset:28672
    s_waitcnt lgkmcnt(4)
    v_mfma_f32_16x16x32_bf16 v[84:87], a[12:15], v[36:39], v[84:87]
    v_mfma_f32_16x16x32_bf16 v[116:119], a[76:79], v[36:39], v[116:119]
    ds_read_b64_tr_b16 v[32:33], v16 offset:32768
    ds_read_b64_tr_b16 v[34:35], v16 offset:36864
    s_waitcnt lgkmcnt(4)
    v_mfma_f32_16x16x32_bf16 v[88:91], a[12:15], v[40:43], v[88:91]
    v_mfma_f32_16x16x32_bf16 v[120:123], a[76:79], v[40:43], v[120:123]
    ds_read_b64_tr_b16 v[36:37], v17 offset:32768
    ds_read_b64_tr_b16 v[38:39], v17 offset:36864
    s_waitcnt lgkmcnt(4)
    v_mfma_f32_16x16x32_bf16 v[92:95], a[12:15], v[44:47], v[92:95]
    v_mfma_f32_16x16x32_bf16 v[124:127], a[76:79], v[44:47], v[124:127]
    ds_read_b64_tr_b16 v[40:41], v18 offset:32768
    ds_read_b64_tr_b16 v[42:43], v18 offset:36864
    s_waitcnt lgkmcnt(4)
    v_mfma_f32_16x16x32_bf16 v[64:67], a[16:19], v[32:35], v[64:67]
    v_mfma_f32_16x16x32_bf16 v[96:99], a[80:83], v[32:35], v[96:99]
    ds_read_b64_tr_b16 v[44:45], v19 offset:32768
    ds_read_b64_tr_b16 v[46:47], v19 offset:36864
    s_waitcnt lgkmcnt(4)
    v_mfma_f32_16x16x32_bf16 v[68:71], a[16:19], v[36:39], v[68:71]
    v_mfma_f32_16x16x32_bf16 v[100:103], a[80:83], v[36:39], v[100:103]
    ds_read_b64_tr_b16 v[32:33], v20 offset:32768
    ds_read_b64_tr_b16 v[34:35], v20 offset:36864
    s_waitcnt lgkmcnt(4)
    v_mfma_f32_16x16x32_bf16 v[72:75], a[16:19], v[40:43], v[72:75]
    v_mfma_f32_16x16x32_bf16 v[104:107], a[80:83], v[40:43], v[104:107]
    ds_read_b64_tr_b16 v[36:37], v21 offset:32768
    ds_read_b64_tr_b16 v[38:39], v21 offset:36864
    s_waitcnt lgkmcnt(4)
    v_mfma_f32_16x16x32_bf16 v[76:79], a[16:19], v[44:47], v[76:79]
    v_mfma_f32_16x16x32_bf16 v[108:111], a[80:83], v[44:47], v[108:111]
    ds_read_b64_tr_b16 v[40:41], v22 offset:32768
    ds_read_b64_tr_b16 v[42:43], v22 offset:36864
    s_waitcnt lgkmcnt(4)
    v_mfma_f32_16x16x32_bf16 v[80:83], a[16:19], v[32:35], v[80:83]
    v_mfma_f32_16x16x32_bf16 v[112:115], a[80:83], v[32:35], v[112:115]
    ds_read_b64_tr_b16 v[44:45], v23 offset:32768
    ds_read_b64_tr_b16 v[46:47], v23 offset:36864
    s_waitcnt lgkmcnt(4)
    v_mfma_f32_16x16x32_bf16 v[84:87], a[16:19], v[36:39], v[84:87]
    v_mfma_f32_16x16x32_bf16 v[116:119], a[80:83], v[36:39], v[116:119]
    ds_read_b64_tr_b16 v[32:33], v16 offset:40960
    ds_read_b64_tr_b16 v[34:35], v16 offset:45056
    s_waitcnt lgkmcnt(4)
    v_mfma_f32_16x16x32_bf16 v[88:91], a[16:19], v[40:43], v[88:91]
    v_mfma_f32_16x16x32_bf16 v[120:123], a[80:83], v[40:43], v[120:123]
    ds_read_b64_tr_b16 v[36:37], v17 offset:40960
    ds_read_b64_tr_b16 v[38:39], v17 offset:45056
    s_waitcnt lgkmcnt(4)
    v_mfma_f32_16x16x32_bf16 v[92:95], a[16:19], v[44:47], v[92:95]
    v_mfma_f32_16x16x32_bf16 v[124:127], a[80:83], v[44:47], v[124:127]
    ds_read_b64_tr_b16 v[40:41], v18 offset:40960
    ds_read_b64_tr_b16 v[42:43], v18 offset:45056
    s_waitcnt lgkmcnt(4)
    v_mfma_f32_16x16x32_bf16 v[64:67], a[20:23], v[32:35], v[64:67]
    v_mfma_f32_16x16x32_bf16 v[96:99], a[84:87], v[32:35], v[96:99]
    ds_read_b64_tr_b16 v[44:45], v19 offset:40960
    ds_read_b64_tr_b16 v[46:47], v19 offset:45056
    s_waitcnt lgkmcnt(4)
    v_mfma_f32_16x16x32_bf16 v[68:71], a[20:23], v[36:39], v[68:71]
    v_mfma_f32_16x16x32_bf16 v[100:103], a[84:87], v[36:39], v[100:103]
    ds_read_b64_tr_b16 v[32:33], v20 offset:40960
    ds_read_b64_tr_b16 v[34:35], v20 offset:45056
    s_waitcnt lgkmcnt(4)
    v_mfma_f32_16x16x32_bf16 v[72:75], a[20:23], v[40:43], v[72:75]
    v_mfma_f32_16x16x32_bf16 v[104:107], a[84:87], v[40:43], v[104:107]
    ds_read_b64_tr_b16 v[36:37], v21 offset:40960
    ds_read_b64_tr_b16 v[38:39], v21 offset:45056
    s_waitcnt lgkmcnt(4)
    v_mfma_f32_16x16x32_bf16 v[76:79], a[20:23], v[44:47], v[76:79]
    v_mfma_f32_16x16x32_bf16 v[108:111], a[84:87], v[44:47], v[108:111]
    ds_read_b64_tr_b16 v[40:41], v22 offset:40960
    ds_read_b64_tr_b16 v[42:43], v22 offset:45056
    s_waitcnt lgkmcnt(4)
    v_mfma_f32_16x16x32_bf16 v[80:83], a[20:23], v[32:35], v[80:83]
    v_mfma_f32_16x16x32_bf16 v[112:115], a[84:87], v[32:35], v[112:115]
    ds_read_b64_tr_b16 v[44:45], v23 offset:40960
    ds_read_b64_tr_b16 v[46:47], v23 offset:45056
    s_waitcnt lgkmcnt(4)
    v_mfma_f32_16x16x32_bf16 v[84:87], a[20:23], v[36:39], v[84:87]
    v_mfma_f32_16x16x32_bf16 v[116:119], a[84:87], v[36:39], v[116:119]
    ds_read_b64_tr_b16 v[32:33], v16 offset:49152
    ds_read_b64_tr_b16 v[34:35], v16 offset:53248
    s_waitcnt lgkmcnt(4)
    v_mfma_f32_16x16x32_bf16 v[88:91], a[20:23], v[40:43], v[88:91]
    v_mfma_f32_16x16x32_bf16 v[120:123], a[84:87], v[40:43], v[120:123]
    ds_read_b64_tr_b16 v[36:37], v17 offset:49152
    ds_read_b64_tr_b16 v[38:39], v17 offset:53248
    s_waitcnt lgkmcnt(4)
    v_mfma_f32_16x16x32_bf16 v[92:95], a[20:23], v[44:47], v[92:95]
    v_mfma_f32_16x16x32_bf16 v[124:127], a[84:87], v[44:47], v[124:127]
    ds_read_b64_tr_b16 v[40:41], v18 offset:49152
    ds_read_b64_tr_b16 v[42:43], v18 offset:53248
    s_waitcnt lgkmcnt(4)
    v_mfma_f32_16x16x32_bf16 v[64:67], a[24:27], v[32:35], v[64:67]
    v_mfma_f32_16x16x32_bf16 v[96:99], a[88:91], v[32:35], v[96:99]
    ds_read_b64_tr_b16 v[44:45], v19 offset:49152
    ds_read_b64_tr_b16 v[46:47], v19 offset:53248
    s_waitcnt lgkmcnt(4)
    v_mfma_f32_16x16x32_bf16 v[68:71], a[24:27], v[36:39], v[68:71]
    v_mfma_f32_16x16x32_bf16 v[100:103], a[88:91], v[36:39], v[100:103]
    ds_read_b64_tr_b16 v[32:33], v20 offset:49152
    ds_read_b64_tr_b16 v[34:35], v20 offset:53248
    s_waitcnt lgkmcnt(4)
    v_mfma_f32_16x16x32_bf16 v[72:75], a[24:27], v[40:43], v[72:75]
    v_mfma_f32_16x16x32_bf16 v[104:107], a[88:91], v[40:43], v[104:107]
    ds_read_b64_tr_b16 v[36:37], v21 offset:49152
    ds_read_b64_tr_b16 v[38:39], v21 offset:53248
    s_waitcnt lgkmcnt(4)
    v_mfma_f32_16x16x32_bf16 v[76:79], a[24:27], v[44:47], v[76:79]
    v_mfma_f32_16x16x32_bf16 v[108:111], a[88:91], v[44:47], v[108:111]
    ds_read_b64_tr_b16 v[40:41], v22 offset:49152
    ds_read_b64_tr_b16 v[42:43], v22 offset:53248
    s_waitcnt lgkmcnt(4)
    v_mfma_f32_16x16x32_bf16 v[80:83], a[24:27], v[32:35], v[80:83]
    v_mfma_f32_16x16x32_bf16 v[112:115], a[88:91], v[32:35], v[112:115]
    ds_read_b64_tr_b16 v[44:45], v23 offset:49152
    ds_read_b64_tr_b16 v[46:47], v23 offset:53248
    s_waitcnt lgkmcnt(4)
    v_mfma_f32_16x16x32_bf16 v[84:87], a[24:27], v[36:39], v[84:87]
    v_mfma_f32_16x16x32_bf16 v[116:119], a[88:91], v[36:39], v[116:119]
    ds_read_b64_tr_b16 v[32:33], v16 offset:57344
    ds_read_b64_tr_b16 v[34:35], v16 offset:61440
    s_waitcnt lgkmcnt(4)
    v_mfma_f32_16x16x32_bf16 v[88:91], a[24:27], v[40:43], v[88:91]
    v_mfma_f32_16x16x32_bf16 v[120:123], a[88:91], v[40:43], v[120:123]
    ds_read_b64_tr_b16 v[36:37], v17 offset:57344
    ds_read_b64_tr_b16 v[38:39], v17 offset:61440
    s_waitcnt lgkmcnt(4)
    v_mfma_f32_16x16x32_bf16 v[92:95], a[24:27], v[44:47], v[92:95]
    v_mfma_f32_16x16x32_bf16 v[124:127], a[88:91], v[44:47], v[124:127]
    ds_read_b64_tr_b16 v[40:41], v18 offset:57344
    ds_read_b64_tr_b16 v[42:43], v18 offset:61440
    s_waitcnt lgkmcnt(4)
    v_mfma_f32_16x16x32_bf16 v[64:67], a[28:31], v[32:35], v[64:67]
    v_mfma_f32_16x16x32_bf16 v[96:99], a[92:95], v[32:35], v[96:99]
    ds_read_b64_tr_b16 v[44:45], v19 offset:57344
    ds_read_b64_tr_b16 v[46:47], v19 offset:61440
    s_waitcnt lgkmcnt(4)
    v_mfma_f32_16x16x32_bf16 v[68:71], a[28:31], v[36:39], v[68:71]
    v_mfma_f32_16x16x32_bf16 v[100:103], a[92:95], v[36:39], v[100:103]
    ds_read_b64_tr_b16 v[32:33], v20 offset:57344
    ds_read_b64_tr_b16 v[34:35], v20 offset:61440
    s_waitcnt lgkmcnt(4)
    v_mfma_f32_16x16x32_bf16 v[72:75], a[28:31], v[40:43], v[72:75]
    v_mfma_f32_16x16x32_bf16 v[104:107], a[92:95], v[40:43], v[104:107]
    ds_read_b64_tr_b16 v[36:37], v21 offset:57344
    ds_read_b64_tr_b16 v[38:39], v21 offset:61440
    s_waitcnt lgkmcnt(4)
    v_mfma_f32_16x16x32_bf16 v[76:79], a[28:31], v[44:47], v[76:79]
    v_mfma_f32_16x16x32_bf16 v[108:111], a[92:95], v[44:47], v[108:111]
    ds_read_b64_tr_b16 v[40:41], v22 offset:57344
    ds_read_b64_tr_b16 v[42:43], v22 offset:61440
    s_waitcnt lgkmcnt(4)
    v_mfma_f32_16x16x32_bf16 v[80:83], a[28:31], v[32:35], v[80:83]
    v_mfma_f32_16x16x32_bf16 v[112:115], a[92:95], v[32:35], v[112:115]
    ds_read_b64_tr_b16 v[44:45], v23 offset:57344
    ds_read_b64_tr_b16 v[46:47], v23 offset:61440
    s_waitcnt lgkmcnt(4)
    v_mfma_f32_16x16x32_bf16 v[84:87], a[28:31], v[36:39], v[84:87]
    v_mfma_f32_16x16x32_bf16 v[116:119], a[92:95], v[36:39], v[116:119]
    ds_read_b64_tr_b16 v[32:33], v24 offset:0
    ds_read_b64_tr_b16 v[34:35], v24 offset:4096
    s_waitcnt lgkmcnt(4)
    v_mfma_f32_16x16x32_bf16 v[88:91], a[28:31], v[40:43], v[88:91]
    v_mfma_f32_16x16x32_bf16 v[120:123], a[92:95], v[40:43], v[120:123]
    ds_read_b64_tr_b16 v[36:37], v25 offset:0
    ds_read_b64_tr_b16 v[38:39], v25 offset:4096
    s_waitcnt lgkmcnt(4)
    v_mfma_f32_16x16x32_bf16 v[92:95], a[28:31], v[44:47], v[92:95]
    v_mfma_f32_16x16x32_bf16 v[124:127], a[92:95], v[44:47], v[124:127]
    ds_read_b64_tr_b16 v[40:41], v26 offset:0
    ds_read_b64_tr_b16 v[42:43], v26 offset:4096
    s_waitcnt lgkmcnt(4)
    v_mfma_f32_16x16x32_bf16 v[64:67], a[32:35], v[32:35], v[64:67]
    v_mfma_f32_16x16x32_bf16 v[96:99], a[96:99], v[32:35], v[96:99]
    ds_read_b64_tr_b16 v[44:45], v27 offset:0
    ds_read_b64_tr_b16 v[46:47], v27 offset:4096
    s_waitcnt lgkmcnt(4)
    v_mfma_f32_16x16x32_bf16 v[68:71], a[32:35], v[36:39], v[68:71]
    v_mfma_f32_16x16x32_bf16 v[100:103], a[96:99], v[36:39], v[100:103]
    ds_read_b64_tr_b16 v[32:33], v28 offset:0
    ds_read_b64_tr_b16 v[34:35], v28 offset:4096
    s_waitcnt lgkmcnt(4)
    v_mfma_f32_16x16x32_bf16 v[72:75], a[32:35], v[40:43], v[72:75]
    v_mfma_f32_16x16x32_bf16 v[104:107], a[96:99], v[40:43], v[104:107]
    ds_read_b64_tr_b16 v[36:37], v29 offset:0
    ds_read_b64_tr_b16 v[38:39], v29 offset:4096
    s_waitcnt lgkmcnt(4)
    v_mfma_f32_16x16x32_bf16 v[76:79], a[32:35], v[44:47], v[76:79]
    v_mfma_f32_16x16x32_bf16 v[108:111], a[96:99], v[44:47], v[108:111]
    ds_read_b64_tr_b16 v[40:41], v30 offset:0
    ds_read_b64_tr_b16 v[42:43], v30 offset:4096
    s_waitcnt lgkmcnt(4)
    v_mfma_f32_16x16x32_bf16 v[80:83], a[32:35], v[32:35], v[80:83]
    v_mfma_f32_16x16x32_bf16 v[112:115], a[96:99], v[32:35], v[112:115]
    ds_read_b64_tr_b16 v[44:45], v31 offset:0
    ds_read_b64_tr_b16 v[46:47], v31 offset:4096
    s_waitcnt lgkmcnt(4)
    v_mfma_f32_16x16x32_bf16 v[84:87], a[32:35], v[36:39], v[84:87]
    v_mfma_f32_16x16x32_bf16 v[116:119], a[96:99], v[36:39], v[116:119]
    ds_read_b64_tr_b16 v[32:33], v24 offset:8192
    ds_read_b64_tr_b16 v[34:35], v24 offset:12288
    s_waitcnt lgkmcnt(4)
    v_mfma_f32_16x16x32_bf16 v[88:91], a[32:35], v[40:43], v[88:91]
    v_mfma_f32_16x16x32_bf16 v[120:123], a[96:99], v[40:43], v[120:123]
    ds_read_b64_tr_b16 v[36:37], v25 offset:8192
    ds_read_b64_tr_b16 v[38:39], v25 offset:12288
    s_waitcnt lgkmcnt(4)
    v_mfma_f32_16x16x32_bf16 v[92:95], a[32:35], v[44:47], v[92:95]
    v_mfma_f32_16x16x32_bf16 v[124:127], a[96:99], v[44:47], v[124:127]
    ds_read_b64_tr_b16 v[40:41], v26 offset:8192
    ds_read_b64_tr_b16 v[42:43], v26 offset:12288
    s_waitcnt lgkmcnt(4)
    v_mfma_f32_16x16x32_bf16 v[64:67], a[36:39], v[32:35], v[64:67]
    v_mfma_f32_16x16x32_bf16 v[96:99], a[100:103], v[32:35], v[96:99]
    ds_read_b64_tr_b16 v[44:45], v27 offset:8192
    ds_read_b64_tr_b16 v[46:47], v27 offset:12288
    s_waitcnt lgkmcnt(4)
    v_mfma_f32_16x16x32_bf16 v[68:71], a[36:39], v[36:39], v[68:71]
    v_mfma_f32_16x16x32_bf16 v[100:103], a[100:103], v[36:39], v[100:103]
    ds_read_b64_tr_b16 v[32:33], v28 offset:8192
    ds_read_b64_tr_b16 v[34:35], v28 offset:12288
    s_waitcnt lgkmcnt(4)
    v_mfma_f32_16x16x32_bf16 v[72:75], a[36:39], v[40:43], v[72:75]
    v_mfma_f32_16x16x32_bf16 v[104:107], a[100:103], v[40:43], v[104:107]
    ds_read_b64_tr_b16 v[36:37], v29 offset:8192
    ds_read_b64_tr_b16 v[38:39], v29 offset:12288
    s_waitcnt lgkmcnt(4)
    v_mfma_f32_16x16x32_bf16 v[76:79], a[36:39], v[44:47], v[76:79]
    v_mfma_f32_16x16x32_bf16 v[108:111], a[100:103], v[44:47], v[108:111]
    ds_read_b64_tr_b16 v[40:41], v30 offset:8192
    ds_read_b64_tr_b16 v[42:43], v30 offset:12288
    s_waitcnt lgkmcnt(4)
    v_mfma_f32_16x16x32_bf16 v[80:83], a[36:39], v[32:35], v[80:83]
    v_mfma_f32_16x16x32_bf16 v[112:115], a[100:103], v[32:35], v[112:115]
    ds_read_b64_tr_b16 v[44:45], v31 offset:8192
    ds_read_b64_tr_b16 v[46:47], v31 offset:12288
    s_waitcnt lgkmcnt(4)
    v_mfma_f32_16x16x32_bf16 v[84:87], a[36:39], v[36:39], v[84:87]
    v_mfma_f32_16x16x32_bf16 v[116:119], a[100:103], v[36:39], v[116:119]
    ds_read_b64_tr_b16 v[32:33], v24 offset:16384
    ds_read_b64_tr_b16 v[34:35], v24 offset:20480
    s_waitcnt lgkmcnt(4)
    v_mfma_f32_16x16x32_bf16 v[88:91], a[36:39], v[40:43], v[88:91]
    v_mfma_f32_16x16x32_bf16 v[120:123], a[100:103], v[40:43], v[120:123]
    ds_read_b64_tr_b16 v[36:37], v25 offset:16384
    ds_read_b64_tr_b16 v[38:39], v25 offset:20480
    s_waitcnt lgkmcnt(4)
    v_mfma_f32_16x16x32_bf16 v[92:95], a[36:39], v[44:47], v[92:95]
    v_mfma_f32_16x16x32_bf16 v[124:127], a[100:103], v[44:47], v[124:127]
    ds_read_b64_tr_b16 v[40:41], v26 offset:16384
    ds_read_b64_tr_b16 v[42:43], v26 offset:20480
    s_waitcnt lgkmcnt(4)
    v_mfma_f32_16x16x32_bf16 v[64:67], a[40:43], v[32:35], v[64:67]
    v_mfma_f32_16x16x32_bf16 v[96:99], a[104:107], v[32:35], v[96:99]
    ds_read_b64_tr_b16 v[44:45], v27 offset:16384
    ds_read_b64_tr_b16 v[46:47], v27 offset:20480
    s_waitcnt lgkmcnt(4)
    v_mfma_f32_16x16x32_bf16 v[68:71], a[40:43], v[36:39], v[68:71]
    v_mfma_f32_16x16x32_bf16 v[100:103], a[104:107], v[36:39], v[100:103]
    ds_read_b64_tr_b16 v[32:33], v28 offset:16384
    ds_read_b64_tr_b16 v[34:35], v28 offset:20480
    s_waitcnt lgkmcnt(4)
    v_mfma_f32_16x16x32_bf16 v[72:75], a[40:43], v[40:43], v[72:75]
    v_mfma_f32_16x16x32_bf16 v[104:107], a[104:107], v[40:43], v[104:107]
    ds_read_b64_tr_b16 v[36:37], v29 offset:16384
    ds_read_b64_tr_b16 v[38:39], v29 offset:20480
    s_waitcnt lgkmcnt(4)
    v_mfma_f32_16x16x32_bf16 v[76:79], a[40:43], v[44:47], v[76:79]
    v_mfma_f32_16x16x32_bf16 v[108:111], a[104:107], v[44:47], v[108:111]
    ds_read_b64_tr_b16 v[40:41], v30 offset:16384
    ds_read_b64_tr_b16 v[42:43], v30 offset:20480
    s_waitcnt lgkmcnt(4)
    v_mfma_f32_16x16x32_bf16 v[80:83], a[40:43], v[32:35], v[80:83]
    v_mfma_f32_16x16x32_bf16 v[112:115], a[104:107], v[32:35], v[112:115]
    ds_read_b64_tr_b16 v[44:45], v31 offset:16384
    ds_read_b64_tr_b16 v[46:47], v31 offset:20480
    s_waitcnt lgkmcnt(4)
    v_mfma_f32_16x16x32_bf16 v[84:87], a[40:43], v[36:39], v[84:87]
    v_mfma_f32_16x16x32_bf16 v[116:119], a[104:107], v[36:39], v[116:119]
    ds_read_b64_tr_b16 v[32:33], v24 offset:24576
    ds_read_b64_tr_b16 v[34:35], v24 offset:28672
    s_waitcnt lgkmcnt(4)
    v_mfma_f32_16x16x32_bf16 v[88:91], a[40:43], v[40:43], v[88:91]
    v_mfma_f32_16x16x32_bf16 v[120:123], a[104:107], v[40:43], v[120:123]
    ds_read_b64_tr_b16 v[36:37], v25 offset:24576
    ds_read_b64_tr_b16 v[38:39], v25 offset:28672
    s_waitcnt lgkmcnt(4)
    v_mfma_f32_16x16x32_bf16 v[92:95], a[40:43], v[44:47], v[92:95]
    v_mfma_f32_16x16x32_bf16 v[124:127], a[104:107], v[44:47], v[124:127]
    ds_read_b64_tr_b16 v[40:41], v26 offset:24576
    ds_read_b64_tr_b16 v[42:43], v26 offset:28672
    s_waitcnt lgkmcnt(4)
    v_mfma_f32_16x16x32_bf16 v[64:67], a[44:47], v[32:35], v[64:67]
    v_mfma_f32_16x16x32_bf16 v[96:99], a[108:111], v[32:35], v[96:99]
    ds_read_b64_tr_b16 v[44:45], v27 offset:24576
    ds_read_b64_tr_b16 v[46:47], v27 offset:28672
    s_waitcnt lgkmcnt(4)
    v_mfma_f32_16x16x32_bf16 v[68:71], a[44:47], v[36:39], v[68:71]
    v_mfma_f32_16x16x32_bf16 v[100:103], a[108:111], v[36:39], v[100:103]
    ds_read_b64_tr_b16 v[32:33], v28 offset:24576
    ds_read_b64_tr_b16 v[34:35], v28 offset:28672
    s_waitcnt lgkmcnt(4)
    v_mfma_f32_16x16x32_bf16 v[72:75], a[44:47], v[40:43], v[72:75]
    v_mfma_f32_16x16x32_bf16 v[104:107], a[108:111], v[40:43], v[104:107]
    ds_read_b64_tr_b16 v[36:37], v29 offset:24576
    ds_read_b64_tr_b16 v[38:39], v29 offset:28672
    s_waitcnt lgkmcnt(4)
    v_mfma_f32_16x16x32_bf16 v[76:79], a[44:47], v[44:47], v[76:79]
    v_mfma_f32_16x16x32_bf16 v[108:111], a[108:111], v[44:47], v[108:111]
    ds_read_b64_tr_b16 v[40:41], v30 offset:24576
    ds_read_b64_tr_b16 v[42:43], v30 offset:28672
    s_waitcnt lgkmcnt(4)
    v_mfma_f32_16x16x32_bf16 v[80:83], a[44:47], v[32:35], v[80:83]
    v_mfma_f32_16x16x32_bf16 v[112:115], a[108:111], v[32:35], v[112:115]
    ds_read_b64_tr_b16 v[44:45], v31 offset:24576
    ds_read_b64_tr_b16 v[46:47], v31 offset:28672
    s_waitcnt lgkmcnt(4)
    v_mfma_f32_16x16x32_bf16 v[84:87], a[44:47], v[36:39], v[84:87]
    v_mfma_f32_16x16x32_bf16 v[116:119], a[108:111], v[36:39], v[116:119]
    ds_read_b64_tr_b16 v[32:33], v24 offset:32768
    ds_read_b64_tr_b16 v[34:35], v24 offset:36864
    s_waitcnt lgkmcnt(4)
    v_mfma_f32_16x16x32_bf16 v[88:91], a[44:47], v[40:43], v[88:91]
    v_mfma_f32_16x16x32_bf16 v[120:123], a[108:111], v[40:43], v[120:123]
    ds_read_b64_tr_b16 v[36:37], v25 offset:32768
    ds_read_b64_tr_b16 v[38:39], v25 offset:36864
    s_waitcnt lgkmcnt(4)
    v_mfma_f32_16x16x32_bf16 v[92:95], a[44:47], v[44:47], v[92:95]
    v_mfma_f32_16x16x32_bf16 v[124:127], a[108:111], v[44:47], v[124:127]
    ds_read_b64_tr_b16 v[40:41], v26 offset:32768
    ds_read_b64_tr_b16 v[42:43], v26 offset:36864
    s_waitcnt lgkmcnt(4)
    v_mfma_f32_16x16x32_bf16 v[64:67], a[48:51], v[32:35], v[64:67]
    v_mfma_f32_16x16x32_bf16 v[96:99], a[112:115], v[32:35], v[96:99]
    ds_read_b64_tr_b16 v[44:45], v27 offset:32768
    ds_read_b64_tr_b16 v[46:47], v27 offset:36864
    s_waitcnt lgkmcnt(4)
    v_mfma_f32_16x16x32_bf16 v[68:71], a[48:51], v[36:39], v[68:71]
    v_mfma_f32_16x16x32_bf16 v[100:103], a[112:115], v[36:39], v[100:103]
    ds_read_b64_tr_b16 v[32:33], v28 offset:32768
    ds_read_b64_tr_b16 v[34:35], v28 offset:36864
    s_waitcnt lgkmcnt(4)
    v_mfma_f32_16x16x32_bf16 v[72:75], a[48:51], v[40:43], v[72:75]
    v_mfma_f32_16x16x32_bf16 v[104:107], a[112:115], v[40:43], v[104:107]
    ds_read_b64_tr_b16 v[36:37], v29 offset:32768
    ds_read_b64_tr_b16 v[38:39], v29 offset:36864
    s_waitcnt lgkmcnt(4)
    v_mfma_f32_16x16x32_bf16 v[76:79], a[48:51], v[44:47], v[76:79]
    v_mfma_f32_16x16x32_bf16 v[108:111], a[112:115], v[44:47], v[108:111]
    ds_read_b64_tr_b16 v[40:41], v30 offset:32768
    ds_read_b64_tr_b16 v[42:43], v30 offset:36864
    s_waitcnt lgkmcnt(4)
    v_mfma_f32_16x16x32_bf16 v[80:83], a[48:51], v[32:35], v[80:83]
    v_mfma_f32_16x16x32_bf16 v[112:115], a[112:115], v[32:35], v[112:115]
    ds_read_b64_tr_b16 v[44:45], v31 offset:32768
    ds_read_b64_tr_b16 v[46:47], v31 offset:36864
    s_waitcnt lgkmcnt(4)
    v_mfma_f32_16x16x32_bf16 v[84:87], a[48:51], v[36:39], v[84:87]
    v_mfma_f32_16x16x32_bf16 v[116:119], a[112:115], v[36:39], v[116:119]
    ds_read_b64_tr_b16 v[32:33], v24 offset:40960
    ds_read_b64_tr_b16 v[34:35], v24 offset:45056
    s_waitcnt lgkmcnt(4)
    v_mfma_f32_16x16x32_bf16 v[88:91], a[48:51], v[40:43], v[88:91]
    v_mfma_f32_16x16x32_bf16 v[120:123], a[112:115], v[40:43], v[120:123]
    ds_read_b64_tr_b16 v[36:37], v25 offset:40960
    ds_read_b64_tr_b16 v[38:39], v25 offset:45056
    s_waitcnt lgkmcnt(4)
    v_mfma_f32_16x16x32_bf16 v[92:95], a[48:51], v[44:47], v[92:95]
    v_mfma_f32_16x16x32_bf16 v[124:127], a[112:115], v[44:47], v[124:127]
    ds_read_b64_tr_b16 v[40:41], v26 offset:40960
    ds_read_b64_tr_b16 v[42:43], v26 offset:45056
    s_waitcnt lgkmcnt(4)
    v_mfma_f32_16x16x32_bf16 v[64:67], a[52:55], v[32:35], v[64:67]
    v_mfma_f32_16x16x32_bf16 v[96:99], a[116:119], v[32:35], v[96:99]
    ds_read_b64_tr_b16 v[44:45], v27 offset:40960
    ds_read_b64_tr_b16 v[46:47], v27 offset:45056
    s_waitcnt lgkmcnt(4)
    v_mfma_f32_16x16x32_bf16 v[68:71], a[52:55], v[36:39], v[68:71]
    v_mfma_f32_16x16x32_bf16 v[100:103], a[116:119], v[36:39], v[100:103]
    ds_read_b64_tr_b16 v[32:33], v28 offset:40960
    ds_read_b64_tr_b16 v[34:35], v28 offset:45056
    s_waitcnt lgkmcnt(4)
    v_mfma_f32_16x16x32_bf16 v[72:75], a[52:55], v[40:43], v[72:75]
    v_mfma_f32_16x16x32_bf16 v[104:107], a[116:119], v[40:43], v[104:107]
    ds_read_b64_tr_b16 v[36:37], v29 offset:40960
    ds_read_b64_tr_b16 v[38:39], v29 offset:45056
    s_waitcnt lgkmcnt(4)
    v_mfma_f32_16x16x32_bf16 v[76:79], a[52:55], v[44:47], v[76:79]
    v_mfma_f32_16x16x32_bf16 v[108:111], a[116:119], v[44:47], v[108:111]
    ds_read_b64_tr_b16 v[40:41], v30 offset:40960
    ds_read_b64_tr_b16 v[42:43], v30 offset:45056
    s_waitcnt lgkmcnt(4)
    v_mfma_f32_16x16x32_bf16 v[80:83], a[52:55], v[32:35], v[80:83]
    v_mfma_f32_16x16x32_bf16 v[112:115], a[116:119], v[32:35], v[112:115]
    ds_read_b64_tr_b16 v[44:45], v31 offset:40960
    ds_read_b64_tr_b16 v[46:47], v31 offset:45056
    s_waitcnt lgkmcnt(4)
    v_mfma_f32_16x16x32_bf16 v[84:87], a[52:55], v[36:39], v[84:87]
    v_mfma_f32_16x16x32_bf16 v[116:119], a[116:119], v[36:39], v[116:119]
    ds_read_b64_tr_b16 v[32:33], v24 offset:49152
    ds_read_b64_tr_b16 v[34:35], v24 offset:53248
    s_waitcnt lgkmcnt(4)
    v_mfma_f32_16x16x32_bf16 v[88:91], a[52:55], v[40:43], v[88:91]
    v_mfma_f32_16x16x32_bf16 v[120:123], a[116:119], v[40:43], v[120:123]
    ds_read_b64_tr_b16 v[36:37], v25 offset:49152
    ds_read_b64_tr_b16 v[38:39], v25 offset:53248
    s_waitcnt lgkmcnt(4)
    v_mfma_f32_16x16x32_bf16 v[92:95], a[52:55], v[44:47], v[92:95]
    v_mfma_f32_16x16x32_bf16 v[124:127], a[116:119], v[44:47], v[124:127]
    ds_read_b64_tr_b16 v[40:41], v26 offset:49152
    ds_read_b64_tr_b16 v[42:43], v26 offset:53248
    s_waitcnt lgkmcnt(4)
    v_mfma_f32_16x16x32_bf16 v[64:67], a[56:59], v[32:35], v[64:67]
    v_mfma_f32_16x16x32_bf16 v[96:99], a[120:123], v[32:35], v[96:99]
    ds_read_b64_tr_b16 v[44:45], v27 offset:49152
    ds_read_b64_tr_b16 v[46:47], v27 offset:53248
    s_waitcnt lgkmcnt(4)
    v_mfma_f32_16x16x32_bf16 v[68:71], a[56:59], v[36:39], v[68:71]
    v_mfma_f32_16x16x32_bf16 v[100:103], a[120:123], v[36:39], v[100:103]
    ds_read_b64_tr_b16 v[32:33], v28 offset:49152
    ds_read_b64_tr_b16 v[34:35], v28 offset:53248
    s_waitcnt lgkmcnt(4)
    v_mfma_f32_16x16x32_bf16 v[72:75], a[56:59], v[40:43], v[72:75]
    v_mfma_f32_16x16x32_bf16 v[104:107], a[120:123], v[40:43], v[104:107]
    ds_read_b64_tr_b16 v[36:37], v29 offset:49152
    ds_read_b64_tr_b16 v[38:39], v29 offset:53248
    s_waitcnt lgkmcnt(4)
    v_mfma_f32_16x16x32_bf16 v[76:79], a[56:59], v[44:47], v[76:79]
    v_mfma_f32_16x16x32_bf16 v[108:111], a[120:123], v[44:47], v[108:111]
    ds_read_b64_tr_b16 v[40:41], v30 offset:49152
    ds_read_b64_tr_b16 v[42:43], v30 offset:53248
    s_waitcnt lgkmcnt(4)
    v_mfma_f32_16x16x32_bf16 v[80:83], a[56:59], v[32:35], v[80:83]
    v_mfma_f32_16x16x32_bf16 v[112:115], a[120:123], v[32:35], v[112:115]
    ds_read_b64_tr_b16 v[44:45], v31 offset:49152
    ds_read_b64_tr_b16 v[46:47], v31 offset:53248
    s_waitcnt lgkmcnt(4)
    v_mfma_f32_16x16x32_bf16 v[84:87], a[56:59], v[36:39], v[84:87]
    v_mfma_f32_16x16x32_bf16 v[116:119], a[120:123], v[36:39], v[116:119]
    ds_read_b64_tr_b16 v[32:33], v24 offset:57344
    ds_read_b64_tr_b16 v[34:35], v24 offset:61440
    s_waitcnt lgkmcnt(4)
    v_mfma_f32_16x16x32_bf16 v[88:91], a[56:59], v[40:43], v[88:91]
    v_mfma_f32_16x16x32_bf16 v[120:123], a[120:123], v[40:43], v[120:123]
    ds_read_b64_tr_b16 v[36:37], v25 offset:57344
    ds_read_b64_tr_b16 v[38:39], v25 offset:61440
    s_waitcnt lgkmcnt(4)
    v_mfma_f32_16x16x32_bf16 v[92:95], a[56:59], v[44:47], v[92:95]
    v_mfma_f32_16x16x32_bf16 v[124:127], a[120:123], v[44:47], v[124:127]
    ds_read_b64_tr_b16 v[40:41], v26 offset:57344
    ds_read_b64_tr_b16 v[42:43], v26 offset:61440
    s_waitcnt lgkmcnt(4)
    v_mfma_f32_16x16x32_bf16 v[64:67], a[60:63], v[32:35], v[64:67]
    v_mfma_f32_16x16x32_bf16 v[96:99], a[124:127], v[32:35], v[96:99]
    ds_read_b64_tr_b16 v[44:45], v27 offset:57344
    ds_read_b64_tr_b16 v[46:47], v27 offset:61440
    s_waitcnt lgkmcnt(4)
    v_mfma_f32_16x16x32_bf16 v[68:71], a[60:63], v[36:39], v[68:71]
    v_mfma_f32_16x16x32_bf16 v[100:103], a[124:127], v[36:39], v[100:103]
    ds_read_b64_tr_b16 v[32:33], v28 offset:57344
    ds_read_b64_tr_b16 v[34:35], v28 offset:61440
    s_waitcnt lgkmcnt(4)
    v_mfma_f32_16x16x32_bf16 v[72:75], a[60:63], v[40:43], v[72:75]
    v_mfma_f32_16x16x32_bf16 v[104:107], a[124:127], v[40:43], v[104:107]
    ds_read_b64_tr_b16 v[36:37], v29 offset:57344
    ds_read_b64_tr_b16 v[38:39], v29 offset:61440
    s_waitcnt lgkmcnt(4)
    v_mfma_f32_16x16x32_bf16 v[76:79], a[60:63], v[44:47], v[76:79]
    v_mfma_f32_16x16x32_bf16 v[108:111], a[124:127], v[44:47], v[108:111]
    ds_read_b64_tr_b16 v[40:41], v30 offset:57344
    ds_read_b64_tr_b16 v[42:43], v30 offset:61440
    s_waitcnt lgkmcnt(4)
    v_mfma_f32_16x16x32_bf16 v[80:83], a[60:63], v[32:35], v[80:83]
    v_mfma_f32_16x16x32_bf16 v[112:115], a[124:127], v[32:35], v[112:115]
    ds_read_b64_tr_b16 v[44:45], v31 offset:57344
    ds_read_b64_tr_b16 v[46:47], v31 offset:61440
    s_waitcnt lgkmcnt(4)
    v_mfma_f32_16x16x32_bf16 v[84:87], a[60:63], v[36:39], v[84:87]
    v_mfma_f32_16x16x32_bf16 v[116:119], a[124:127], v[36:39], v[116:119]
    s_waitcnt lgkmcnt(2)
    v_mfma_f32_16x16x32_bf16 v[88:91], a[60:63], v[40:43], v[88:91]
    v_mfma_f32_16x16x32_bf16 v[120:123], a[124:127], v[40:43], v[120:123]
    s_waitcnt lgkmcnt(0)
    v_mfma_f32_16x16x32_bf16 v[92:95], a[60:63], v[44:47], v[92:95]
    v_mfma_f32_16x16x32_bf16 v[124:127], a[124:127], v[44:47], v[124:127]
    s_lshl_b32 s33, s31, 18
    s_lshl_b32 s34, s21, 13
    s_add_u32 s33, s33, s34
    s_add_u32 s33, s33, 0x2000000
    v_cvt_pk_bf16_f32 v40, v64, v65
    v_cvt_pk_bf16_f32 v41, v66, v67
    v_cvt_pk_bf16_f32 v42, v96, v97
    v_cvt_pk_bf16_f32 v43, v98, v99
    buffer_store_dwordx4 v[40:43], v9, s[4:7], s33 offen offset:0 sc1
    v_cvt_pk_bf16_f32 v44, v68, v69
    v_cvt_pk_bf16_f32 v45, v70, v71
    v_cvt_pk_bf16_f32 v46, v100, v101
    v_cvt_pk_bf16_f32 v47, v102, v103
    buffer_store_dwordx4 v[44:47], v9, s[4:7], s33 offen offset:1024 sc1
    v_cvt_pk_bf16_f32 v48, v72, v73
    v_cvt_pk_bf16_f32 v49, v74, v75
    v_cvt_pk_bf16_f32 v50, v104, v105
    v_cvt_pk_bf16_f32 v51, v106, v107
    buffer_store_dwordx4 v[48:51], v9, s[4:7], s33 offen offset:2048 sc1
    v_cvt_pk_bf16_f32 v52, v76, v77
    v_cvt_pk_bf16_f32 v53, v78, v79
    v_cvt_pk_bf16_f32 v54, v108, v109
    v_cvt_pk_bf16_f32 v55, v110, v111
    buffer_store_dwordx4 v[52:55], v9, s[4:7], s33 offen offset:3072 sc1
    v_cvt_pk_bf16_f32 v40, v80, v81
    v_cvt_pk_bf16_f32 v41, v82, v83
    v_cvt_pk_bf16_f32 v42, v112, v113
    v_cvt_pk_bf16_f32 v43, v114, v115
    s_add_u32 s33, s33, 4096
    buffer_store_dwordx4 v[40:43], v9, s[4:7], s33 offen offset:0 sc1
    v_cvt_pk_bf16_f32 v44, v84, v85
    v_cvt_pk_bf16_f32 v45, v86, v87
    v_cvt_pk_bf16_f32 v46, v116, v117
    v_cvt_pk_bf16_f32 v47, v118, v119
    buffer_store_dwordx4 v[44:47], v9, s[4:7], s33 offen offset:1024 sc1
    v_cvt_pk_bf16_f32 v48, v88, v89
    v_cvt_pk_bf16_f32 v49, v90, v91
    v_cvt_pk_bf16_f32 v50, v120, v121
    v_cvt_pk_bf16_f32 v51, v122, v123
    buffer_store_dwordx4 v[48:51], v9, s[4:7], s33 offen offset:2048 sc1
    v_cvt_pk_bf16_f32 v52, v92, v93
    v_cvt_pk_bf16_f32 v53, v94, v95
    v_cvt_pk_bf16_f32 v54, v124, v125
    v_cvt_pk_bf16_f32 v55, v126, v127
    buffer_store_dwordx4 v[52:55], v9, s[4:7], s33 offen offset:3072 sc1
    s_add_u32 s32, s32, 1
    s_waitcnt vmcnt(0)
    v_mov_b32 v3, s32
    s_mov_b64 exec, 1
    buffer_store_dword v3, v8, s[4:7], 0 offen sc1
    s_mov_b64 exec, -1
    s_add_u32 s31, s31, 4
    s_cmp_lt_u32 s31, 64
    s_cbranch_scc1 V_LOOP
    s_endpgm
ROLE_CHAIN:
    s_load_dwordx2 s[8:9], s[0:1], 16
    s_mov_b32 s10, 0x400000
    s_mov_b32 s11, 0x20000
    s_load_dwordx2 s[12:13], s[0:1], 24
    s_mov_b32 s14, 0x400000
    s_mov_b32 s15, 0x20000
    s_load_dwordx2 s[52:53], s[0:1], 32
    s_mov_b32 s54, 0x400000
    s_mov_b32 s55, 0x20000
    s_load_dwordx2 s[56:57], s[0:1], 40
    s_mov_b32 s58, 0x400000
    s_mov_b32 s59, 0x20000
    s_load_dwordx2 s[60:61], s[0:1], 8
    s_mov_b32 s62, 0x2000
    s_mov_b32 s63, 0x20000
    v_lshrrev_b32 v2, 4, v0
    v_and_b32 v3, 1, v2
    v_lshlrev_b32 v3, 1, v3
    v_and_b32 v4, 15, v0
    v_xor_b32 v4, v4, v3
    v_lshlrev_b32 v4, 4, v4
    v_lshl_add_u32 v40, v2, 13, v4
    v_xor_b32 v41, 64, v40
    v_xor_b32 v42, 128, v40
    v_xor_b32 v43, 192, v40
    s_and_b32 s23, s20, 1
    s_lshl_b32 s23, s23, 2
    v_xor_b32 v4, s23, v0
    v_lshlrev_b32 v44, 4, v4
    v_xor_b32 v45, 128, v44
    s_waitcnt lgkmcnt(0)
    s_lshl_b32 s30, s21, 8
    s_lshl_b32 s31, s20, 15
    s_add_u32 s30, s30, s31
    s_lshl_b32 s31, s21, 17
    s_lshl_b32 s32, s20, 10
    s_add_u32 s31, s31, s32
    s_lshl_b32 s23, s20, 6
    v_add_u32 v104, s23, v0
    v_and_b32 v105, 7, v104
    v_lshlrev_b32 v105, 10, v105
    v_bfe_u32 v106, v104, 3, 2
    v_lshl_add_u32 v105, v106, 3, v105
    v_lshrrev_b32 v106, 5, v104
    v_lshl_add_u32 v105, v106, 6, v105
    buffer_load_dwordx2 v[108:109], v105, s[60:63], 0 offen
    buffer_load_dwordx2 v[110:111], v105, s[60:63], 0 offen offset:32
    buffer_load_dwordx2 v[112:113], v105, s[60:63], 0 offen offset:512
    buffer_load_dwordx2 v[114:115], v105, s[60:63], 0 offen offset:544
    v_lshlrev_b32 v107, 4, v104
    v_add_u32 v107, 0x20000, v107
    s_cmp_eq_u32 s66, 0
    s_cbranch_scc1 CH_DMA
    s_cmp_eq_u32 s20, 0
    s_cbranch_scc1 CH_W0
    s_lshl_b32 s33, s20, 10
    s_add_u32 s34, s30, 0
    s_mov_b32 m0, s33
    s_add_u32 s33, s33, 4096
    buffer_load_dwordx4 v40, s[8:11], s34 offen lds
    s_add_u32 s34, s34, 131072
    s_mov_b32 m0, s33
    s_add_u32 s33, s33, 4096
    buffer_load_dwordx4 v41, s[8:11], s34 offen lds
    s_add_u32 s34, s34, 131072
    s_mov_b32 m0, s33
    s_add_u32 s33, s33, 4096
    buffer_load_dwordx4 v42, s[8:11], s34 offen lds
    s_add_u32 s34, s34, 131072
    s_mov_b32 m0, s33
    s_add_u32 s33, s33, 4096
    buffer_load_dwordx4 v43, s[8:11], s34 offen lds
    s_add_u32 s34, s34, 131072
    s_mov_b32 m0, s33
    s_add_u32 s33, s33, 4096
    buffer_load_dwordx4 v40, s[8:11], s34 offen lds
    s_add_u32 s34, s34, 131072
    s_mov_b32 m0, s33
    s_add_u32 s33, s33, 4096
    buffer_load_dwordx4 v41, s[8:11], s34 offen lds
    s_add_u32 s34, s34, 131072
    s_mov_b32 m0, s33
    s_add_u32 s33, s33, 4096
    buffer_load_dwordx4 v42, s[8:11], s34 offen lds
    s_add_u32 s34, s34, 131072
    s_mov_b32 m0, s33
    s_add_u32 s33, s33, 4096
    buffer_load_dwordx4 v43, s[8:11], s34 offen lds
    s_add_u32 s34, s34, 131072
    s_mov_b32 m0, s33
    s_add_u32 s33, s33, 4096
    buffer_load_dwordx4 v40, s[8:11], s34 offen lds
    s_add_u32 s34, s34, 131072
    s_mov_b32 m0, s33
    s_add_u32 s33, s33, 4096
    buffer_load_dwordx4 v41, s[8:11], s34 offen lds
    s_add_u32 s34, s34, 131072
    s_mov_b32 m0, s33
    s_add_u32 s33, s33, 4096
    buffer_load_dwordx4 v42, s[8:11], s34 offen lds
    s_add_u32 s34, s34, 131072
    s_mov_b32 m0, s33
    s_add_u32 s33, s33, 4096
    buffer_load_dwordx4 v43, s[8:11], s34 offen lds
    s_add_u32 s34, s34, 131072
    s_mov_b32 m0, s33
    s_add_u32 s33, s33, 4096
    buffer_load_dwordx4 v40, s[8:11], s34 offen lds
    s_add_u32 s34, s34, 131072
    s_mov_b32 m0, s33
    s_add_u32 s33, s33, 4096
    buffer_load_dwordx4 v41, s[8:11], s34 offen lds
    s_add_u32 s34, s34, 131072
    s_mov_b32 m0, s33
    s_add_u32 s33, s33, 4096
    buffer_load_dwordx4 v42, s[8:11], s34 offen lds
    s_add_u32 s34, s34, 131072
    s_mov_b32 m0, s33
    s_add_u32 s33, s33, 4096
    buffer_load_dwordx4 v43, s[8:11], s34 offen lds
    s_add_u32 s34, s34, 131072
    s_lshl_b32 s33, s20, 10
    s_add_u32 s33, s33, 0x10000
    s_add_u32 s34, s30, 2097152
    s_mov_b32 m0, s33
    s_add_u32 s33, s33, 4096
    buffer_load_dwordx4 v40, s[8:11], s34 offen lds
    s_add_u32 s34, s34, 131072
    s_mov_b32 m0, s33
    s_add_u32 s33, s33, 4096
    buffer_load_dwordx4 v41, s[8:11], s34 offen lds
    s_add_u32 s34, s34, 131072
    s_mov_b32 m0, s33
    s_add_u32 s33, s33, 4096
    buffer_load_dwordx4 v42, s[8:11], s34 offen lds
    s_add_u32 s34, s34, 131072
    s_mov_b32 m0, s33
    s_add_u32 s33, s33, 4096
    buffer_load_dwordx4 v43, s[8:11], s34 offen lds
    s_add_u32 s34, s34, 131072
    s_mov_b32 m0, s33
    s_add_u32 s33, s33, 4096
    buffer_load_dwordx4 v40, s[8:11], s34 offen lds
    s_add_u32 s34, s34, 131072
    s_mov_b32 m0, s33
    s_add_u32 s33, s33, 4096
    buffer_load_dwordx4 v41, s[8:11], s34 offen lds
    s_add_u32 s34, s34, 131072
    s_mov_b32 m0, s33
    s_add_u32 s33, s33, 4096
    buffer_load_dwordx4 v42, s[8:11], s34 offen lds
    s_add_u32 s34, s34, 131072
    s_mov_b32 m0, s33
    s_add_u32 s33, s33, 4096
    buffer_load_dwordx4 v43, s[8:11], s34 offen lds
    s_add_u32 s34, s34, 131072
    s_mov_b32 m0, s33
    s_add_u32 s33, s33, 4096
    buffer_load_dwordx4 v40, s[8:11], s34 offen lds
    s_add_u32 s34, s34, 131072
    s_mov_b32 m0, s33
    s_add_u32 s33, s33, 4096
    buffer_load_dwordx4 v41, s[8:11], s34 offen lds
    s_add_u32 s34, s34, 131072
    s_mov_b32 m0, s33
    s_add_u32 s33, s33, 4096
    buffer_load_dwordx4 v42, s[8:11], s34 offen lds
    s_add_u32 s34, s34, 131072
    s_mov_b32 m0, s33
    s_add_u32 s33, s33, 4096
    buffer_load_dwordx4 v43, s[8:11], s34 offen lds
    s_add_u32 s34, s34, 131072
    s_mov_b32 m0, s33
    s_add_u32 s33, s33, 4096
    buffer_load_dwordx4 v40, s[8:11], s34 offen lds
    s_add_u32 s34, s34, 131072
    s_mov_b32 m0, s33
    s_add_u32 s33, s33, 4096
    buffer_load_dwordx4 v41, s[8:11], s34 offen lds
    s_add_u32 s34, s34, 131072
    s_mov_b32 m0, s33
    s_add_u32 s33, s33, 4096
    buffer_load_dwordx4 v42, s[8:11], s34 offen lds
    s_add_u32 s34, s34, 131072
    s_mov_b32 m0, s33
    s_add_u32 s33, s33, 4096
    buffer_load_dwordx4 v43, s[8:11], s34 offen lds
    s_add_u32 s34, s34, 131072
    s_waitcnt vmcnt(32)
    s_barrier
    s_branch CH_JOIN
CH_W0:
    s_waitcnt vmcnt(0)
    s_barrier
    v_readfirstlane_b32 s24, v126
    s_cmp_eq_u32 s24, 0
    s_cbranch_scc0 INITE_10
    s_mov_b32 s23, 32768
    v_mov_b32 v2, 128
INITW_9:
    buffer_load_dword v3, v2, s[16:19], 0 offen sc1
    s_waitcnt vmcnt(0)
    v_readfirstlane_b32 s24, v3
    s_sub_u32 s23, s23, 1
    s_cbranch_scc1 INITE_10
    s_cmp_eq_u32 s24, 0
    s_cbranch_scc0 INITE_10
    s_sleep 2
    s_branch INITW_9
INITE_10:
    s_lshl_b32 s23, s2, 2
    v_mov_b32 v5, s23
    v_mov_b32 v10, 1
    buffer_store_dword v10, v5, s[4:7], 0 offen sc1
CH_DMA:
    s_lshl_b32 s33, s20, 10
    s_add_u32 s34, s30, 0
    s_mov_b32 m0, s33
    s_add_u32 s33, s33, 4096
    buffer_load_dwordx4 v40, s[8:11], s34 offen lds
    s_add_u32 s34, s34, 131072
    s_mov_b32 m0, s33
    s_add_u32 s33, s33, 4096
    buffer_load_dwordx4 v41, s[8:11], s34 offen lds
    s_add_u32 s34, s34, 131072
    s_mov_b32 m0, s33
    s_add_u32 s33, s33, 4096
    buffer_load_dwordx4 v42, s[8:11], s34 offen lds
    s_add_u32 s34, s34, 131072
    s_mov_b32 m0, s33
    s_add_u32 s33, s33, 4096
    buffer_load_dwordx4 v43, s[8:11], s34 offen lds
    s_add_u32 s34, s34, 131072
    s_mov_b32 m0, s33
    s_add_u32 s33, s33, 4096
    buffer_load_dwordx4 v40, s[8:11], s34 offen lds
    s_add_u32 s34, s34, 131072
    s_mov_b32 m0, s33
    s_add_u32 s33, s33, 4096
    buffer_load_dwordx4 v41, s[8:11], s34 offen lds
    s_add_u32 s34, s34, 131072
    s_mov_b32 m0, s33
    s_add_u32 s33, s33, 4096
    buffer_load_dwordx4 v42, s[8:11], s34 offen lds
    s_add_u32 s34, s34, 131072
    s_mov_b32 m0, s33
    s_add_u32 s33, s33, 4096
    buffer_load_dwordx4 v43, s[8:11], s34 offen lds
    s_add_u32 s34, s34, 131072
    s_mov_b32 m0, s33
    s_add_u32 s33, s33, 4096
    buffer_load_dwordx4 v40, s[8:11], s34 offen lds
    s_add_u32 s34, s34, 131072
    s_mov_b32 m0, s33
    s_add_u32 s33, s33, 4096
    buffer_load_dwordx4 v41, s[8:11], s34 offen lds
    s_add_u32 s34, s34, 131072
    s_mov_b32 m0, s33
    s_add_u32 s33, s33, 4096
    buffer_load_dwordx4 v42, s[8:11], s34 offen lds
    s_add_u32 s34, s34, 131072
    s_mov_b32 m0, s33
    s_add_u32 s33, s33, 4096
    buffer_load_dwordx4 v43, s[8:11], s34 offen lds
    s_add_u32 s34, s34, 131072
    s_mov_b32 m0, s33
    s_add_u32 s33, s33, 4096
    buffer_load_dwordx4 v40, s[8:11], s34 offen lds
    s_add_u32 s34, s34, 131072
    s_mov_b32 m0, s33
    s_add_u32 s33, s33, 4096
    buffer_load_dwordx4 v41, s[8:11], s34 offen lds
    s_add_u32 s34, s34, 131072
    s_mov_b32 m0, s33
    s_add_u32 s33, s33, 4096
    buffer_load_dwordx4 v42, s[8:11], s34 offen lds
    s_add_u32 s34, s34, 131072
    s_mov_b32 m0, s33
    s_add_u32 s33, s33, 4096
    buffer_load_dwordx4 v43, s[8:11], s34 offen lds
    s_add_u32 s34, s34, 131072
    s_lshl_b32 s33, s20, 10
    s_add_u32 s33, s33, 0x10000
    s_add_u32 s34, s30, 2097152
    s_mov_b32 m0, s33
    s_add_u32 s33, s33, 4096
    buffer_load_dwordx4 v40, s[8:11], s34 offen lds
    s_add_u32 s34, s34, 131072
    s_mov_b32 m0, s33
    s_add_u32 s33, s33, 4096
    buffer_load_dwordx4 v41, s[8:11], s34 offen lds
    s_add_u32 s34, s34, 131072
    s_mov_b32 m0, s33
    s_add_u32 s33, s33, 4096
    buffer_load_dwordx4 v42, s[8:11], s34 offen lds
    s_add_u32 s34, s34, 131072
    s_mov_b32 m0, s33
    s_add_u32 s33, s33, 4096
    buffer_load_dwordx4 v43, s[8:11], s34 offen lds
    s_add_u32 s34, s34, 131072
    s_mov_b32 m0, s33
    s_add_u32 s33, s33, 4096
    buffer_load_dwordx4 v40, s[8:11], s34 offen lds
    s_add_u32 s34, s34, 131072
    s_mov_b32 m0, s33
    s_add_u32 s33, s33, 4096
    buffer_load_dwordx4 v41, s[8:11], s34 offen lds
    s_add_u32 s34, s34, 131072
    s_mov_b32 m0, s33
    s_add_u32 s33, s33, 4096
    buffer_load_dwordx4 v42, s[8:11], s34 offen lds
    s_add_u32 s34, s34, 131072
    s_mov_b32 m0, s33
    s_add_u32 s33, s33, 4096
    buffer_load_dwordx4 v43, s[8:11], s34 offen lds
    s_add_u32 s34, s34, 131072
    s_mov_b32 m0, s33
    s_add_u32 s33, s33, 4096
    buffer_load_dwordx4 v40, s[8:11], s34 offen lds
    s_add_u32 s34, s34, 131072
    s_mov_b32 m0, s33
    s_add_u32 s33, s33, 4096
    buffer_load_dwordx4 v41, s[8:11], s34 offen lds
    s_add_u32 s34, s34, 131072
    s_mov_b32 m0, s33
    s_add_u32 s33, s33, 4096
    buffer_load_dwordx4 v42, s[8:11], s34 offen lds
    s_add_u32 s34, s34, 131072
    s_mov_b32 m0, s33
    s_add_u32 s33, s33, 4096
    buffer_load_dwordx4 v43, s[8:11], s34 offen lds
    s_add_u32 s34, s34, 131072
    s_mov_b32 m0, s33
    s_add_u32 s33, s33, 4096
    buffer_load_dwordx4 v40, s[8:11], s34 offen lds
    s_add_u32 s34, s34, 131072
    s_mov_b32 m0, s33
    s_add_u32 s33, s33, 4096
    buffer_load_dwordx4 v41, s[8:11], s34 offen lds
    s_add_u32 s34, s34, 131072
    s_mov_b32 m0, s33
    s_add_u32 s33, s33, 4096
    buffer_load_dwordx4 v42, s[8:11], s34 offen lds
    s_add_u32 s34, s34, 131072
    s_mov_b32 m0, s33
    s_add_u32 s33, s33, 4096
    buffer_load_dwordx4 v43, s[8:11], s34 offen lds
    s_add_u32 s34, s34, 131072
CH_JOIN:
    v_bfe_u32 v2, v0, 3, 1
    v_bfe_u32 v3, v0, 4, 1
    v_bfe_u32 v4, v0, 5, 1
    v_bfe_u32 v5, v0, 2, 1
    v_lshlrev_b32 v6, 5, v2
    v_lshl_add_u32 v6, v3, 4, v6
    v_lshl_add_u32 v6, v4, 2, v6
    v_add_u32 v6, v6, v5
    v_lshl_add_u32 v7, v2, 1, v3
    v_lshl_add_u32 v7, v7, 1, v5
    v_lshlrev_b32 v7, 1, v7
    v_bfe_u32 v8, v0, 1, 1
    v_and_b32 v9, 1, v0
    s_lshl_b32 s23, s20, 2
    s_add_u32 s23, s23, 0
    v_add_u32 v10, s23, v8
    v_xor_b32 v10, v10, v7
    v_lshlrev_b32 v10, 4, v10
    v_lshl_add_u32 v10, v6, 8, v10
    v_lshl_add_u32 v46, v9, 3, v10
    v_add_u32 v48, 0x10000, v46
    s_lshl_b32 s23, s20, 2
    s_add_u32 s23, s23, 2
    v_add_u32 v10, s23, v8
    v_xor_b32 v10, v10, v7
    v_lshlrev_b32 v10, 4, v10
    v_lshl_add_u32 v10, v6, 8, v10
    v_lshl_add_u32 v47, v9, 3, v10
    v_add_u32 v49, 0x10000, v47
    v_lshlrev_b32 v6, 4, v3
    v_lshl_add_u32 v6, v4, 2, v6
    v_add_u32 v6, v6, v5
    v_lshl_add_u32 v7, v3, 1, v5
    v_lshlrev_b32 v7, 2, v7
    s_lshl_b32 s23, s20, 4
    s_add_u32 s23, s23, 0
    v_lshl_add_u32 v10, v2, 1, v8
    v_add_u32 v10, s23, v10
    v_xor_b32 v10, v10, v7
    v_lshlrev_b32 v10, 4, v10
    v_lshl_add_u32 v10, v6, 10, v10
    v_lshl_add_u32 v50, v9, 3, v10
    s_lshl_b32 s23, s20, 4
    s_add_u32 s23, s23, 4
    v_lshl_add_u32 v10, v2, 1, v8
    v_add_u32 v10, s23, v10
    v_xor_b32 v10, v10, v7
    v_lshlrev_b32 v10, 4, v10
    v_lshl_add_u32 v10, v6, 10, v10
    v_lshl_add_u32 v51, v9, 3, v10
    s_lshl_b32 s23, s20, 4
    s_add_u32 s23, s23, 8
    v_lshl_add_u32 v10, v2, 1, v8
    v_add_u32 v10, s23, v10
    v_xor_b32 v10, v10, v7
    v_lshlrev_b32 v10, 4, v10
    v_lshl_add_u32 v10, v6, 10, v10
    v_lshl_add_u32 v52, v9, 3, v10
    s_lshl_b32 s23, s20, 4
    s_add_u32 s23, s23, 12
    v_lshl_add_u32 v10, v2, 1, v8
    v_add_u32 v10, s23, v10
    v_xor_b32 v10, v10, v7
    v_lshlrev_b32 v10, 4, v10
    v_lshl_add_u32 v10, v6, 10, v10
    v_lshl_add_u32 v53, v9, 3, v10
    v_mov_b32 v56, -1
    v_mov_b32 v57, -1
    v_mov_b32 v58, -1
    v_mov_b32 v59, -1
    v_lshlrev_b32 v55, 4, v0
    s_lshl_b32 s23, s21, 13
    s_lshl_b32 s24, s20, 11
    s_add_u32 s23, s23, s24
    s_add_u32 s23, s23, 0x8000000
    s_add_u32 s24, s23, 0
    buffer_store_dwordx4 v[56:59], v55, s[4:7], s24 offen sc1
    s_add_u32 s24, s23, 1024
    buffer_store_dwordx4 v[56:59], v55, s[4:7], s24 offen sc1
    s_add_u32 s24, s23, 262144
    buffer_store_dwordx4 v[56:59], v55, s[4:7], s24 offen sc1
    s_add_u32 s24, s23, 263168
    buffer_store_dwordx4 v[56:59], v55, s[4:7], s24 offen sc1
    v_lshrrev_b32 v2, 4, v0
    v_and_b32 v3, 7, v0
    v_lshlrev_b32 v3, 4, v3
    v_lshl_add_u32 v3, v2, 7, v3
    s_lshr_b32 s23, s21, 1
    s_lshl_b32 s23, s23, 9
    s_and_b32 s24, s21, 1
    s_lshl_b32 s24, s24, 3
    s_add_u32 s23, s23, s24
    v_add_u32 v61, s23, v3
    s_mov_b32 s24, 0x8100000
    buffer_store_dwordx2 v[56:57], v61, s[4:7], s24 offen sc1
    s_mov_b32 s24, 0x8102000
    buffer_store_dwordx2 v[56:57], v61, s[4:7], s24 offen sc1
    s_mov_b32 s24, 0x8104000
    buffer_store_dwordx2 v[56:57], v61, s[4:7], s24 offen sc1
    v_lshrrev_b32 v100, 4, v0
    v_and_b32 v101, 15, v0
    v_and_b32 v102, 7, v0
    v_bfe_u32 v103, v0, 3, 1
    v_mov_b32 v1, 0x44444444
    v_mov_b32 v104, 0xeeeeeeee
    v_cmp_eq_u32 vcc, 1, v103
    s_nop 1
    v_cndmask_b32 v1, v1, v104, vcc
    v_lshlrev_b32 v104, 9, v103
    v_lshl_add_u32 v104, v100, 7, v104
    v_lshl_add_u32 v104, v102, 4, v104
    v_add_u32 v2, 0x20000, v104
    v_lshlrev_b32 v11, 4, v0
    s_xor_b32 s23, s20, 0
    s_lshr_b32 s24, s23, 1
    s_lshl_b32 s24, s24, 16
    s_and_b32 s23, s23, 1
    s_lshl_b32 s23, s23, 13
    s_add_u32 s24, s24, s23
    s_lshl_b32 s23, s20, 14
    s_add_u32 s24, s24, s23
    v_add_u32 v14, s24, v11
    s_xor_b32 s23, s20, 1
    s_lshr_b32 s24, s23, 1
    s_lshl_b32 s24, s24, 16
    s_and_b32 s23, s23, 1
    s_lshl_b32 s23, s23, 13
    s_add_u32 s24, s24, s23
    s_lshl_b32 s23, s20, 14
    s_add_u32 s24, s24, s23
    v_add_u32 v15, s24, v11
    s_xor_b32 s23, s20, 2
    s_lshr_b32 s24, s23, 1
    s_lshl_b32 s24, s24, 16
    s_and_b32 s23, s23, 1
    s_lshl_b32 s23, s23, 13
    s_add_u32 s24, s24, s23
    s_lshl_b32 s23, s20, 14
    s_add_u32 s24, s24, s23
    v_add_u32 v16, s24, v11
    s_xor_b32 s23, s20, 3
    s_lshr_b32 s24, s23, 1
    s_lshl_b32 s24, s24, 16
    s_and_b32 s23, s23, 1
    s_lshl_b32 s23, s23, 13
    s_add_u32 s24, s24, s23
    s_lshl_b32 s23, s20, 14
    s_add_u32 s24, s24, s23
    v_add_u32 v17, s24, v11
    v_lshrrev_b32 v104, 1, v100
    v_lshl_add_u32 v104, v104, 4, v101
    s_lshl_b32 s23, s20, 5
    v_add_u32 v104, s23, v104
    v_lshlrev_b32 v104, 5, v104
    v_and_b32 v105, 1, v100
    v_lshl_add_u32 v104, v105, 3, v104
    v_add_u32 v3, 0x22000, v104
    v_bfe_u32 v104, v0, 2, 2
    v_lshl_add_u32 v104, v100, 2, v104
    v_lshlrev_b32 v104, 5, v104
    v_and_b32 v105, 1, v0
    v_lshl_add_u32 v104, v105, 3, v104
    v_add_u32 v4, 0x22000, v104
    v_add_u32 v5, 0x24000, v11
    v_lshlrev_b32 v104, 7, v100
    v_lshl_add_u32 v104, v102, 4, v104
    v_add_u32 v104, 0x23000, v104
    s_lshl_b32 s23, s20, 9
    v_add_u32 v6, s23, v104
    v_lshrrev_b32 v104, 5, v0
    v_lshlrev_b32 v104, 24, v104
    v_and_b32 v105, 31, v0
    v_lshl_add_u32 v7, v105, 6, v104
    v_lshrrev_b32 v104, 1, v100
    s_lshl_b32 s23, s20, 3
    v_add_u32 v104, s23, v104
    v_lshlrev_b32 v104, 13, v104
    v_lshrrev_b32 v105, 2, v101
    v_lshl_add_u32 v104, v105, 11, v104
    v_and_b32 v105, 3, v101
    v_lshl_add_u32 v104, v105, 4, v104
    v_and_b32 v105, 1, v100
    v_lshl_add_u32 v104, v105, 3, v104
    s_lshl_b32 s23, s21, 6
    v_add_u32 v10, s23, v104
    v_lshrrev_b32 v104, 1, v100
    v_lshlrev_b32 v104, 2, v104
    v_lshl_add_u32 v104, v102, 4, v104
    s_lshr_b32 s23, s21, 1
    s_lshl_b32 s23, s23, 9
    s_and_b32 s24, s21, 1
    s_lshl_b32 s24, s24, 3
    s_add_u32 s23, s23, s24
    s_lshl_b32 s24, s20, 7
    s_add_u32 s23, s23, s24
    v_add_u32 v12, s23, v104
    v_mov_b32 v127, 0
    s_lshl_b32 s23, s21, 7
    v_and_b32 v104, 1, v0
    v_lshlrev_b32 v104, 12, v104
    s_add_u32 s23, s23, 0x1000
    v_add_u32 v13, s23, v104
    v_and_b32 v104, 1, v0
    v_cmp_eq_u32 vcc, 1, v104
    v_mov_b32 v9, 0x3f80
    v_mov_b32 v104, 0x3f800000
    v_cndmask_b32 v9, v9, v104, vcc
    v_and_b32 v24, 31, v0
    v_lshlrev_b32 v20, 7, v24
    v_add_u32 v20, 0x9000, v20
    v_bfe_u32 v24, v0, 1, 1
    v_lshl_add_u32 v21, v24, 2, v13
    s_mov_b32 s40, 0
    s_lshl_b32 s23, s21, 13
    s_lshl_b32 s24, s20, 11
    s_add_u32 s50, s23, s24
    s_add_u32 s50, s50, 0x1000000
    s_add_u32 s51, s24, 0x24000
    s_waitcnt vmcnt(31)
    ds_write_b128 v107, v[108:111]
    ds_write_b128 v107, v[112:115] offset:4096
    s_barrier
    ds_read_b64_tr_b16 a[0:1], v46 offset:0
    ds_read_b64_tr_b16 a[2:3], v46 offset:512
    ds_read_b64_tr_b16 a[4:5], v46 offset:2048
    ds_read_b64_tr_b16 a[6:7], v46 offset:2560
    ds_read_b64_tr_b16 a[8:9], v47 offset:0
    ds_read_b64_tr_b16 a[10:11], v47 offset:512
    ds_read_b64_tr_b16 a[12:13], v47 offset:2048
    ds_read_b64_tr_b16 a[14:15], v47 offset:2560
    s_waitcnt lgkmcnt(0)
    ds_read_b64_tr_b16 a[16:17], v46 offset:16384
    ds_read_b64_tr_b16 a[18:19], v46 offset:16896
    ds_read_b64_tr_b16 a[20:21], v46 offset:18432
    ds_read_b64_tr_b16 a[22:23], v46 offset:18944
    ds_read_b64_tr_b16 a[24:25], v47 offset:16384
    ds_read_b64_tr_b16 a[26:27], v47 offset:16896
    ds_read_b64_tr_b16 a[28:29], v47 offset:18432
    ds_read_b64_tr_b16 a[30:31], v47 offset:18944
    s_waitcnt lgkmcnt(0)
    s_waitcnt lgkmcnt(0)
    s_barrier
    s_lshl_b32 s33, s20, 10
    s_add_u32 s34, s30, 0
    s_mov_b32 m0, s33
    s_add_u32 s33, s33, 4096
    buffer_load_dwordx4 v40, s[12:15], s34 offen lds
    s_add_u32 s34, s34, 131072
    s_mov_b32 m0, s33
    s_add_u32 s33, s33, 4096
    buffer_load_dwordx4 v41, s[12:15], s34 offen lds
    s_add_u32 s34, s34, 131072
    s_mov_b32 m0, s33
    s_add_u32 s33, s33, 4096
    buffer_load_dwordx4 v42, s[12:15], s34 offen lds
    s_add_u32 s34, s34, 131072
    s_mov_b32 m0, s33
    s_add_u32 s33, s33, 4096
    buffer_load_dwordx4 v43, s[12:15], s34 offen lds
    s_add_u32 s34, s34, 131072
    s_mov_b32 m0, s33
    s_add_u32 s33, s33, 4096
    buffer_load_dwordx4 v40, s[12:15], s34 offen lds
    s_add_u32 s34, s34, 131072
    s_mov_b32 m0, s33
    s_add_u32 s33, s33, 4096
    buffer_load_dwordx4 v41, s[12:15], s34 offen lds
    s_add_u32 s34, s34, 131072
    s_mov_b32 m0, s33
    s_add_u32 s33, s33, 4096
    buffer_load_dwordx4 v42, s[12:15], s34 offen lds
    s_add_u32 s34, s34, 131072
    s_mov_b32 m0, s33
    s_add_u32 s33, s33, 4096
    buffer_load_dwordx4 v43, s[12:15], s34 offen lds
    s_add_u32 s34, s34, 131072
    s_waitcnt vmcnt(31)
    s_barrier
    ds_read_b64_tr_b16 a[32:33], v46 offset:32768
    ds_read_b64_tr_b16 a[34:35], v46 offset:33280
    ds_read_b64_tr_b16 a[36:37], v46 offset:34816
    ds_read_b64_tr_b16 a[38:39], v46 offset:35328
    ds_read_b64_tr_b16 a[40:41], v47 offset:32768
    ds_read_b64_tr_b16 a[42:43], v47 offset:33280
    ds_read_b64_tr_b16 a[44:45], v47 offset:34816
    ds_read_b64_tr_b16 a[46:47], v47 offset:35328
    s_waitcnt lgkmcnt(0)
    ds_read_b64_tr_b16 a[48:49], v46 offset:49152
    ds_read_b64_tr_b16 a[50:51], v46 offset:49664
    ds_read_b64_tr_b16 a[52:53], v46 offset:51200
    ds_read_b64_tr_b16 a[54:55], v46 offset:51712
    ds_read_b64_tr_b16 a[56:57], v47 offset:49152
    ds_read_b64_tr_b16 a[58:59], v47 offset:49664
    ds_read_b64_tr_b16 a[60:61], v47 offset:51200
    ds_read_b64_tr_b16 a[62:63], v47 offset:51712
    s_waitcnt lgkmcnt(0)
    s_waitcnt lgkmcnt(0)
    s_barrier
    s_lshl_b32 s33, s20, 10
    s_add_u32 s33, s33, 0x8000
    s_add_u32 s34, s30, 1048576
    s_mov_b32 m0, s33
    s_add_u32 s33, s33, 4096
    buffer_load_dwordx4 v40, s[12:15], s34 offen lds
    s_add_u32 s34, s34, 131072
    s_mov_b32 m0, s33
    s_add_u32 s33, s33, 4096
    buffer_load_dwordx4 v41, s[12:15], s34 offen lds
    s_add_u32 s34, s34, 131072
    s_mov_b32 m0, s33
    s_add_u32 s33, s33, 4096
    buffer_load_dwordx4 v42, s[12:15], s34 offen lds
    s_add_u32 s34, s34, 131072
    s_mov_b32 m0, s33
    s_add_u32 s33, s33, 4096
    buffer_load_dwordx4 v43, s[12:15], s34 offen lds
    s_add_u32 s34, s34, 131072
    s_mov_b32 m0, s33
    s_add_u32 s33, s33, 4096
    buffer_load_dwordx4 v40, s[12:15], s34 offen lds
    s_add_u32 s34, s34, 131072
    s_mov_b32 m0, s33
    s_add_u32 s33, s33, 4096
    buffer_load_dwordx4 v41, s[12:15], s34 offen lds
    s_add_u32 s34, s34, 131072
    s_mov_b32 m0, s33
    s_add_u32 s33, s33, 4096
    buffer_load_dwordx4 v42, s[12:15], s34 offen lds
    s_add_u32 s34, s34, 131072
    s_mov_b32 m0, s33
    s_add_u32 s33, s33, 4096
    buffer_load_dwordx4 v43, s[12:15], s34 offen lds
    s_add_u32 s34, s34, 131072
    s_waitcnt vmcnt(31)
    s_barrier
    ds_read_b64_tr_b16 a[64:65], v48 offset:0
    ds_read_b64_tr_b16 a[66:67], v48 offset:512
    ds_read_b64_tr_b16 a[68:69], v48 offset:2048
    ds_read_b64_tr_b16 a[70:71], v48 offset:2560
    ds_read_b64_tr_b16 a[72:73], v49 offset:0
    ds_read_b64_tr_b16 a[74:75], v49 offset:512
    ds_read_b64_tr_b16 a[76:77], v49 offset:2048
    ds_read_b64_tr_b16 a[78:79], v49 offset:2560
    s_waitcnt lgkmcnt(0)
    ds_read_b64_tr_b16 a[80:81], v48 offset:16384
    ds_read_b64_tr_b16 a[82:83], v48 offset:16896
    ds_read_b64_tr_b16 a[84:85], v48 offset:18432
    ds_read_b64_tr_b16 a[86:87], v48 offset:18944
    ds_read_b64_tr_b16 a[88:89], v49 offset:16384
    ds_read_b64_tr_b16 a[90:91], v49 offset:16896
    ds_read_b64_tr_b16 a[92:93], v49 offset:18432
    ds_read_b64_tr_b16 a[94:95], v49 offset:18944
    s_waitcnt lgkmcnt(0)
    s_waitcnt lgkmcnt(0)
    s_barrier
    s_lshl_b32 s33, s20, 10
    s_add_u32 s33, s33, 0x10000
    s_add_u32 s34, s30, 2097152
    s_mov_b32 m0, s33
    s_add_u32 s33, s33, 4096
    buffer_load_dwordx4 v40, s[12:15], s34 offen lds
    s_add_u32 s34, s34, 131072
    s_mov_b32 m0, s33
    s_add_u32 s33, s33, 4096
    buffer_load_dwordx4 v41, s[12:15], s34 offen lds
    s_add_u32 s34, s34, 131072
    s_mov_b32 m0, s33
    s_add_u32 s33, s33, 4096
    buffer_load_dwordx4 v42, s[12:15], s34 offen lds
    s_add_u32 s34, s34, 131072
    s_mov_b32 m0, s33
    s_add_u32 s33, s33, 4096
    buffer_load_dwordx4 v43, s[12:15], s34 offen lds
    s_add_u32 s34, s34, 131072
    s_mov_b32 m0, s33
    s_add_u32 s33, s33, 4096
    buffer_load_dwordx4 v40, s[12:15], s34 offen lds
    s_add_u32 s34, s34, 131072
    s_mov_b32 m0, s33
    s_add_u32 s33, s33, 4096
    buffer_load_dwordx4 v41, s[12:15], s34 offen lds
    s_add_u32 s34, s34, 131072
    s_mov_b32 m0, s33
    s_add_u32 s33, s33, 4096
    buffer_load_dwordx4 v42, s[12:15], s34 offen lds
    s_add_u32 s34, s34, 131072
    s_mov_b32 m0, s33
    s_add_u32 s33, s33, 4096
    buffer_load_dwordx4 v43, s[12:15], s34 offen lds
    s_add_u32 s34, s34, 131072
    s_waitcnt vmcnt(31)
    s_barrier
    ds_read_b64_tr_b16 a[96:97], v48 offset:32768
    ds_read_b64_tr_b16 a[98:99], v48 offset:33280
    ds_read_b64_tr_b16 a[100:101], v48 offset:34816
    ds_read_b64_tr_b16 a[102:103], v48 offset:35328
    ds_read_b64_tr_b16 a[104:105], v49 offset:32768
    ds_read_b64_tr_b16 a[106:107], v49 offset:33280
    ds_read_b64_tr_b16 a[108:109], v49 offset:34816
    ds_read_b64_tr_b16 a[110:111], v49 offset:35328
    s_waitcnt lgkmcnt(0)
    ds_read_b64_tr_b16 a[112:113], v48 offset:49152
    ds_read_b64_tr_b16 a[114:115], v48 offset:49664
    ds_read_b64_tr_b16 a[116:117], v48 offset:51200
    ds_read_b64_tr_b16 a[118:119], v48 offset:51712
    ds_read_b64_tr_b16 a[120:121], v49 offset:49152
    ds_read_b64_tr_b16 a[122:123], v49 offset:49664
    ds_read_b64_tr_b16 a[124:125], v49 offset:51200
    ds_read_b64_tr_b16 a[126:127], v49 offset:51712
    s_waitcnt lgkmcnt(0)
    s_waitcnt lgkmcnt(0)
    s_barrier
    s_lshl_b32 s33, s20, 10
    s_add_u32 s33, s33, 0x18000
    s_add_u32 s34, s30, 3145728
    s_mov_b32 m0, s33
    s_add_u32 s33, s33, 4096
    buffer_load_dwordx4 v40, s[12:15], s34 offen lds
    s_add_u32 s34, s34, 131072
    s_mov_b32 m0, s33
    s_add_u32 s33, s33, 4096
    buffer_load_dwordx4 v41, s[12:15], s34 offen lds
    s_add_u32 s34, s34, 131072
    s_mov_b32 m0, s33
    s_add_u32 s33, s33, 4096
    buffer_load_dwordx4 v42, s[12:15], s34 offen lds
    s_add_u32 s34, s34, 131072
    s_mov_b32 m0, s33
    s_add_u32 s33, s33, 4096
    buffer_load_dwordx4 v43, s[12:15], s34 offen lds
    s_add_u32 s34, s34, 131072
    s_mov_b32 m0, s33
    s_add_u32 s33, s33, 4096
    buffer_load_dwordx4 v40, s[12:15], s34 offen lds
    s_add_u32 s34, s34, 131072
    s_mov_b32 m0, s33
    s_add_u32 s33, s33, 4096
    buffer_load_dwordx4 v41, s[12:15], s34 offen lds
    s_add_u32 s34, s34, 131072
    s_mov_b32 m0, s33
    s_add_u32 s33, s33, 4096
    buffer_load_dwordx4 v42, s[12:15], s34 offen lds
    s_add_u32 s34, s34, 131072
    s_mov_b32 m0, s33
    s_add_u32 s33, s33, 4096
    buffer_load_dwordx4 v43, s[12:15], s34 offen lds
    s_add_u32 s34, s34, 131072
    s_waitcnt vmcnt(24)
    s_barrier
    s_lshl_b32 s23, s21, 7
    s_add_u32 s23, s23, 0x9000
    v_mov_b32 v24, s23
    s_add_u32 s24, s26, 1
    v_mov_b32 v25, s24
    buffer_store_dword v25, v24, s[4:7], 0 offen sc1
    ds_read_b64_tr_b16 a[128:129], v46 offset:0
    ds_read_b64_tr_b16 a[130:131], v46 offset:512
    ds_read_b64_tr_b16 a[132:133], v46 offset:2048
    ds_read_b64_tr_b16 a[134:135], v46 offset:2560
    ds_read_b64_tr_b16 a[136:137], v47 offset:0
    ds_read_b64_tr_b16 a[138:139], v47 offset:512
    ds_read_b64_tr_b16 a[140:141], v47 offset:2048
    ds_read_b64_tr_b16 a[142:143], v47 offset:2560
    s_waitcnt lgkmcnt(0)
    ds_read_b64_tr_b16 a[144:145], v46 offset:16384
    ds_read_b64_tr_b16 a[146:147], v46 offset:16896
    ds_read_b64_tr_b16 a[148:149], v46 offset:18432
    ds_read_b64_tr_b16 a[150:151], v46 offset:18944
    ds_read_b64_tr_b16 a[152:153], v47 offset:16384
    ds_read_b64_tr_b16 a[154:155], v47 offset:16896
    ds_read_b64_tr_b16 a[156:157], v47 offset:18432
    ds_read_b64_tr_b16 a[158:159], v47 offset:18944
    s_waitcnt lgkmcnt(0)
    s_waitcnt lgkmcnt(0)
    s_barrier
    s_lshl_b32 s33, s20, 10
    s_add_u32 s34, s30, 0
    s_mov_b32 m0, s33
    s_add_u32 s33, s33, 4096
    buffer_load_dwordx4 v40, s[52:55], s34 offen lds
    s_add_u32 s34, s34, 131072
    s_mov_b32 m0, s33
    s_add_u32 s33, s33, 4096
    buffer_load_dwordx4 v41, s[52:55], s34 offen lds
    s_add_u32 s34, s34, 131072
    s_mov_b32 m0, s33
    s_add_u32 s33, s33, 4096
    buffer_load_dwordx4 v42, s[52:55], s34 offen lds
    s_add_u32 s34, s34, 131072
    s_mov_b32 m0, s33
    s_add_u32 s33, s33, 4096
    buffer_load_dwordx4 v43, s[52:55], s34 offen lds
    s_add_u32 s34, s34, 131072
    s_mov_b32 m0, s33
    s_add_u32 s33, s33, 4096
    buffer_load_dwordx4 v40, s[52:55], s34 offen lds
    s_add_u32 s34, s34, 131072
    s_mov_b32 m0, s33
    s_add_u32 s33, s33, 4096
    buffer_load_dwordx4 v41, s[52:55], s34 offen lds
    s_add_u32 s34, s34, 131072
    s_mov_b32 m0, s33
    s_add_u32 s33, s33, 4096
    buffer_load_dwordx4 v42, s[52:55], s34 offen lds
    s_add_u32 s34, s34, 131072
    s_mov_b32 m0, s33
    s_add_u32 s33, s33, 4096
    buffer_load_dwordx4 v43, s[52:55], s34 offen lds
    s_add_u32 s34, s34, 131072
    s_waitcnt vmcnt(24)
    s_barrier
    ds_read_b64_tr_b16 a[160:161], v46 offset:32768
    ds_read_b64_tr_b16 a[162:163], v46 offset:33280
    ds_read_b64_tr_b16 a[164:165], v46 offset:34816
    ds_read_b64_tr_b16 a[166:167], v46 offset:35328
    ds_read_b64_tr_b16 a[168:169], v47 offset:32768
    ds_read_b64_tr_b16 a[170:171], v47 offset:33280
    ds_read_b64_tr_b16 a[172:173], v47 offset:34816
    ds_read_b64_tr_b16 a[174:175], v47 offset:35328
    s_waitcnt lgkmcnt(0)
    ds_read_b64_tr_b16 a[176:177], v46 offset:49152
    ds_read_b64_tr_b16 a[178:179], v46 offset:49664
    ds_read_b64_tr_b16 a[180:181], v46 offset:51200
    ds_read_b64_tr_b16 a[182:183], v46 offset:51712
    ds_read_b64_tr_b16 a[184:185], v47 offset:49152
    ds_read_b64_tr_b16 a[186:187], v47 offset:49664
    ds_read_b64_tr_b16 a[188:189], v47 offset:51200
    ds_read_b64_tr_b16 a[190:191], v47 offset:51712
    s_waitcnt lgkmcnt(0)
    s_waitcnt lgkmcnt(0)
    s_barrier
    s_lshl_b32 s33, s20, 10
    s_add_u32 s33, s33, 0x8000
    s_add_u32 s34, s30, 1048576
    s_mov_b32 m0, s33
    s_add_u32 s33, s33, 4096
    buffer_load_dwordx4 v40, s[52:55], s34 offen lds
    s_add_u32 s34, s34, 131072
    s_mov_b32 m0, s33
    s_add_u32 s33, s33, 4096
    buffer_load_dwordx4 v41, s[52:55], s34 offen lds
    s_add_u32 s34, s34, 131072
    s_mov_b32 m0, s33
    s_add_u32 s33, s33, 4096
    buffer_load_dwordx4 v42, s[52:55], s34 offen lds
    s_add_u32 s34, s34, 131072
    s_mov_b32 m0, s33
    s_add_u32 s33, s33, 4096
    buffer_load_dwordx4 v43, s[52:55], s34 offen lds
    s_add_u32 s34, s34, 131072
    s_mov_b32 m0, s33
    s_add_u32 s33, s33, 4096
    buffer_load_dwordx4 v40, s[52:55], s34 offen lds
    s_add_u32 s34, s34, 131072
    s_mov_b32 m0, s33
    s_add_u32 s33, s33, 4096
    buffer_load_dwordx4 v41, s[52:55], s34 offen lds
    s_add_u32 s34, s34, 131072
    s_mov_b32 m0, s33
    s_add_u32 s33, s33, 4096
    buffer_load_dwordx4 v42, s[52:55], s34 offen lds
    s_add_u32 s34, s34, 131072
    s_mov_b32 m0, s33
    s_add_u32 s33, s33, 4096
    buffer_load_dwordx4 v43, s[52:55], s34 offen lds
    s_add_u32 s34, s34, 131072
    s_waitcnt vmcnt(24)
    s_barrier
    ds_read_b64_tr_b16 a[192:193], v48 offset:0
    ds_read_b64_tr_b16 a[194:195], v48 offset:512
    ds_read_b64_tr_b16 a[196:197], v48 offset:2048
    ds_read_b64_tr_b16 a[198:199], v48 offset:2560
    ds_read_b64_tr_b16 a[200:201], v49 offset:0
    ds_read_b64_tr_b16 a[202:203], v49 offset:512
    ds_read_b64_tr_b16 a[204:205], v49 offset:2048
    ds_read_b64_tr_b16 a[206:207], v49 offset:2560
    s_waitcnt lgkmcnt(0)
    ds_read_b64_tr_b16 a[208:209], v48 offset:16384
    ds_read_b64_tr_b16 a[210:211], v48 offset:16896
    ds_read_b64_tr_b16 a[212:213], v48 offset:18432
    ds_read_b64_tr_b16 a[214:215], v48 offset:18944
    ds_read_b64_tr_b16 a[216:217], v49 offset:16384
    ds_read_b64_tr_b16 a[218:219], v49 offset:16896
    ds_read_b64_tr_b16 a[220:221], v49 offset:18432
    ds_read_b64_tr_b16 a[222:223], v49 offset:18944
    s_waitcnt lgkmcnt(0)
    s_waitcnt lgkmcnt(0)
    s_barrier
    s_lshl_b32 s33, s20, 10
    s_add_u32 s33, s33, 0x10000
    s_add_u32 s34, s30, 2097152
    s_mov_b32 m0, s33
    s_add_u32 s33, s33, 4096
    buffer_load_dwordx4 v40, s[52:55], s34 offen lds
    s_add_u32 s34, s34, 131072
    s_mov_b32 m0, s33
    s_add_u32 s33, s33, 4096
    buffer_load_dwordx4 v41, s[52:55], s34 offen lds
    s_add_u32 s34, s34, 131072
    s_mov_b32 m0, s33
    s_add_u32 s33, s33, 4096
    buffer_load_dwordx4 v42, s[52:55], s34 offen lds
    s_add_u32 s34, s34, 131072
    s_mov_b32 m0, s33
    s_add_u32 s33, s33, 4096
    buffer_load_dwordx4 v43, s[52:55], s34 offen lds
    s_add_u32 s34, s34, 131072
    s_mov_b32 m0, s33
    s_add_u32 s33, s33, 4096
    buffer_load_dwordx4 v40, s[52:55], s34 offen lds
    s_add_u32 s34, s34, 131072
    s_mov_b32 m0, s33
    s_add_u32 s33, s33, 4096
    buffer_load_dwordx4 v41, s[52:55], s34 offen lds
    s_add_u32 s34, s34, 131072
    s_mov_b32 m0, s33
    s_add_u32 s33, s33, 4096
    buffer_load_dwordx4 v42, s[52:55], s34 offen lds
    s_add_u32 s34, s34, 131072
    s_mov_b32 m0, s33
    s_add_u32 s33, s33, 4096
    buffer_load_dwordx4 v43, s[52:55], s34 offen lds
    s_add_u32 s34, s34, 131072
    s_waitcnt vmcnt(24)
    s_barrier
    ds_read_b64_tr_b16 a[224:225], v48 offset:32768
    ds_read_b64_tr_b16 a[226:227], v48 offset:33280
    ds_read_b64_tr_b16 a[228:229], v48 offset:34816
    ds_read_b64_tr_b16 a[230:231], v48 offset:35328
    ds_read_b64_tr_b16 a[232:233], v49 offset:32768
    ds_read_b64_tr_b16 a[234:235], v49 offset:33280
    ds_read_b64_tr_b16 a[236:237], v49 offset:34816
    ds_read_b64_tr_b16 a[238:239], v49 offset:35328
    s_waitcnt lgkmcnt(0)
    ds_read_b64_tr_b16 a[240:241], v48 offset:49152
    ds_read_b64_tr_b16 a[242:243], v48 offset:49664
    ds_read_b64_tr_b16 a[244:245], v48 offset:51200
    ds_read_b64_tr_b16 a[246:247], v48 offset:51712
    ds_read_b64_tr_b16 a[248:249], v49 offset:49152
    ds_read_b64_tr_b16 a[250:251], v49 offset:49664
    ds_read_b64_tr_b16 a[252:253], v49 offset:51200
    ds_read_b64_tr_b16 a[254:255], v49 offset:51712
    s_waitcnt lgkmcnt(0)
    s_waitcnt lgkmcnt(0)
    s_barrier
    s_lshl_b32 s33, s20, 10
    s_add_u32 s33, s33, 0x18000
    s_add_u32 s34, s30, 3145728
    s_mov_b32 m0, s33
    s_add_u32 s33, s33, 4096
    buffer_load_dwordx4 v40, s[52:55], s34 offen lds
    s_add_u32 s34, s34, 131072
    s_mov_b32 m0, s33
    s_add_u32 s33, s33, 4096
    buffer_load_dwordx4 v41, s[52:55], s34 offen lds
    s_add_u32 s34, s34, 131072
    s_mov_b32 m0, s33
    s_add_u32 s33, s33, 4096
    buffer_load_dwordx4 v42, s[52:55], s34 offen lds
    s_add_u32 s34, s34, 131072
    s_mov_b32 m0, s33
    s_add_u32 s33, s33, 4096
    buffer_load_dwordx4 v43, s[52:55], s34 offen lds
    s_add_u32 s34, s34, 131072
    s_mov_b32 m0, s33
    s_add_u32 s33, s33, 4096
    buffer_load_dwordx4 v40, s[52:55], s34 offen lds
    s_add_u32 s34, s34, 131072
    s_mov_b32 m0, s33
    s_add_u32 s33, s33, 4096
    buffer_load_dwordx4 v41, s[52:55], s34 offen lds
    s_add_u32 s34, s34, 131072
    s_mov_b32 m0, s33
    s_add_u32 s33, s33, 4096
    buffer_load_dwordx4 v42, s[52:55], s34 offen lds
    s_add_u32 s34, s34, 131072
    s_mov_b32 m0, s33
    s_add_u32 s33, s33, 4096
    buffer_load_dwordx4 v43, s[52:55], s34 offen lds
    s_add_u32 s34, s34, 131072
    s_waitcnt vmcnt(24)
    s_barrier
    ds_read_b64_tr_b16 v[128:129], v46 offset:0
    ds_read_b64_tr_b16 v[130:131], v46 offset:512
    ds_read_b64_tr_b16 v[132:133], v46 offset:2048
    ds_read_b64_tr_b16 v[134:135], v46 offset:2560
    ds_read_b64_tr_b16 v[136:137], v47 offset:0
    ds_read_b64_tr_b16 v[138:139], v47 offset:512
    ds_read_b64_tr_b16 v[140:141], v47 offset:2048
    ds_read_b64_tr_b16 v[142:143], v47 offset:2560
    s_waitcnt lgkmcnt(0)
    ds_read_b64_tr_b16 v[144:145], v46 offset:16384
    ds_read_b64_tr_b16 v[146:147], v46 offset:16896
    ds_read_b64_tr_b16 v[148:149], v46 offset:18432
    ds_read_b64_tr_b16 v[150:151], v46 offset:18944
    ds_read_b64_tr_b16 v[152:153], v47 offset:16384
    ds_read_b64_tr_b16 v[154:155], v47 offset:16896
    ds_read_b64_tr_b16 v[156:157], v47 offset:18432
    ds_read_b64_tr_b16 v[158:159], v47 offset:18944
    s_waitcnt lgkmcnt(0)
    s_waitcnt lgkmcnt(0)
    s_barrier
    s_lshl_b32 s33, s20, 10
    s_add_u32 s34, s31, 0
    s_mov_b32 m0, s33
    s_add_u32 s33, s33, 4096
    buffer_load_dwordx4 v44, s[56:59], s34 offen lds
    s_add_u32 s34, s34, 4096
    s_mov_b32 m0, s33
    s_add_u32 s33, s33, 4096
    buffer_load_dwordx4 v44, s[56:59], s34 offen lds
    s_add_u32 s34, s34, 4096
    s_mov_b32 m0, s33
    s_add_u32 s33, s33, 4096
    buffer_load_dwordx4 v44, s[56:59], s34 offen lds
    s_add_u32 s34, s34, 4096
    s_mov_b32 m0, s33
    s_add_u32 s33, s33, 4096
    buffer_load_dwordx4 v44, s[56:59], s34 offen lds
    s_add_u32 s34, s34, 4096
    s_mov_b32 m0, s33
    s_add_u32 s33, s33, 4096
    buffer_load_dwordx4 v45, s[56:59], s34 offen lds
    s_add_u32 s34, s34, 4096
    s_mov_b32 m0, s33
    s_add_u32 s33, s33, 4096
    buffer_load_dwordx4 v45, s[56:59], s34 offen lds
    s_add_u32 s34, s34, 4096
    s_mov_b32 m0, s33
    s_add_u32 s33, s33, 4096
    buffer_load_dwordx4 v45, s[56:59], s34 offen lds
    s_add_u32 s34, s34, 4096
    s_mov_b32 m0, s33
    s_add_u32 s33, s33, 4096
    buffer_load_dwordx4 v45, s[56:59], s34 offen lds
    s_add_u32 s34, s34, 4096
    s_waitcnt vmcnt(24)
    s_barrier
    ds_read_b64_tr_b16 v[160:161], v46 offset:32768
    ds_read_b64_tr_b16 v[162:163], v46 offset:33280
    ds_read_b64_tr_b16 v[164:165], v46 offset:34816
    ds_read_b64_tr_b16 v[166:167], v46 offset:35328
    ds_read_b64_tr_b16 v[168:169], v47 offset:32768
    ds_read_b64_tr_b16 v[170:171], v47 offset:33280
    ds_read_b64_tr_b16 v[172:173], v47 offset:34816
    ds_read_b64_tr_b16 v[174:175], v47 offset:35328
    s_waitcnt lgkmcnt(0)
    ds_read_b64_tr_b16 v[176:177], v46 offset:49152
    ds_read_b64_tr_b16 v[178:179], v46 offset:49664
    ds_read_b64_tr_b16 v[180:181], v46 offset:51200
    ds_read_b64_tr_b16 v[182:183], v46 offset:51712
    ds_read_b64_tr_b16 v[184:185], v47 offset:49152
    ds_read_b64_tr_b16 v[186:187], v47 offset:49664
    ds_read_b64_tr_b16 v[188:189], v47 offset:51200
    ds_read_b64_tr_b16 v[190:191], v47 offset:51712
    s_waitcnt lgkmcnt(0)
    s_waitcnt lgkmcnt(0)
    s_barrier
    s_lshl_b32 s33, s20, 10
    s_add_u32 s33, s33, 0x8000
    s_add_u32 s34, s31, 32768
    s_mov_b32 m0, s33
    s_add_u32 s33, s33, 4096
    buffer_load_dwordx4 v44, s[56:59], s34 offen lds
    s_add_u32 s34, s34, 4096
    s_mov_b32 m0, s33
    s_add_u32 s33, s33, 4096
    buffer_load_dwordx4 v44, s[56:59], s34 offen lds
    s_add_u32 s34, s34, 4096
    s_mov_b32 m0, s33
    s_add_u32 s33, s33, 4096
    buffer_load_dwordx4 v44, s[56:59], s34 offen lds
    s_add_u32 s34, s34, 4096
    s_mov_b32 m0, s33
    s_add_u32 s33, s33, 4096
    buffer_load_dwordx4 v44, s[56:59], s34 offen lds
    s_add_u32 s34, s34, 4096
    s_mov_b32 m0, s33
    s_add_u32 s33, s33, 4096
    buffer_load_dwordx4 v45, s[56:59], s34 offen lds
    s_add_u32 s34, s34, 4096
    s_mov_b32 m0, s33
    s_add_u32 s33, s33, 4096
    buffer_load_dwordx4 v45, s[56:59], s34 offen lds
    s_add_u32 s34, s34, 4096
    s_mov_b32 m0, s33
    s_add_u32 s33, s33, 4096
    buffer_load_dwordx4 v45, s[56:59], s34 offen lds
    s_add_u32 s34, s34, 4096
    s_mov_b32 m0, s33
    s_add_u32 s33, s33, 4096
    buffer_load_dwordx4 v45, s[56:59], s34 offen lds
    s_add_u32 s34, s34, 4096
    s_waitcnt vmcnt(24)
    s_barrier
    ds_read_b64_tr_b16 v[192:193], v48 offset:0
    ds_read_b64_tr_b16 v[194:195], v48 offset:512
    ds_read_b64_tr_b16 v[196:197], v48 offset:2048
    ds_read_b64_tr_b16 v[198:199], v48 offset:2560
    ds_read_b64_tr_b16 v[200:201], v49 offset:0
    ds_read_b64_tr_b16 v[202:203], v49 offset:512
    ds_read_b64_tr_b16 v[204:205], v49 offset:2048
    ds_read_b64_tr_b16 v[206:207], v49 offset:2560
    s_waitcnt lgkmcnt(0)
    ds_read_b64_tr_b16 v[208:209], v48 offset:16384
    ds_read_b64_tr_b16 v[210:211], v48 offset:16896
    ds_read_b64_tr_b16 v[212:213], v48 offset:18432
    ds_read_b64_tr_b16 v[214:215], v48 offset:18944
    ds_read_b64_tr_b16 v[216:217], v49 offset:16384
    ds_read_b64_tr_b16 v[218:219], v49 offset:16896
    ds_read_b64_tr_b16 v[220:221], v49 offset:18432
    ds_read_b64_tr_b16 v[222:223], v49 offset:18944
    s_waitcnt lgkmcnt(0)
    s_waitcnt lgkmcnt(0)
    s_barrier
    s_lshl_b32 s33, s20, 10
    s_add_u32 s33, s33, 0x10000
    s_add_u32 s34, s31, 65536
    s_mov_b32 m0, s33
    s_add_u32 s33, s33, 4096
    buffer_load_dwordx4 v44, s[56:59], s34 offen lds
    s_add_u32 s34, s34, 4096
    s_mov_b32 m0, s33
    s_add_u32 s33, s33, 4096
    buffer_load_dwordx4 v44, s[56:59], s34 offen lds
    s_add_u32 s34, s34, 4096
    s_mov_b32 m0, s33
    s_add_u32 s33, s33, 4096
    buffer_load_dwordx4 v44, s[56:59], s34 offen lds
    s_add_u32 s34, s34, 4096
    s_mov_b32 m0, s33
    s_add_u32 s33, s33, 4096
    buffer_load_dwordx4 v44, s[56:59], s34 offen lds
    s_add_u32 s34, s34, 4096
    s_mov_b32 m0, s33
    s_add_u32 s33, s33, 4096
    buffer_load_dwordx4 v45, s[56:59], s34 offen lds
    s_add_u32 s34, s34, 4096
    s_mov_b32 m0, s33
    s_add_u32 s33, s33, 4096
    buffer_load_dwordx4 v45, s[56:59], s34 offen lds
    s_add_u32 s34, s34, 4096
    s_mov_b32 m0, s33
    s_add_u32 s33, s33, 4096
    buffer_load_dwordx4 v45, s[56:59], s34 offen lds
    s_add_u32 s34, s34, 4096
    s_mov_b32 m0, s33
    s_add_u32 s33, s33, 4096
    buffer_load_dwordx4 v45, s[56:59], s34 offen lds
    s_add_u32 s34, s34, 4096
    s_waitcnt vmcnt(24)
    s_barrier
    ds_read_b64_tr_b16 v[224:225], v48 offset:32768
    ds_read_b64_tr_b16 v[226:227], v48 offset:33280
    ds_read_b64_tr_b16 v[228:229], v48 offset:34816
    ds_read_b64_tr_b16 v[230:231], v48 offset:35328
    ds_read_b64_tr_b16 v[232:233], v49 offset:32768
    ds_read_b64_tr_b16 v[234:235], v49 offset:33280
    ds_read_b64_tr_b16 v[236:237], v49 offset:34816
    ds_read_b64_tr_b16 v[238:239], v49 offset:35328
    s_waitcnt lgkmcnt(0)
    ds_read_b64_tr_b16 v[240:241], v48 offset:49152
    ds_read_b64_tr_b16 v[242:243], v48 offset:49664
    ds_read_b64_tr_b16 v[244:245], v48 offset:51200
    ds_read_b64_tr_b16 v[246:247], v48 offset:51712
    ds_read_b64_tr_b16 v[248:249], v49 offset:49152
    ds_read_b64_tr_b16 v[250:251], v49 offset:49664
    ds_read_b64_tr_b16 v[252:253], v49 offset:51200
    ds_read_b64_tr_b16 v[254:255], v49 offset:51712
    s_waitcnt lgkmcnt(0)
    s_waitcnt lgkmcnt(0)
    s_barrier
    s_lshl_b32 s33, s20, 10
    s_add_u32 s33, s33, 0x18000
    s_add_u32 s34, s31, 98304
    s_mov_b32 m0, s33
    s_add_u32 s33, s33, 4096
    buffer_load_dwordx4 v44, s[56:59], s34 offen lds
    s_add_u32 s34, s34, 4096
    s_mov_b32 m0, s33
    s_add_u32 s33, s33, 4096
    buffer_load_dwordx4 v44, s[56:59], s34 offen lds
    s_add_u32 s34, s34, 4096
    s_mov_b32 m0, s33
    s_add_u32 s33, s33, 4096
    buffer_load_dwordx4 v44, s[56:59], s34 offen lds
    s_add_u32 s34, s34, 4096
    s_mov_b32 m0, s33
    s_add_u32 s33, s33, 4096
    buffer_load_dwordx4 v44, s[56:59], s34 offen lds
    s_add_u32 s34, s34, 4096
    s_mov_b32 m0, s33
    s_add_u32 s33, s33, 4096
    buffer_load_dwordx4 v45, s[56:59], s34 offen lds
    s_add_u32 s34, s34, 4096
    s_mov_b32 m0, s33
    s_add_u32 s33, s33, 4096
    buffer_load_dwordx4 v45, s[56:59], s34 offen lds
    s_add_u32 s34, s34, 4096
    s_mov_b32 m0, s33
    s_add_u32 s33, s33, 4096
    buffer_load_dwordx4 v45, s[56:59], s34 offen lds
    s_add_u32 s34, s34, 4096
    s_mov_b32 m0, s33
    s_add_u32 s33, s33, 4096
    buffer_load_dwordx4 v45, s[56:59], s34 offen lds
    s_add_u32 s34, s34, 4096
    s_waitcnt vmcnt(16)
    s_barrier
    v_add_u32 v54, 0x0, v50
    ds_read_b64_tr_b16 v[60:61], v54 offset:0
    ds_read_b64_tr_b16 v[62:63], v54 offset:2048
    ds_read_b64_tr_b16 v[64:65], v54 offset:8192
    ds_read_b64_tr_b16 v[66:67], v54 offset:10240
    s_waitcnt lgkmcnt(0)
    v_add_u32 v54, 0x0, v51
    ds_read_b64_tr_b16 v[68:69], v54 offset:0
    ds_read_b64_tr_b16 v[70:71], v54 offset:2048
    ds_read_b64_tr_b16 v[72:73], v54 offset:8192
    ds_read_b64_tr_b16 v[74:75], v54 offset:10240
    s_waitcnt lgkmcnt(0)
    v_add_u32 v54, 0x0, v52
    ds_read_b64_tr_b16 v[76:77], v54 offset:0
    ds_read_b64_tr_b16 v[78:79], v54 offset:2048
    ds_read_b64_tr_b16 v[80:81], v54 offset:8192
    ds_read_b64_tr_b16 v[82:83], v54 offset:10240
    s_waitcnt lgkmcnt(0)
    v_add_u32 v54, 0x0, v53
    ds_read_b64_tr_b16 v[84:85], v54 offset:0
    ds_read_b64_tr_b16 v[86:87], v54 offset:2048
    ds_read_b64_tr_b16 v[88:89], v54 offset:8192
    ds_read_b64_tr_b16 v[90:91], v54 offset:10240
    s_waitcnt lgkmcnt(0)
    v_add_u32 v54, 0x8000, v50
    ds_read_b64_tr_b16 v[92:93], v54 offset:0
    ds_read_b64_tr_b16 v[94:95], v54 offset:2048
    ds_read_b64_tr_b16 v[96:97], v54 offset:8192
    ds_read_b64_tr_b16 v[98:99], v54 offset:10240
    s_waitcnt lgkmcnt(0)
    v_add_u32 v54, 0x8000, v51
    ds_read_b64_tr_b16 v[100:101], v54 offset:0
    ds_read_b64_tr_b16 v[102:103], v54 offset:2048
    ds_read_b64_tr_b16 v[104:105], v54 offset:8192
    ds_read_b64_tr_b16 v[106:107], v54 offset:10240
    s_waitcnt lgkmcnt(0)
    v_add_u32 v54, 0x8000, v52
    ds_read_b64_tr_b16 v[108:109], v54 offset:0
    ds_read_b64_tr_b16 v[110:111], v54 offset:2048
    ds_read_b64_tr_b16 v[112:113], v54 offset:8192
    ds_read_b64_tr_b16 v[114:115], v54 offset:10240
    s_waitcnt lgkmcnt(0)
    v_add_u32 v54, 0x8000, v53
    ds_read_b64_tr_b16 v[116:117], v54 offset:0
    ds_read_b64_tr_b16 v[118:119], v54 offset:2048
    ds_read_b64_tr_b16 v[120:121], v54 offset:8192
    ds_read_b64_tr_b16 v[122:123], v54 offset:10240
    s_waitcnt lgkmcnt(0)
    s_barrier
    s_lshl_b32 s23, s20, 14
    v_lshlrev_b32 v54, 4, v0
    v_add_u32 v54, s23, v54
    ds_write_b128 v54, v[60:63] offset:0
    ds_write_b128 v54, v[64:67] offset:1024
    s_waitcnt lgkmcnt(0)
    ds_write_b128 v54, v[68:71] offset:2048
    ds_write_b128 v54, v[72:75] offset:3072
    s_waitcnt lgkmcnt(0)
    ds_write_b128 v54, v[76:79] offset:4096
    ds_write_b128 v54, v[80:83] offset:5120
    s_waitcnt lgkmcnt(0)
    ds_write_b128 v54, v[84:87] offset:6144
    ds_write_b128 v54, v[88:91] offset:7168
    s_waitcnt lgkmcnt(0)
    ds_write_b128 v54, v[92:95] offset:8192
    ds_write_b128 v54, v[96:99] offset:9216
    s_waitcnt lgkmcnt(0)
    ds_write_b128 v54, v[100:103] offset:10240
    ds_write_b128 v54, v[104:107] offset:11264
    s_waitcnt lgkmcnt(0)
    ds_write_b128 v54, v[108:111] offset:12288
    ds_write_b128 v54, v[112:115] offset:13312
    s_waitcnt lgkmcnt(0)
    ds_write_b128 v54, v[116:119] offset:14336
    ds_write_b128 v54, v[120:123] offset:15360
    s_waitcnt lgkmcnt(0)
    s_waitcnt lgkmcnt(0)
    s_barrier
    buffer_load_dword v22, v20, s[4:7], 0 offen sc1
    buffer_load_dword v23, v21, s[4:7], 0 offen sc1
    s_waitcnt vmcnt(0)
    s_barrier
    s_mov_b32 s24, 32768
RDY_11:
    v_cmp_eq_u32 vcc, 0, v22
    s_sub_u32 s24, s24, 1
    s_cbranch_scc1 RDYE_12
    s_nop 2
    s_cbranch_vccz RDYE_12
    s_sleep 1
    buffer_load_dword v22, v20, s[4:7], 0 offen sc1
    s_waitcnt vmcnt(0)
    s_branch RDY_11
RDYE_12:
    s_add_u32 s24, s26, 1
    v_cmp_ne_u32 vcc, s24, v22
    s_mov_b64 s[64:65], vcc
    v_cmp_gt_u32 vcc, 1, v23
    s_nop 4
    s_cbranch_vccz KV0_13
    s_add_u32 s23, s40, 0
    s_min_u32 s23, s23, 63
    s_and_b32 s24, s23, 3
    s_lshl_b32 s24, s24, 2
    s_lshr_b32 s23, s23, 2
    s_add_u32 s23, s23, 1
    s_mov_b32 s25, 32768
WKV_14:
    buffer_load_dword v18, v13, s[4:7], s24 offen sc1
    s_waitcnt vmcnt(0)
    v_cmp_gt_u32 vcc, s23, v18
    s_sub_u32 s25, s25, 1
    s_cbranch_scc1 WKVE_15
    s_nop 2
    s_cbranch_vccz WKVE_15
    s_sleep 1
    s_branch WKV_14
WKVE_15:
    s_add_u32 s23, s40, 1
    s_min_u32 s23, s23, 63
    s_and_b32 s24, s23, 3
    s_lshl_b32 s24, s24, 2
    s_lshr_b32 s23, s23, 2
    s_add_u32 s23, s23, 1
    s_mov_b32 s25, 32768
WKV_16:
    buffer_load_dword v18, v13, s[4:7], s24 offen sc1
    s_waitcnt vmcnt(0)
    v_cmp_gt_u32 vcc, s23, v18
    s_sub_u32 s25, s25, 1
    s_cbranch_scc1 WKVE_17
    s_nop 2
    s_cbranch_vccz WKVE_17
    s_sleep 1
    s_branch WKV_16
WKVE_17:
KV0_13:
    s_mov_b32 m0, s51
    s_add_u32 s24, s50, 0x1000000
    s_add_u32 s23, s51, 8192
    buffer_load_dwordx4 v11, s[4:7], s50 offen offset:0 lds
    buffer_load_dwordx4 v11, s[4:7], s50 offen offset:1024 lds
    s_mov_b32 m0, s23
    s_add_u32 s50, s50, 0x40000
    buffer_load_dwordx4 v11, s[4:7], s24 offen offset:0 lds
    buffer_load_dwordx4 v11, s[4:7], s24 offen offset:1024 lds
    v_add_u32 v54, 0x10000, v50
    ds_read_b64_tr_b16 v[60:61], v54 offset:0
    ds_read_b64_tr_b16 v[62:63], v54 offset:2048
    ds_read_b64_tr_b16 v[64:65], v54 offset:8192
    ds_read_b64_tr_b16 v[66:67], v54 offset:10240
    s_waitcnt lgkmcnt(0)
    v_add_u32 v54, 0x10000, v51
    ds_read_b64_tr_b16 v[68:69], v54 offset:0
    ds_read_b64_tr_b16 v[70:71], v54 offset:2048
    ds_read_b64_tr_b16 v[72:73], v54 offset:8192
    ds_read_b64_tr_b16 v[74:75], v54 offset:10240
    s_waitcnt lgkmcnt(0)
    v_add_u32 v54, 0x10000, v52
    ds_read_b64_tr_b16 v[76:77], v54 offset:0
    ds_read_b64_tr_b16 v[78:79], v54 offset:2048
    ds_read_b64_tr_b16 v[80:81], v54 offset:8192
    ds_read_b64_tr_b16 v[82:83], v54 offset:10240
    s_waitcnt lgkmcnt(0)
    v_add_u32 v54, 0x10000, v53
    ds_read_b64_tr_b16 v[84:85], v54 offset:0
    ds_read_b64_tr_b16 v[86:87], v54 offset:2048
    ds_read_b64_tr_b16 v[88:89], v54 offset:8192
    ds_read_b64_tr_b16 v[90:91], v54 offset:10240
    s_waitcnt lgkmcnt(0)
    v_add_u32 v54, 0x18000, v50
    ds_read_b64_tr_b16 v[92:93], v54 offset:0
    ds_read_b64_tr_b16 v[94:95], v54 offset:2048
    ds_read_b64_tr_b16 v[96:97], v54 offset:8192
    ds_read_b64_tr_b16 v[98:99], v54 offset:10240
    s_waitcnt lgkmcnt(0)
    v_add_u32 v54, 0x18000, v51
    ds_read_b64_tr_b16 v[100:101], v54 offset:0
    ds_read_b64_tr_b16 v[102:103], v54 offset:2048
    ds_read_b64_tr_b16 v[104:105], v54 offset:8192
    ds_read_b64_tr_b16 v[106:107], v54 offset:10240
    s_waitcnt lgkmcnt(0)
    v_add_u32 v54, 0x18000, v52
    ds_read_b64_tr_b16 v[108:109], v54 offset:0
    ds_read_b64_tr_b16 v[110:111], v54 offset:2048
    ds_read_b64_tr_b16 v[112:113], v54 offset:8192
    ds_read_b64_tr_b16 v[114:115], v54 offset:10240
    s_waitcnt lgkmcnt(0)
    v_add_u32 v54, 0x18000, v53
    ds_read_b64_tr_b16 v[116:117], v54 offset:0
    ds_read_b64_tr_b16 v[118:119], v54 offset:2048
    ds_read_b64_tr_b16 v[120:121], v54 offset:8192
    ds_read_b64_tr_b16 v[122:123], v54 offset:10240
    s_waitcnt lgkmcnt(0)
    s_barrier
    s_lshl_b32 s23, s20, 14
    s_add_u32 s23, s23, 0x10000
    v_lshlrev_b32 v54, 4, v0
    v_add_u32 v54, s23, v54
    ds_write_b128 v54, v[60:63] offset:0
    ds_write_b128 v54, v[64:67] offset:1024
    s_waitcnt lgkmcnt(0)
    ds_write_b128 v54, v[68:71] offset:2048
    ds_write_b128 v54, v[72:75] offset:3072
    s_waitcnt lgkmcnt(0)
    ds_write_b128 v54, v[76:79] offset:4096
    ds_write_b128 v54, v[80:83] offset:5120
    s_waitcnt lgkmcnt(0)
    ds_write_b128 v54, v[84:87] offset:6144
    ds_write_b128 v54, v[88:91] offset:7168
    s_waitcnt lgkmcnt(0)
    ds_write_b128 v54, v[92:95] offset:8192
    ds_write_b128 v54, v[96:99] offset:9216
    s_waitcnt lgkmcnt(0)
    ds_write_b128 v54, v[100:103] offset:10240
    ds_write_b128 v54, v[104:107] offset:11264
    s_waitcnt lgkmcnt(0)
    ds_write_b128 v54, v[108:111] offset:12288
    ds_write_b128 v54, v[112:115] offset:13312
    s_waitcnt lgkmcnt(0)
    ds_write_b128 v54, v[116:119] offset:14336
    ds_write_b128 v54, v[120:123] offset:15360
    s_waitcnt lgkmcnt(0)
    s_waitcnt lgkmcnt(0)
    s_barrier
    s_mov_b32 s8, 0x3030303
    s_mov_b32 s9, 0x3030303
    s_mov_b32 s10, 0xc0c0c0c
    s_mov_b32 s11, 0xc0c0c0c
    s_mov_b32 s12, 0x30303030
    s_mov_b32 s13, 0x30303030
    s_mov_b32 s14, 0xc0c0c0c0
    s_mov_b32 s15, 0xc0c0c0c0
    s_mov_b32 s54, 0x3f803f80
    s_mov_b32 s56, 0x3f003f00
    s_mov_b32 s55, 0x3f803f80
    s_mov_b32 s57, 0x3f003f00
    s_mov_b32 s46, 0x3e0293ee
    s_mov_b32 s47, 0x3e0293ee
    v_mov_b32 v70, 0
    v_mov_b32 v78, 0
    v_mov_b32 v71, 0
    v_mov_b32 v79, 0
    v_mov_b32 v72, 0
    v_mov_b32 v80, 0
    v_mov_b32 v73, 0
    v_mov_b32 v81, 0
    v_mov_b32 v74, 0
    v_mov_b32 v82, 0
    v_mov_b32 v75, 0
    v_mov_b32 v83, 0
    v_mov_b32 v76, 0
    v_mov_b32 v84, 0
    v_mov_b32 v77, 0
    v_mov_b32 v85, 0
    v_mov_b32 v86, -1
    v_mov_b32 v87, -1
    v_mov_b32 v88, -1
    v_mov_b32 v89, -1
    s_waitcnt vmcnt(0) lgkmcnt(0)
    s_barrier
    s_mov_b32 s41, 0x8100000
    s_mov_b32 s42, 0x8102000
    s_mov_b32 s43, 0x8104000
    s_lshl_b32 s23, s21, 13
    s_lshl_b32 s24, s20, 11
    s_add_u32 s45, s23, s24
    s_mov_b32 s44, 0x8000000
    s_lshl_b32 s23, s21, 12
    s_lshl_b32 s24, s20, 10
    s_add_u32 s23, s23, s24
    s_add_u32 s52, s23, 0x7000000
    s_lshl_b32 s23, s21, 7
    s_add_u32 s53, s23, 0x3000
    s_cmp_eq_u64 s[64:65], 0
    s_cbranch_scc0 CH_SLOW_PH1
CH_FAST_PH1:
    ds_read_b128 v[38:41], v2 offset:0
    ds_read_b128 v[42:45], v2 offset:1024
    ds_read_b128 v[46:49], v2 offset:2048
    ds_read_b128 v[50:53], v2 offset:3072
    ds_read_b128 v[54:57], v2 offset:4096
    ds_read_b128 v[58:61], v2 offset:5120
    ds_read_b128 v[62:65], v2 offset:6144
    ds_read_b128 v[66:69], v2 offset:7168
    s_add_u32 s25, s40, 2
    s_min_u32 s25, s25, 63
    s_and_b32 s25, s25, 3
    s_lshl_b32 s25, s25, 2
    v_mov_b32 v19, s40
    s_xor_b32 s23, s44, 0x40000
    s_add_u32 s23, s23, s45
    s_waitcnt lgkmcnt(7)
    v_smfmac_f32_16x16x64_bf16 v[70:73], v[38:41], a[0:7], v1
    v_smfmac_f32_16x16x64_bf16 v[74:77], v[38:41], a[8:15], v1
    s_waitcnt lgkmcnt(6)
    v_smfmac_f32_16x16x64_bf16 v[70:73], v[42:45], a[16:23], v1
    v_smfmac_f32_16x16x64_bf16 v[74:77], v[42:45], a[24:31], v1
    buffer_store_dwordx4 v[86:89], v11, s[4:7], s23 offen offset:0
    s_waitcnt lgkmcnt(5)
    v_smfmac_f32_16x16x64_bf16 v[70:73], v[46:49], a[32:39], v1
    s_waitcnt vmcnt(1)
    ds_read_b128 v[102:105], v5 offset:0
    v_smfmac_f32_16x16x64_bf16 v[74:77], v[46:49], a[40:47], v1
    ds_read_b128 v[106:109], v5 offset:1024
    buffer_store_dwordx4 v[86:89], v11, s[4:7], s23 offen offset:1024
    s_waitcnt lgkmcnt(6)
    v_smfmac_f32_16x16x64_bf16 v[70:73], v[50:53], a[48:55], v1
    ds_read_b128 v[110:113], v5 offset:2048
    v_smfmac_f32_16x16x64_bf16 v[74:77], v[50:53], a[56:63], v1
    ds_read_b128 v[114:117], v5 offset:3072
    buffer_store_dword v86, v12, s[4:7], s43 offen
    s_waitcnt lgkmcnt(7)
    v_smfmac_f32_16x16x64_bf16 v[70:73], v[54:57], a[64:71], v1
    ds_read_b128 v[20:23], v5 offset:4096
    v_smfmac_f32_16x16x64_bf16 v[74:77], v[54:57], a[72:79], v1
    ds_read_b128 v[24:27], v5 offset:5120
    buffer_load_dword v127, v13, s[4:7], s25 offen sc1
    s_waitcnt lgkmcnt(8)
    v_smfmac_f32_16x16x64_bf16 v[70:73], v[58:61], a[80:87], v1
    ds_read_b128 v[28:31], v5 offset:6144
    v_smfmac_f32_16x16x64_bf16 v[74:77], v[58:61], a[88:95], v1
    ds_read_b128 v[32:35], v5 offset:7168
    buffer_store_dword v19, off, s[4:7], s53 sc1
    s_waitcnt lgkmcnt(9)
    v_smfmac_f32_16x16x64_bf16 v[70:73], v[62:65], a[96:103], v1
    v_smfmac_f32_16x16x64_bf16 v[74:77], v[62:65], a[104:111], v1
    buffer_load_dword v8, v7, s[4:7], s50 offen
    s_waitcnt lgkmcnt(8)
    v_smfmac_f32_16x16x64_bf16 v[70:73], v[66:69], a[112:119], v1
    v_smfmac_f32_16x16x64_bf16 v[74:77], v[66:69], a[120:127], v1
    v_smfmac_f32_16x16x64_bf16 v[78:81], v[38:41], a[128:135], v1
    v_smfmac_f32_16x16x64_bf16 v[82:85], v[38:41], a[136:143], v1
    v_smfmac_f32_16x16x64_bf16 v[78:81], v[42:45], a[144:151], v1
    v_permlane32_swap_b32 v70, v74
    v_permlane32_swap_b32 v71, v75
    v_smfmac_f32_16x16x64_bf16 v[82:85], v[42:45], a[152:159], v1
    v_permlane32_swap_b32 v72, v76
    v_permlane32_swap_b32 v73, v77
    v_smfmac_f32_16x16x64_bf16 v[78:81], v[46:49], a[160:167], v1
    v_pk_add_f32 v[70:71], v[70:71], v[74:75]
    v_pk_add_f32 v[72:73], v[72:73], v[76:77]
    v_smfmac_f32_16x16x64_bf16 v[82:85], v[46:49], a[168:175], v1
    v_cvt_pk_bf16_f32 v18, v70, v71
    v_cvt_pk_bf16_f32 v19, v72, v73
    v_smfmac_f32_16x16x64_bf16 v[78:81], v[50:53], a[176:183], v1
    ds_write_b64 v3, v[18:19]
    v_smfmac_f32_16x16x64_bf16 v[82:85], v[50:53], a[184:191], v1
    v_mov_b64 v[70:71], 0
    v_smfmac_f32_16x16x64_bf16 v[78:81], v[54:57], a[192:199], v1
    v_mov_b64 v[72:73], 0
    v_smfmac_f32_16x16x64_bf16 v[82:85], v[54:57], a[200:207], v1
    v_mov_b64 v[74:75], 0
    v_smfmac_f32_16x16x64_bf16 v[78:81], v[58:61], a[208:215], v1
    v_mov_b64 v[76:77], 0
    v_smfmac_f32_16x16x64_bf16 v[82:85], v[58:61], a[216:223], v1
    s_waitcnt lgkmcnt(0)
    s_barrier
    ds_read_b64_tr_b16 v[86:87], v4 offset:0
    ds_read_b64_tr_b16 v[88:89], v4 offset:512
    v_smfmac_f32_16x16x64_bf16 v[78:81], v[62:65], a[224:231], v1
    ds_read_b64_tr_b16 v[90:91], v4 offset:1024
    ds_read_b64_tr_b16 v[92:93], v4 offset:1536
    v_smfmac_f32_16x16x64_bf16 v[82:85], v[62:65], a[232:239], v1
    ds_read_b64_tr_b16 v[94:95], v4 offset:2048
    ds_read_b64_tr_b16 v[96:97], v4 offset:2560
    v_smfmac_f32_16x16x64_bf16 v[78:81], v[66:69], a[240:247], v1
    ds_read_b64_tr_b16 v[98:99], v4 offset:3072
    ds_read_b64_tr_b16 v[100:101], v4 offset:3584
    v_smfmac_f32_16x16x64_bf16 v[82:85], v[66:69], a[248:255], v1
    s_mov_b32 m0, s51
    v_smfmac_f32_16x16x64_bf16 v[70:73], v[38:41], v[128:135], v1
    v_smfmac_f32_16x16x64_bf16 v[74:77], v[38:41], v[136:143], v1
    v_permlane32_swap_b32 v78, v82
    v_permlane32_swap_b32 v79, v83
    v_permlane32_swap_b32 v80, v84
    v_permlane32_swap_b32 v81, v85
    v_smfmac_f32_16x16x64_bf16 v[70:73], v[42:45], v[144:151], v1
    v_pk_add_f32 v[78:79], v[78:79], v[82:83]
    v_pk_add_f32 v[80:81], v[80:81], v[84:85]
    v_cvt_pk_bf16_f32 v18, v78, v79
    v_cvt_pk_bf16_f32 v19, v80, v81
    ds_write_b64 v3, v[18:19] offset:16
    v_smfmac_f32_16x16x64_bf16 v[74:77], v[42:45], v[152:159], v1
    s_waitcnt lgkmcnt(7)
    v_mfma_f32_16x16x32_bf16 v[118:121], v[102:105], v[86:89], 0
    s_waitcnt lgkmcnt(5)
    v_mfma_f32_16x16x32_bf16 v[118:121], v[106:109], v[90:93], v[118:121]
    s_waitcnt lgkmcnt(3)
    v_mfma_f32_16x16x32_bf16 v[118:121], v[110:113], v[94:97], v[118:121]
    s_waitcnt lgkmcnt(1)
    v_mfma_f32_16x16x32_bf16 v[118:121], v[114:117], v[98:101], v[118:121]
    v_smfmac_f32_16x16x64_bf16 v[70:73], v[46:49], v[160:167], v1
    v_smfmac_f32_16x16x64_bf16 v[74:77], v[46:49], v[168:175], v1
    s_waitcnt lgkmcnt(0)
    s_barrier
    ds_read_b64_tr_b16 v[102:103], v4 offset:16
    ds_read_b64_tr_b16 v[104:105], v4 offset:528
    v_mfma_f32_16x16x32_bf16 v[122:125], v[20:23], v[86:89], 0
    ds_read_b64_tr_b16 v[106:107], v4 offset:1040
    ds_read_b64_tr_b16 v[108:109], v4 offset:1552
    v_mfma_f32_16x16x32_bf16 v[122:125], v[24:27], v[90:93], v[122:125]
    ds_read_b64_tr_b16 v[110:111], v4 offset:2064
    ds_read_b64_tr_b16 v[112:113], v4 offset:2576
    v_mfma_f32_16x16x32_bf16 v[122:125], v[28:31], v[94:97], v[122:125]
    ds_read_b64_tr_b16 v[114:115], v4 offset:3088
    ds_read_b64_tr_b16 v[116:117], v4 offset:3600
    v_mfma_f32_16x16x32_bf16 v[122:125], v[32:35], v[98:101], v[122:125]
    s_lshl_b32 s23, s20, 11
    v_add_u32 v18, s23, v5
    ds_read_b128 v[30:33], v18 offset:8192
    ds_read_b128 v[34:37], v18 offset:9216
    v_smfmac_f32_16x16x64_bf16 v[70:73], v[50:53], v[176:183], v1
    v_max3_f32 v82, v118, v119, v120
    s_lshl_b32 s23, s20, 10
    v_add_u32 v18, s23, v4
    v_smfmac_f32_16x16x64_bf16 v[74:77], v[50:53], v[184:191], v1
    v_max3_f32 v83, v121, v122, v123
    v_max3_f32 v82, v82, v124, v125
    v_max_f32 v82, v82, v83
    s_waitcnt lgkmcnt(8)
    v_mfma_f32_16x16x32_bf16 v[78:81], v[102:105], v[86:89], 0
    s_waitcnt lgkmcnt(6)
    v_mfma_f32_16x16x32_bf16 v[78:81], v[106:109], v[90:93], v[78:81]
    s_waitcnt lgkmcnt(4)
    v_mfma_f32_16x16x32_bf16 v[78:81], v[110:113], v[94:97], v[78:81]
    s_waitcnt lgkmcnt(2)
    v_mfma_f32_16x16x32_bf16 v[78:81], v[114:117], v[98:101], v[78:81]
    ds_read_b64_tr_b16 v[114:115], v18 offset:16
    ds_read_b64_tr_b16 v[116:117], v18 offset:528
    v_mov_b32 v83, v82
    v_smfmac_f32_16x16x64_bf16 v[70:73], v[54:57], v[192:199], v1
    s_nop 0
    v_permlane32_swap_b32 v82, v83
    v_max_f32 v82, v82, v83
    v_mov_b32 v83, v82
    v_smfmac_f32_16x16x64_bf16 v[74:77], v[54:57], v[200:207], v1
    s_nop 0
    v_permlane16_swap_b32 v82, v83
    v_max_f32 v82, v82, v83
    v_max3_f32 v83, v78, v79, v80
    v_max3_f32 v82, v82, v83, v81
    v_mov_b32 v83, v82
    v_smfmac_f32_16x16x64_bf16 v[70:73], v[58:61], v[208:215], v1
    s_nop 0
    v_permlane16_swap_b32 v82, v83
    v_max_f32 v82, v82, v83
    v_smfmac_f32_16x16x64_bf16 v[74:77], v[58:61], v[216:223], v1
    v_mul_f32_e64 v82, -s46, v82
    v_fma_f32 v118, v118, s46, v82
    v_fma_f32 v119, v119, s46, v82
    v_smfmac_f32_16x16x64_bf16 v[70:73], v[62:65], v[224:231], v1
    v_fma_f32 v120, v120, s46, v82
    v_fma_f32 v121, v121, s46, v82
    v_smfmac_f32_16x16x64_bf16 v[74:77], v[62:65], v[232:239], v1
    v_fma_f32 v122, v122, s46, v82
    v_fma_f32 v123, v123, s46, v82
    v_smfmac_f32_16x16x64_bf16 v[70:73], v[66:69], v[240:247], v1
    v_fma_f32 v124, v124, s46, v82
    v_fma_f32 v125, v125, s46, v82
    v_smfmac_f32_16x16x64_bf16 v[74:77], v[66:69], v[248:255], v1
    v_fma_f32 v78, v78, s46, v82
    v_fma_f32 v79, v79, s46, v82
    v_fma_f32 v80, v80, s46, v82
    v_fma_f32 v81, v81, s46, v82
    s_waitcnt lgkmcnt(0)
    buffer_store_dwordx4 v[114:117], v11, s[4:7], s52 offen sc1
    v_exp_f32 v118, v118
    v_exp_f32 v119, v119
    v_exp_f32 v120, v120
    v_exp_f32 v121, v121
    v_exp_f32 v122, v122
    v_exp_f32 v123, v123
    v_exp_f32 v124, v124
    v_exp_f32 v125, v125
    v_exp_f32 v78, v78
    v_exp_f32 v79, v79
    v_exp_f32 v80, v80
    v_exp_f32 v81, v81
    v_cvt_pk_bf16_f32 v102, v118, v119
    v_cvt_pk_bf16_f32 v103, v120, v121
    v_cvt_pk_bf16_f32 v104, v122, v123
    v_cvt_pk_bf16_f32 v105, v124, v125
    v_cvt_pk_bf16_f32 v106, v78, v79
    v_cvt_pk_bf16_f32 v107, v80, v81
    v_mov_b64 v[20:21], s[54:55]
    v_mov_b64 v[22:23], s[54:55]
    v_cvt_pk_bf16_f32 v110, v70, v71
    v_cvt_pk_bf16_f32 v111, v72, v73
    v_cvt_pk_bf16_f32 v112, v74, v75
    v_cvt_pk_bf16_f32 v113, v76, v77
    s_add_u32 s23, s52, 0x800000
    v_lshrrev_b32 v18, 1, v11
    v_mov_b64 v[24:25], s[56:57]
    s_cmp_eq_u32 s40, 63
    v_mfma_f32_16x16x32_bf16 v[82:85], v[20:23], v[102:105], 0
    v_mfma_f32_16x16x32_bf16 v[118:121], v[30:33], v[102:105], 0
    ds_read_b128 v[86:89], v14 offset:0
    ds_read_b128 v[90:93], v14 offset:1024
    v_mfma_f32_16x16x32_bf16 v[122:125], v[34:37], v[102:105], 0
    ds_read_b128 v[94:97], v14 offset:2048
    ds_read_b128 v[98:101], v14 offset:3072
    v_mfma_f32_16x16x16_bf16 v[82:85], v[24:25], v[106:107], v[82:85]
    ds_read_b128 v[38:41], v14 offset:4096
    ds_read_b128 v[42:45], v14 offset:5120
    v_mfma_f32_16x16x16_bf16 v[118:121], v[110:111], v[106:107], v[118:121]
    ds_read_b128 v[46:49], v14 offset:6144
    ds_read_b128 v[50:53], v14 offset:7168
    v_mfma_f32_16x16x16_bf16 v[122:125], v[112:113], v[106:107], v[122:125]
    buffer_store_dwordx2 v[110:111], v18, s[4:7], s23 offen offset:0 sc1
    buffer_store_dwordx2 v[112:113], v18, s[4:7], s23 offen offset:512 sc1
    s_cbranch_scc1 CH_FAST_DONE
    buffer_load_dwordx4 v11, s[4:7], s50 offen offset:0 lds
    v_mov_b64 v[70:71], 0
    v_mov_b64 v[72:73], 0
    v_mov_b64 v[74:75], 0
    v_mov_b64 v[76:77], 0
    v_rcp_f32 v82, v82
    s_nop 0
    v_pk_mul_f32 v[118:119], v[118:119], v[82:83] op_sel_hi:[1,0]
    v_pk_mul_f32 v[120:121], v[120:121], v[82:83] op_sel_hi:[1,0]
    v_pk_mul_f32 v[122:123], v[122:123], v[82:83] op_sel_hi:[1,0]
    v_pk_mul_f32 v[124:125], v[124:125], v[82:83] op_sel_hi:[1,0]
    v_cvt_pk_bf16_f32 v102, v118, v119
    v_cvt_pk_bf16_f32 v103, v120, v121
    v_cvt_pk_bf16_f32 v104, v122, v123
    v_cvt_pk_bf16_f32 v105, v124, v125
    ds_write_b128 v6, v[102:105]
    v_mov_b64 v[30:31], 0
    v_mov_b64 v[32:33], 0
    v_mov_b64 v[34:35], 0
    v_mov_b64 v[36:37], 0
    ds_read_b128 v[54:57], v15 offset:0
    ds_read_b128 v[58:61], v15 offset:1024
    ds_read_b128 v[62:65], v15 offset:2048
    ds_read_b128 v[66:69], v15 offset:3072
    ds_read_b128 v[78:81], v15 offset:4096
    ds_read_b128 v[82:85], v15 offset:5120
    ds_read_b128 v[118:121], v15 offset:6144
    ds_read_b128 v[122:125], v15 offset:7168
    buffer_load_dwordx4 v11, s[4:7], s50 offen offset:1024 lds
    v_xor_b32 v18, 512, v6
    v_xor_b32 v19, 1024, v6
    s_add_u32 s23, s51, 8192
    s_mov_b32 m0, s23
    s_add_u32 s24, s50, 0x1000000
    s_waitcnt lgkmcnt(8)
    s_barrier
    ds_read_b128 v[106:109], v18
    v_xor_b32 v18, 512, v19
    ds_read_b128 v[110:113], v19
    ds_read_b128 v[114:117], v18
    v_smfmac_f32_16x16x64_bf16 v[70:73], v[102:105], v[86:93], v1
    ds_read_b128 v[86:89], v16 offset:0
    ds_read_b128 v[90:93], v16 offset:1024
    v_smfmac_f32_16x16x64_bf16 v[74:77], v[102:105], v[94:101], v1
    ds_read_b128 v[94:97], v16 offset:2048
    ds_read_b128 v[98:101], v16 offset:3072
    v_smfmac_f32_16x16x64_bf16 v[30:33], v[102:105], v[38:45], v1
    ds_read_b128 v[38:41], v16 offset:4096
    ds_read_b128 v[42:45], v16 offset:5120
    v_smfmac_f32_16x16x64_bf16 v[34:37], v[102:105], v[46:53], v1
    ds_read_b128 v[46:49], v16 offset:6144
    ds_read_b128 v[50:53], v16 offset:7168
    buffer_load_dwordx4 v11, s[4:7], s24 offen offset:0 lds
    s_waitcnt lgkmcnt(10)
    v_smfmac_f32_16x16x64_bf16 v[70:73], v[106:109], v[54:61], v1
    ds_read_b128 v[54:57], v17 offset:0
    ds_read_b128 v[58:61], v17 offset:1024
    v_smfmac_f32_16x16x64_bf16 v[74:77], v[106:109], v[62:69], v1
    ds_read_b128 v[62:65], v17 offset:2048
    ds_read_b128 v[66:69], v17 offset:3072
    v_smfmac_f32_16x16x64_bf16 v[30:33], v[106:109], v[78:85], v1
    ds_read_b128 v[78:81], v17 offset:4096
    ds_read_b128 v[82:85], v17 offset:5120
    v_smfmac_f32_16x16x64_bf16 v[34:37], v[106:109], v[118:125], v1
    ds_read_b128 v[118:121], v17 offset:6144
    ds_read_b128 v[122:125], v17 offset:7168
    buffer_load_dwordx4 v11, s[4:7], s24 offen offset:1024 lds
    s_waitcnt lgkmcnt(15)
    s_waitcnt lgkmcnt(14)
    v_smfmac_f32_16x16x64_bf16 v[70:73], v[110:113], v[86:93], v1
    s_waitcnt lgkmcnt(12)
    v_smfmac_f32_16x16x64_bf16 v[74:77], v[110:113], v[94:101], v1
    s_waitcnt lgkmcnt(6)
    v_smfmac_f32_16x16x64_bf16 v[70:73], v[114:117], v[54:61], v1
    s_waitcnt lgkmcnt(4)
    v_smfmac_f32_16x16x64_bf16 v[74:77], v[114:117], v[62:69], v1
    v_smfmac_f32_16x16x64_bf16 v[30:33], v[110:113], v[38:45], v1
    v_smfmac_f32_16x16x64_bf16 v[34:37], v[110:113], v[46:53], v1
    v_cvt_pk_bf16_f32 v102, v70, v71
    v_cvt_pk_bf16_f32 v103, v72, v73
    s_add_u32 s23, s44, 0
    buffer_store_dwordx2 v[102:103], v10, s[4:7], s23 offen
    s_waitcnt lgkmcnt(2)
    v_smfmac_f32_16x16x64_bf16 v[30:33], v[114:117], v[78:85], v1
    s_waitcnt lgkmcnt(0)
    v_smfmac_f32_16x16x64_bf16 v[34:37], v[114:117], v[118:125], v1
    v_cvt_pk_bf16_f32 v104, v74, v75
    v_cvt_pk_bf16_f32 v105, v76, v77
    s_add_u32 s23, s44, 16384
    buffer_store_dwordx2 v[104:105], v10, s[4:7], s23 offen
    v_cvt_pk_bf16_f32 v106, v30, v31
    v_cvt_pk_bf16_f32 v107, v32, v33
    s_add_u32 s23, s44, 32768
    buffer_store_dwordx2 v[106:107], v10, s[4:7], s23 offen
    v_cvt_pk_bf16_f32 v108, v34, v35
    v_cvt_pk_bf16_f32 v109, v36, v37
    s_add_u32 s23, s44, 49152
    buffer_store_dwordx2 v[108:109], v10, s[4:7], s23 offen
    s_add_u32 s48, s44, s45
    v_cndmask_b32 v118, 0, v9, s[8:9]
    v_cndmask_b32 v119, 0, v9, s[10:11]
    v_cndmask_b32 v120, 0, v9, s[12:13]
    v_cndmask_b32 v121, 0, v9, s[14:15]
    v_mov_b64 v[70:71], 0
    v_mov_b64 v[72:73], 0
    v_mov_b64 v[74:75], 0
    v_mov_b64 v[76:77], 0
    s_add_u32 s40, s40, 1
    s_xor_b32 s44, s44, 0x40000
    s_mov_b32 s23, s41
    s_mov_b32 s41, s42
    s_mov_b32 s42, s43
    s_mov_b32 s43, s23
    s_lshl_b32 s24, s20, 11
    s_add_u32 s28, s41, s24
    s_add_u32 s24, s24, 0x20000
    s_add_u32 s52, s52, 0x20000
    s_cmp_lt_u32 s40, 63
    s_cselect_b32 s23, 0x40000, 0
    s_add_u32 s50, s50, s23
    s_sleep 2
    s_mov_b32 s25, 32768
    buffer_load_dwordx4 v[38:41], v11, s[4:7], s48 offen offset:0 sc1
    buffer_load_dwordx4 v[42:45], v11, s[4:7], s48 offen offset:1024 sc1
    s_sleep 3
    buffer_load_dwordx4 v[46:49], v11, s[4:7], s48 offen offset:0 sc1
    buffer_load_dwordx4 v[50:53], v11, s[4:7], s48 offen offset:1024 sc1
CH_FAST_POLL1:
    s_waitcnt vmcnt(2)
    v_max3_u32 v18, v38, v39, v40
    v_max3_u32 v19, v41, v42, v43
    v_max3_u32 v18, v18, v44, v45
    v_max_u32 v18, v18, v19
    v_cmp_eq_u32 vcc, -1, v18
    s_sub_u32 s25, s25, 1
    s_cbranch_scc1 CH_FAST_POLL1E_0
    s_nop 2
    s_cbranch_vccz CH_FAST_POLL1E_0
    buffer_load_dwordx4 v[38:41], v11, s[4:7], s48 offen offset:0 sc1
    buffer_load_dwordx4 v[42:45], v11, s[4:7], s48 offen offset:1024 sc1
    s_waitcnt vmcnt(2)
    v_max3_u32 v18, v46, v47, v48
    v_max3_u32 v19, v49, v50, v51
    v_max3_u32 v18, v18, v52, v53
    v_max_u32 v18, v18, v19
    v_cmp_eq_u32 vcc, -1, v18
    s_nop 4
    s_cbranch_vccz CH_FAST_POLL1E_1
    buffer_load_dwordx4 v[46:49], v11, s[4:7], s48 offen offset:0 sc1
    buffer_load_dwordx4 v[50:53], v11, s[4:7], s48 offen offset:1024 sc1
    s_branch CH_FAST_POLL1
CH_FAST_POLL1E_1:
    v_mfma_f32_16x16x32_bf16 v[78:81], v[46:49], v[118:121], 0
    v_mfma_f32_16x16x32_bf16 v[78:81], v[50:53], v[118:121], v[78:81]
    s_branch CH_FAST_POLL1J
CH_FAST_POLL1E_0:
    s_nop 4
    s_nop 1
    v_mfma_f32_16x16x32_bf16 v[78:81], v[38:41], v[118:121], 0
    v_mfma_f32_16x16x32_bf16 v[78:81], v[42:45], v[118:121], v[78:81]
CH_FAST_POLL1J:
    s_add_u32 s23, s40, 1
    s_min_u32 s23, s23, 63
    s_lshr_b32 s23, s23, 2
    s_add_u32 s23, s23, 1
    v_cmp_gt_u32 vcc, s23, v127
    v_add_u32 v8, s24, v11
    s_nop 1
    v_permlane32_swap_b32 v78, v80
    s_nop 0
    v_permlane32_swap_b32 v79, v81
    v_pk_add_f32 v[78:79], v[78:79], v[80:81]
    s_nop 1
    v_permlane16_swap_b32 v78, v79
    v_add_f32 v78, v78, v79
    v_mov_b32 v79, v78
    s_nop 1
    v_permlane16_swap_b32 v78, v79
    v_cvt_pk_bf16_f32 v18, v78, v79
    buffer_store_dword v18, v12, s[4:7], s41 offen
    s_cbranch_vccz CH_FAST_KVOK
    s_add_u32 s23, s40, 1
    s_min_u32 s23, s23, 63
    s_and_b32 s24, s23, 3
    s_lshl_b32 s24, s24, 2
    s_lshr_b32 s23, s23, 2
    s_add_u32 s23, s23, 1
    s_mov_b32 s25, 32768
WKV_18:
    buffer_load_dword v18, v13, s[4:7], s24 offen sc1
    s_waitcnt vmcnt(0)
    v_cmp_gt_u32 vcc, s23, v18
    s_sub_u32 s25, s25, 1
    s_cbranch_scc1 WKVE_19
    s_nop 2
    s_cbranch_vccz WKVE_19
    s_sleep 1
    s_branch WKV_18
WKVE_19:
CH_FAST_KVOK:
    v_mov_b64 v[86:87], -1
    v_mov_b64 v[88:89], -1
    v_mov_b64 v[78:79], 0
    v_mov_b64 v[80:81], 0
    v_mov_b64 v[82:83], 0
    v_mov_b64 v[84:85], 0
    s_sleep 2
    s_mov_b32 s25, 32768
    buffer_load_dwordx4 v[102:105], v11, s[4:7], s28 offen offset:0 sc1
    buffer_load_dwordx4 v[106:109], v11, s[4:7], s28 offen offset:1024 sc1
    s_sleep 3
    buffer_load_dwordx4 v[110:113], v11, s[4:7], s28 offen offset:0 sc1
    buffer_load_dwordx4 v[114:117], v11, s[4:7], s28 offen offset:1024 sc1
CH_FAST_POLL2:
    s_waitcnt vmcnt(2)
    v_max3_u32 v18, v102, v103, v104
    v_max3_u32 v19, v105, v106, v107
    v_max3_u32 v18, v18, v108, v109
    v_max_u32 v18, v18, v19
    v_cmp_eq_u32 vcc, -1, v18
    s_sub_u32 s25, s25, 1
    s_cbranch_scc1 CH_FAST_POLL2E_0
    s_nop 2
    s_cbranch_vccz CH_FAST_POLL2E_0
    buffer_load_dwordx4 v[102:105], v11, s[4:7], s28 offen offset:0 sc1
    buffer_load_dwordx4 v[106:109], v11, s[4:7], s28 offen offset:1024 sc1
    s_waitcnt vmcnt(2)
    v_max3_u32 v18, v110, v111, v112
    v_max3_u32 v19, v113, v114, v115
    v_max3_u32 v18, v18, v116, v117
    v_max_u32 v18, v18, v19
    v_cmp_eq_u32 vcc, -1, v18
    s_nop 4
    s_cbranch_vccz CH_FAST_POLL2E_1
    buffer_load_dwordx4 v[110:113], v11, s[4:7], s28 offen offset:0 sc1
    buffer_load_dwordx4 v[114:117], v11, s[4:7], s28 offen offset:1024 sc1
    s_branch CH_FAST_POLL2
CH_FAST_POLL2E_1:
    ds_write_b128 v8, v[110:113] offset:0
    ds_write_b128 v8, v[114:117] offset:1024
    s_branch CH_FAST_POLL2J
CH_FAST_POLL2E_0:
    ds_write_b128 v8, v[102:105] offset:0
    ds_write_b128 v8, v[106:109] offset:1024
CH_FAST_POLL2J:
    s_waitcnt lgkmcnt(0)
    s_barrier
    s_branch CH_FAST_PH1
CH_FAST_DONE:
    s_waitcnt vmcnt(0) lgkmcnt(0)
    s_barrier
    v_mov_b32 v19, 64
    buffer_store_dword v19, off, s[4:7], s53 sc1
    s_waitcnt vmcnt(0)
    s_endpgm
CH_SLOW_PH1:
    ds_read_b128 v[38:41], v2 offset:0
    ds_read_b128 v[42:45], v2 offset:1024
    ds_read_b128 v[46:49], v2 offset:2048
    ds_read_b128 v[50:53], v2 offset:3072
    ds_read_b128 v[54:57], v2 offset:4096
    ds_read_b128 v[58:61], v2 offset:5120
    ds_read_b128 v[62:65], v2 offset:6144
    ds_read_b128 v[66:69], v2 offset:7168
    s_add_u32 s25, s40, 2
    s_min_u32 s25, s25, 63
    s_and_b32 s25, s25, 3
    s_lshl_b32 s25, s25, 2
    v_mov_b32 v19, s40
    s_xor_b32 s23, s44, 0x40000
    s_add_u32 s23, s23, s45
    s_waitcnt lgkmcnt(7)
    v_smfmac_f32_16x16x64_bf16 v[70:73], v[38:41], a[0:7], v1
    v_smfmac_f32_16x16x64_bf16 v[74:77], v[38:41], a[8:15], v1
    s_waitcnt lgkmcnt(6)
    v_smfmac_f32_16x16x64_bf16 v[70:73], v[42:45], a[16:23], v1
    v_smfmac_f32_16x16x64_bf16 v[74:77], v[42:45], a[24:31], v1
    buffer_store_dwordx4 v[86:89], v11, s[4:7], s23 offen offset:0 sc1
    s_waitcnt lgkmcnt(5)
    v_smfmac_f32_16x16x64_bf16 v[70:73], v[46:49], a[32:39], v1
    s_waitcnt vmcnt(1)
    ds_read_b128 v[102:105], v5 offset:0
    v_smfmac_f32_16x16x64_bf16 v[74:77], v[46:49], a[40:47], v1
    ds_read_b128 v[106:109], v5 offset:1024
    buffer_store_dwordx4 v[86:89], v11, s[4:7], s23 offen offset:1024 sc1
    s_waitcnt lgkmcnt(6)
    v_smfmac_f32_16x16x64_bf16 v[70:73], v[50:53], a[48:55], v1
    ds_read_b128 v[110:113], v5 offset:2048
    v_smfmac_f32_16x16x64_bf16 v[74:77], v[50:53], a[56:63], v1
    ds_read_b128 v[114:117], v5 offset:3072
    buffer_store_dword v86, v12, s[4:7], s43 offen sc1
    s_waitcnt lgkmcnt(7)
    v_smfmac_f32_16x16x64_bf16 v[70:73], v[54:57], a[64:71], v1
    ds_read_b128 v[20:23], v5 offset:4096
    v_smfmac_f32_16x16x64_bf16 v[74:77], v[54:57], a[72:79], v1
    ds_read_b128 v[24:27], v5 offset:5120
    buffer_load_dword v127, v13, s[4:7], s25 offen sc1
    s_waitcnt lgkmcnt(8)
    v_smfmac_f32_16x16x64_bf16 v[70:73], v[58:61], a[80:87], v1
    ds_read_b128 v[28:31], v5 offset:6144
    v_smfmac_f32_16x16x64_bf16 v[74:77], v[58:61], a[88:95], v1
    ds_read_b128 v[32:35], v5 offset:7168
    buffer_store_dword v19, off, s[4:7], s53 sc1
    s_waitcnt lgkmcnt(9)
    v_smfmac_f32_16x16x64_bf16 v[70:73], v[62:65], a[96:103], v1
    v_smfmac_f32_16x16x64_bf16 v[74:77], v[62:65], a[104:111], v1
    buffer_load_dword v8, v7, s[4:7], s50 offen
    s_waitcnt lgkmcnt(8)
    v_smfmac_f32_16x16x64_bf16 v[70:73], v[66:69], a[112:119], v1
    v_smfmac_f32_16x16x64_bf16 v[74:77], v[66:69], a[120:127], v1
    v_smfmac_f32_16x16x64_bf16 v[78:81], v[38:41], a[128:135], v1
    v_smfmac_f32_16x16x64_bf16 v[82:85], v[38:41], a[136:143], v1
    v_smfmac_f32_16x16x64_bf16 v[78:81], v[42:45], a[144:151], v1
    v_permlane32_swap_b32 v70, v74
    v_permlane32_swap_b32 v71, v75
    v_smfmac_f32_16x16x64_bf16 v[82:85], v[42:45], a[152:159], v1
    v_permlane32_swap_b32 v72, v76
    v_permlane32_swap_b32 v73, v77
    v_smfmac_f32_16x16x64_bf16 v[78:81], v[46:49], a[160:167], v1
    v_pk_add_f32 v[70:71], v[70:71], v[74:75]
    v_pk_add_f32 v[72:73], v[72:73], v[76:77]
    v_smfmac_f32_16x16x64_bf16 v[82:85], v[46:49], a[168:175], v1
    v_cvt_pk_bf16_f32 v18, v70, v71
    v_cvt_pk_bf16_f32 v19, v72, v73
    v_smfmac_f32_16x16x64_bf16 v[78:81], v[50:53], a[176:183], v1
    ds_write_b64 v3, v[18:19]
    v_smfmac_f32_16x16x64_bf16 v[82:85], v[50:53], a[184:191], v1
    v_mov_b64 v[70:71], 0
    v_smfmac_f32_16x16x64_bf16 v[78:81], v[54:57], a[192:199], v1
    v_mov_b64 v[72:73], 0
    v_smfmac_f32_16x16x64_bf16 v[82:85], v[54:57], a[200:207], v1
    v_mov_b64 v[74:75], 0
    v_smfmac_f32_16x16x64_bf16 v[78:81], v[58:61], a[208:215], v1
    v_mov_b64 v[76:77], 0
    v_smfmac_f32_16x16x64_bf16 v[82:85], v[58:61], a[216:223], v1
    s_waitcnt lgkmcnt(0)
    s_barrier
    ds_read_b64_tr_b16 v[86:87], v4 offset:0
    ds_read_b64_tr_b16 v[88:89], v4 offset:512
    v_smfmac_f32_16x16x64_bf16 v[78:81], v[62:65], a[224:231], v1
    ds_read_b64_tr_b16 v[90:91], v4 offset:1024
    ds_read_b64_tr_b16 v[92:93], v4 offset:1536
    v_smfmac_f32_16x16x64_bf16 v[82:85], v[62:65], a[232:239], v1
    ds_read_b64_tr_b16 v[94:95], v4 offset:2048
    ds_read_b64_tr_b16 v[96:97], v4 offset:2560
    v_smfmac_f32_16x16x64_bf16 v[78:81], v[66:69], a[240:247], v1
    ds_read_b64_tr_b16 v[98:99], v4 offset:3072
    ds_read_b64_tr_b16 v[100:101], v4 offset:3584
    v_smfmac_f32_16x16x64_bf16 v[82:85], v[66:69], a[248:255], v1
    s_mov_b32 m0, s51
    v_smfmac_f32_16x16x64_bf16 v[70:73], v[38:41], v[128:135], v1
    v_smfmac_f32_16x16x64_bf16 v[74:77], v[38:41], v[136:143], v1
    v_permlane32_swap_b32 v78, v82
    v_permlane32_swap_b32 v79, v83
    v_permlane32_swap_b32 v80, v84
    v_permlane32_swap_b32 v81, v85
    v_smfmac_f32_16x16x64_bf16 v[70:73], v[42:45], v[144:151], v1
    v_pk_add_f32 v[78:79], v[78:79], v[82:83]
    v_pk_add_f32 v[80:81], v[80:81], v[84:85]
    v_cvt_pk_bf16_f32 v18, v78, v79
    v_cvt_pk_bf16_f32 v19, v80, v81
    ds_write_b64 v3, v[18:19] offset:16
    v_smfmac_f32_16x16x64_bf16 v[74:77], v[42:45], v[152:159], v1
    s_waitcnt lgkmcnt(7)
    v_mfma_f32_16x16x32_bf16 v[118:121], v[102:105], v[86:89], 0
    s_waitcnt lgkmcnt(5)
    v_mfma_f32_16x16x32_bf16 v[118:121], v[106:109], v[90:93], v[118:121]
    s_waitcnt lgkmcnt(3)
    v_mfma_f32_16x16x32_bf16 v[118:121], v[110:113], v[94:97], v[118:121]
    s_waitcnt lgkmcnt(1)
    v_mfma_f32_16x16x32_bf16 v[118:121], v[114:117], v[98:101], v[118:121]
    v_smfmac_f32_16x16x64_bf16 v[70:73], v[46:49], v[160:167], v1
    v_smfmac_f32_16x16x64_bf16 v[74:77], v[46:49], v[168:175], v1
    s_waitcnt lgkmcnt(0)
    s_barrier
    ds_read_b64_tr_b16 v[102:103], v4 offset:16
    ds_read_b64_tr_b16 v[104:105], v4 offset:528
    v_mfma_f32_16x16x32_bf16 v[122:125], v[20:23], v[86:89], 0
    ds_read_b64_tr_b16 v[106:107], v4 offset:1040
    ds_read_b64_tr_b16 v[108:109], v4 offset:1552
    v_mfma_f32_16x16x32_bf16 v[122:125], v[24:27], v[90:93], v[122:125]
    ds_read_b64_tr_b16 v[110:111], v4 offset:2064
    ds_read_b64_tr_b16 v[112:113], v4 offset:2576
    v_mfma_f32_16x16x32_bf16 v[122:125], v[28:31], v[94:97], v[122:125]
    ds_read_b64_tr_b16 v[114:115], v4 offset:3088
    ds_read_b64_tr_b16 v[116:117], v4 offset:3600
    v_mfma_f32_16x16x32_bf16 v[122:125], v[32:35], v[98:101], v[122:125]
    s_lshl_b32 s23, s20, 11
    v_add_u32 v18, s23, v5
    ds_read_b128 v[30:33], v18 offset:8192
    ds_read_b128 v[34:37], v18 offset:9216
    v_smfmac_f32_16x16x64_bf16 v[70:73], v[50:53], v[176:183], v1
    v_max3_f32 v82, v118, v119, v120
    s_lshl_b32 s23, s20, 10
    v_add_u32 v18, s23, v4
    v_smfmac_f32_16x16x64_bf16 v[74:77], v[50:53], v[184:191], v1
    v_max3_f32 v83, v121, v122, v123
    v_max3_f32 v82, v82, v124, v125
    v_max_f32 v82, v82, v83
    s_waitcnt lgkmcnt(8)
    v_mfma_f32_16x16x32_bf16 v[78:81], v[102:105], v[86:89], 0
    s_waitcnt lgkmcnt(6)
    v_mfma_f32_16x16x32_bf16 v[78:81], v[106:109], v[90:93], v[78:81]
    s_waitcnt lgkmcnt(4)
    v_mfma_f32_16x16x32_bf16 v[78:81], v[110:113], v[94:97], v[78:81]
    s_waitcnt lgkmcnt(2)
    v_mfma_f32_16x16x32_bf16 v[78:81], v[114:117], v[98:101], v[78:81]
    ds_read_b64_tr_b16 v[114:115], v18 offset:16
    ds_read_b64_tr_b16 v[116:117], v18 offset:528
    v_mov_b32 v83, v82
    v_smfmac_f32_16x16x64_bf16 v[70:73], v[54:57], v[192:199], v1
    s_nop 0
    v_permlane32_swap_b32 v82, v83
    v_max_f32 v82, v82, v83
    v_mov_b32 v83, v82
    v_smfmac_f32_16x16x64_bf16 v[74:77], v[54:57], v[200:207], v1
    s_nop 0
    v_permlane16_swap_b32 v82, v83
    v_max_f32 v82, v82, v83
    v_max3_f32 v83, v78, v79, v80
    v_max3_f32 v82, v82, v83, v81
    v_mov_b32 v83, v82
    v_smfmac_f32_16x16x64_bf16 v[70:73], v[58:61], v[208:215], v1
    s_nop 0
    v_permlane16_swap_b32 v82, v83
    v_max_f32 v82, v82, v83
    v_smfmac_f32_16x16x64_bf16 v[74:77], v[58:61], v[216:223], v1
    v_mul_f32_e64 v82, -s46, v82
    v_fma_f32 v118, v118, s46, v82
    v_fma_f32 v119, v119, s46, v82
    v_smfmac_f32_16x16x64_bf16 v[70:73], v[62:65], v[224:231], v1
    v_fma_f32 v120, v120, s46, v82
    v_fma_f32 v121, v121, s46, v82
    v_smfmac_f32_16x16x64_bf16 v[74:77], v[62:65], v[232:239], v1
    v_fma_f32 v122, v122, s46, v82
    v_fma_f32 v123, v123, s46, v82
    v_smfmac_f32_16x16x64_bf16 v[70:73], v[66:69], v[240:247], v1
    v_fma_f32 v124, v124, s46, v82
    v_fma_f32 v125, v125, s46, v82
    v_smfmac_f32_16x16x64_bf16 v[74:77], v[66:69], v[248:255], v1
    v_fma_f32 v78, v78, s46, v82
    v_fma_f32 v79, v79, s46, v82
    v_fma_f32 v80, v80, s46, v82
    v_fma_f32 v81, v81, s46, v82
    s_waitcnt lgkmcnt(0)
    buffer_store_dwordx4 v[114:117], v11, s[4:7], s52 offen sc1
    v_exp_f32 v118, v118
    v_exp_f32 v119, v119
    v_exp_f32 v120, v120
    v_exp_f32 v121, v121
    v_exp_f32 v122, v122
    v_exp_f32 v123, v123
    v_exp_f32 v124, v124
    v_exp_f32 v125, v125
    v_exp_f32 v78, v78
    v_exp_f32 v79, v79
    v_exp_f32 v80, v80
    v_exp_f32 v81, v81
    v_cvt_pk_bf16_f32 v102, v118, v119
    v_cvt_pk_bf16_f32 v103, v120, v121
    v_cvt_pk_bf16_f32 v104, v122, v123
    v_cvt_pk_bf16_f32 v105, v124, v125
    v_cvt_pk_bf16_f32 v106, v78, v79
    v_cvt_pk_bf16_f32 v107, v80, v81
    v_mov_b64 v[20:21], s[54:55]
    v_mov_b64 v[22:23], s[54:55]
    v_cvt_pk_bf16_f32 v110, v70, v71
    v_cvt_pk_bf16_f32 v111, v72, v73
    v_cvt_pk_bf16_f32 v112, v74, v75
    v_cvt_pk_bf16_f32 v113, v76, v77
    s_add_u32 s23, s52, 0x800000
    v_lshrrev_b32 v18, 1, v11
    v_mov_b64 v[24:25], s[56:57]
    s_cmp_eq_u32 s40, 63
    v_mfma_f32_16x16x32_bf16 v[82:85], v[20:23], v[102:105], 0
    v_mfma_f32_16x16x32_bf16 v[118:121], v[30:33], v[102:105], 0
    ds_read_b128 v[86:89], v14 offset:0
    ds_read_b128 v[90:93], v14 offset:1024
    v_mfma_f32_16x16x32_bf16 v[122:125], v[34:37], v[102:105], 0
    ds_read_b128 v[94:97], v14 offset:2048
    ds_read_b128 v[98:101], v14 offset:3072
    v_mfma_f32_16x16x16_bf16 v[82:85], v[24:25], v[106:107], v[82:85]
    ds_read_b128 v[38:41], v14 offset:4096
    ds_read_b128 v[42:45], v14 offset:5120
    v_mfma_f32_16x16x16_bf16 v[118:121], v[110:111], v[106:107], v[118:121]
    ds_read_b128 v[46:49], v14 offset:6144
    ds_read_b128 v[50:53], v14 offset:7168
    v_mfma_f32_16x16x16_bf16 v[122:125], v[112:113], v[106:107], v[122:125]
    buffer_store_dwordx2 v[110:111], v18, s[4:7], s23 offen offset:0 sc1
    buffer_store_dwordx2 v[112:113], v18, s[4:7], s23 offen offset:512 sc1
    s_cbranch_scc1 CH_SLOW_DONE
    buffer_load_dwordx4 v11, s[4:7], s50 offen offset:0 lds
    v_mov_b64 v[70:71], 0
    v_mov_b64 v[72:73], 0
    v_mov_b64 v[74:75], 0
    v_mov_b64 v[76:77], 0
    v_rcp_f32 v82, v82
    s_nop 0
    v_pk_mul_f32 v[118:119], v[118:119], v[82:83] op_sel_hi:[1,0]
    v_pk_mul_f32 v[120:121], v[120:121], v[82:83] op_sel_hi:[1,0]
    v_pk_mul_f32 v[122:123], v[122:123], v[82:83] op_sel_hi:[1,0]
    v_pk_mul_f32 v[124:125], v[124:125], v[82:83] op_sel_hi:[1,0]
    v_cvt_pk_bf16_f32 v102, v118, v119
    v_cvt_pk_bf16_f32 v103, v120, v121
    v_cvt_pk_bf16_f32 v104, v122, v123
    v_cvt_pk_bf16_f32 v105, v124, v125
    ds_write_b128 v6, v[102:105]
    v_mov_b64 v[30:31], 0
    v_mov_b64 v[32:33], 0
    v_mov_b64 v[34:35], 0
    v_mov_b64 v[36:37], 0
    ds_read_b128 v[54:57], v15 offset:0
    ds_read_b128 v[58:61], v15 offset:1024
    ds_read_b128 v[62:65], v15 offset:2048
    ds_read_b128 v[66:69], v15 offset:3072
    ds_read_b128 v[78:81], v15 offset:4096
    ds_read_b128 v[82:85], v15 offset:5120
    ds_read_b128 v[118:121], v15 offset:6144
    ds_read_b128 v[122:125], v15 offset:7168
    buffer_load_dwordx4 v11, s[4:7], s50 offen offset:1024 lds
    v_xor_b32 v18, 512, v6
    v_xor_b32 v19, 1024, v6
    s_add_u32 s23, s51, 8192
    s_mov_b32 m0, s23
    s_add_u32 s24, s50, 0x1000000
    s_waitcnt lgkmcnt(8)
    s_barrier
    ds_read_b128 v[106:109], v18
    v_xor_b32 v18, 512, v19
    ds_read_b128 v[110:113], v19
    ds_read_b128 v[114:117], v18
    v_smfmac_f32_16x16x64_bf16 v[70:73], v[102:105], v[86:93], v1
    ds_read_b128 v[86:89], v16 offset:0
    ds_read_b128 v[90:93], v16 offset:1024
    v_smfmac_f32_16x16x64_bf16 v[74:77], v[102:105], v[94:101], v1
    ds_read_b128 v[94:97], v16 offset:2048
    ds_read_b128 v[98:101], v16 offset:3072
    v_smfmac_f32_16x16x64_bf16 v[30:33], v[102:105], v[38:45], v1
    ds_read_b128 v[38:41], v16 offset:4096
    ds_read_b128 v[42:45], v16 offset:5120
    v_smfmac_f32_16x16x64_bf16 v[34:37], v[102:105], v[46:53], v1
    ds_read_b128 v[46:49], v16 offset:6144
    ds_read_b128 v[50:53], v16 offset:7168
    buffer_load_dwordx4 v11, s[4:7], s24 offen offset:0 lds
    s_waitcnt lgkmcnt(10)
    v_smfmac_f32_16x16x64_bf16 v[70:73], v[106:109], v[54:61], v1
    ds_read_b128 v[54:57], v17 offset:0
    ds_read_b128 v[58:61], v17 offset:1024
    v_smfmac_f32_16x16x64_bf16 v[74:77], v[106:109], v[62:69], v1
    ds_read_b128 v[62:65], v17 offset:2048
    ds_read_b128 v[66:69], v17 offset:3072
    v_smfmac_f32_16x16x64_bf16 v[30:33], v[106:109], v[78:85], v1
    ds_read_b128 v[78:81], v17 offset:4096
    ds_read_b128 v[82:85], v17 offset:5120
    v_smfmac_f32_16x16x64_bf16 v[34:37], v[106:109], v[118:125], v1
    ds_read_b128 v[118:121], v17 offset:6144
    ds_read_b128 v[122:125], v17 offset:7168
    buffer_load_dwordx4 v11, s[4:7], s24 offen offset:1024 lds
    s_waitcnt lgkmcnt(15)
    s_waitcnt lgkmcnt(14)
    v_smfmac_f32_16x16x64_bf16 v[70:73], v[110:113], v[86:93], v1
    s_waitcnt lgkmcnt(12)
    v_smfmac_f32_16x16x64_bf16 v[74:77], v[110:113], v[94:101], v1
    s_waitcnt lgkmcnt(6)
    v_smfmac_f32_16x16x64_bf16 v[70:73], v[114:117], v[54:61], v1
    s_waitcnt lgkmcnt(4)
    v_smfmac_f32_16x16x64_bf16 v[74:77], v[114:117], v[62:69], v1
    v_smfmac_f32_16x16x64_bf16 v[30:33], v[110:113], v[38:45], v1
    v_smfmac_f32_16x16x64_bf16 v[34:37], v[110:113], v[46:53], v1
    v_cvt_pk_bf16_f32 v102, v70, v71
    v_cvt_pk_bf16_f32 v103, v72, v73
    s_add_u32 s23, s44, 0
    buffer_store_dwordx2 v[102:103], v10, s[4:7], s23 offen sc1
    s_waitcnt lgkmcnt(2)
    v_smfmac_f32_16x16x64_bf16 v[30:33], v[114:117], v[78:85], v1
    s_waitcnt lgkmcnt(0)
    v_smfmac_f32_16x16x64_bf16 v[34:37], v[114:117], v[118:125], v1
    v_cvt_pk_bf16_f32 v104, v74, v75
    v_cvt_pk_bf16_f32 v105, v76, v77
    s_add_u32 s23, s44, 16384
    buffer_store_dwordx2 v[104:105], v10, s[4:7], s23 offen sc1
    v_cvt_pk_bf16_f32 v106, v30, v31
    v_cvt_pk_bf16_f32 v107, v32, v33
    s_add_u32 s23, s44, 32768
    buffer_store_dwordx2 v[106:107], v10, s[4:7], s23 offen sc1
    v_cvt_pk_bf16_f32 v108, v34, v35
    v_cvt_pk_bf16_f32 v109, v36, v37
    s_add_u32 s23, s44, 49152
    buffer_store_dwordx2 v[108:109], v10, s[4:7], s23 offen sc1
    s_add_u32 s48, s44, s45
    v_cndmask_b32 v118, 0, v9, s[8:9]
    v_cndmask_b32 v119, 0, v9, s[10:11]
    v_cndmask_b32 v120, 0, v9, s[12:13]
    v_cndmask_b32 v121, 0, v9, s[14:15]
    v_mov_b64 v[70:71], 0
    v_mov_b64 v[72:73], 0
    v_mov_b64 v[74:75], 0
    v_mov_b64 v[76:77], 0
    s_add_u32 s40, s40, 1
    s_xor_b32 s44, s44, 0x40000
    s_mov_b32 s23, s41
    s_mov_b32 s41, s42
    s_mov_b32 s42, s43
    s_mov_b32 s43, s23
    s_lshl_b32 s24, s20, 11
    s_add_u32 s28, s41, s24
    s_add_u32 s24, s24, 0x20000
    s_add_u32 s52, s52, 0x20000
    s_cmp_lt_u32 s40, 63
    s_cselect_b32 s23, 0x40000, 0
    s_add_u32 s50, s50, s23
    s_sleep 2
    s_mov_b32 s25, 32768
    buffer_load_dwordx4 v[38:41], v11, s[4:7], s48 offen offset:0 sc1
    buffer_load_dwordx4 v[42:45], v11, s[4:7], s48 offen offset:1024 sc1
    s_sleep 3
    buffer_load_dwordx4 v[46:49], v11, s[4:7], s48 offen offset:0 sc1
    buffer_load_dwordx4 v[50:53], v11, s[4:7], s48 offen offset:1024 sc1
CH_SLOW_POLL1:
    s_waitcnt vmcnt(2)
    v_max3_u32 v18, v38, v39, v40
    v_max3_u32 v19, v41, v42, v43
    v_max3_u32 v18, v18, v44, v45
    v_max_u32 v18, v18, v19
    v_cmp_eq_u32 vcc, -1, v18
    s_sub_u32 s25, s25, 1
    s_cbranch_scc1 CH_SLOW_POLL1E_0
    s_nop 2
    s_cbranch_vccz CH_SLOW_POLL1E_0
    buffer_load_dwordx4 v[38:41], v11, s[4:7], s48 offen offset:0 sc1
    buffer_load_dwordx4 v[42:45], v11, s[4:7], s48 offen offset:1024 sc1
    s_waitcnt vmcnt(2)
    v_max3_u32 v18, v46, v47, v48
    v_max3_u32 v19, v49, v50, v51
    v_max3_u32 v18, v18, v52, v53
    v_max_u32 v18, v18, v19
    v_cmp_eq_u32 vcc, -1, v18
    s_nop 4
    s_cbranch_vccz CH_SLOW_POLL1E_1
    buffer_load_dwordx4 v[46:49], v11, s[4:7], s48 offen offset:0 sc1
    buffer_load_dwordx4 v[50:53], v11, s[4:7], s48 offen offset:1024 sc1
    s_branch CH_SLOW_POLL1
CH_SLOW_POLL1E_1:
    v_mfma_f32_16x16x32_bf16 v[78:81], v[46:49], v[118:121], 0
    v_mfma_f32_16x16x32_bf16 v[78:81], v[50:53], v[118:121], v[78:81]
    s_branch CH_SLOW_POLL1J
CH_SLOW_POLL1E_0:
    s_nop 4
    s_nop 1
    v_mfma_f32_16x16x32_bf16 v[78:81], v[38:41], v[118:121], 0
    v_mfma_f32_16x16x32_bf16 v[78:81], v[42:45], v[118:121], v[78:81]
CH_SLOW_POLL1J:
    s_add_u32 s23, s40, 1
    s_min_u32 s23, s23, 63
    s_lshr_b32 s23, s23, 2
    s_add_u32 s23, s23, 1
    v_cmp_gt_u32 vcc, s23, v127
    v_add_u32 v8, s24, v11
    s_nop 1
    v_permlane32_swap_b32 v78, v80
    s_nop 0
    v_permlane32_swap_b32 v79, v81
    v_pk_add_f32 v[78:79], v[78:79], v[80:81]
    s_nop 1
    v_permlane16_swap_b32 v78, v79
    v_add_f32 v78, v78, v79
    v_mov_b32 v79, v78
    s_nop 1
    v_permlane16_swap_b32 v78, v79
    v_cvt_pk_bf16_f32 v18, v78, v79
    buffer_store_dword v18, v12, s[4:7], s41 offen sc1
    s_cbranch_vccz CH_SLOW_KVOK
    s_add_u32 s23, s40, 1
    s_min_u32 s23, s23, 63
    s_and_b32 s24, s23, 3
    s_lshl_b32 s24, s24, 2
    s_lshr_b32 s23, s23, 2
    s_add_u32 s23, s23, 1
    s_mov_b32 s25, 32768
WKV_20:
    buffer_load_dword v18, v13, s[4:7], s24 offen sc1
    s_waitcnt vmcnt(0)
    v_cmp_gt_u32 vcc, s23, v18
    s_sub_u32 s25, s25, 1
    s_cbranch_scc1 WKVE_21
    s_nop 2
    s_cbranch_vccz WKVE_21
    s_sleep 1
    s_branch WKV_20
WKVE_21:
CH_SLOW_KVOK:
    v_mov_b64 v[86:87], -1
    v_mov_b64 v[88:89], -1
    v_mov_b64 v[78:79], 0
    v_mov_b64 v[80:81], 0
    v_mov_b64 v[82:83], 0
    v_mov_b64 v[84:85], 0
    s_sleep 2
    s_mov_b32 s25, 32768
    buffer_load_dwordx4 v[102:105], v11, s[4:7], s28 offen offset:0 sc1
    buffer_load_dwordx4 v[106:109], v11, s[4:7], s28 offen offset:1024 sc1
    s_sleep 3
    buffer_load_dwordx4 v[110:113], v11, s[4:7], s28 offen offset:0 sc1
    buffer_load_dwordx4 v[114:117], v11, s[4:7], s28 offen offset:1024 sc1
CH_SLOW_POLL2:
    s_waitcnt vmcnt(2)
    v_max3_u32 v18, v102, v103, v104
    v_max3_u32 v19, v105, v106, v107
    v_max3_u32 v18, v18, v108, v109
    v_max_u32 v18, v18, v19
    v_cmp_eq_u32 vcc, -1, v18
    s_sub_u32 s25, s25, 1
    s_cbranch_scc1 CH_SLOW_POLL2E_0
    s_nop 2
    s_cbranch_vccz CH_SLOW_POLL2E_0
    buffer_load_dwordx4 v[102:105], v11, s[4:7], s28 offen offset:0 sc1
    buffer_load_dwordx4 v[106:109], v11, s[4:7], s28 offen offset:1024 sc1
    s_waitcnt vmcnt(2)
    v_max3_u32 v18, v110, v111, v112
    v_max3_u32 v19, v113, v114, v115
    v_max3_u32 v18, v18, v116, v117
    v_max_u32 v18, v18, v19
    v_cmp_eq_u32 vcc, -1, v18
    s_nop 4
    s_cbranch_vccz CH_SLOW_POLL2E_1
    buffer_load_dwordx4 v[110:113], v11, s[4:7], s28 offen offset:0 sc1
    buffer_load_dwordx4 v[114:117], v11, s[4:7], s28 offen offset:1024 sc1
    s_branch CH_SLOW_POLL2
CH_SLOW_POLL2E_1:
    ds_write_b128 v8, v[110:113] offset:0
    ds_write_b128 v8, v[114:117] offset:1024
    s_branch CH_SLOW_POLL2J
CH_SLOW_POLL2E_0:
    ds_write_b128 v8, v[102:105] offset:0
    ds_write_b128 v8, v[106:109] offset:1024
CH_SLOW_POLL2J:
    s_waitcnt lgkmcnt(0)
    s_barrier
    s_branch CH_SLOW_PH1
CH_SLOW_DONE:
    s_waitcnt vmcnt(0) lgkmcnt(0)
    s_barrier
    v_mov_b32 v19, 64
    buffer_store_dword v19, off, s[4:7], s53 sc1
    s_waitcnt vmcnt(0)
    s_endpgm
ROLE_QA:
    s_and_b32 s23, s21, 31
    s_lshl_b32 s23, s23, 7
    s_add_u32 s23, s23, 0x9000
    v_mov_b32 v2, s23
    s_mov_b32 s25, 1
    s_mov_b32 s24, 32768
WF_22:
    buffer_load_dword v3, v2, s[4:7], 0 offen sc1
    s_waitcnt vmcnt(0)
    v_cmp_gt_u32 vcc, s25, v3
    s_sub_u32 s24, s24, 1
    s_cbranch_scc1 WFE_23
    s_nop 2
    s_cbranch_vccz WFE_23
    s_sleep 32
    s_branch WF_22
WFE_23:
    s_load_dwordx2 s[8:9], s[0:1], 16
    s_mov_b32 s10, 0x400000
    s_mov_b32 s11, 0x20000
    s_waitcnt lgkmcnt(0)
    s_lshl_b32 s30, s21, 8
    v_lshrrev_b32 v2, 4, v0
    s_and_b32 s23, s20, 1
    s_lshl_b32 s23, s23, 2
    v_add_u32 v3, s23, v2
    v_lshlrev_b32 v3, 1, v3
    v_and_b32 v4, 15, v0
    v_xor_b32 v4, v4, v3
    v_lshlrev_b32 v4, 4, v4
    s_mov_b32 s23, 8192
    v_mul_lo_u32 v2, v2, s23
    v_add_u32 v2, v2, v4
    s_mul_i32 s24, s20, 32768
    s_add_u32 s24, s24, s30
    s_lshl_b32 s25, s20, 10
    s_mov_b32 s27, 32
DMA_24:
    s_mov_b32 m0, s25
    s_add_u32 s25, s25, 4096
    buffer_load_dwordx4 v2, s[8:11], s24 offen lds
    s_add_u32 s24, s24, 131072
    s_sub_u32 s27, s27, 1
    s_cmp_lg_u32 s27, 0
    s_cbranch_scc1 DMA_24
    v_bfe_u32 v2, v0, 2, 2
    v_lshrrev_b32 v3, 4, v0
    v_lshl_add_u32 v4, v3, 2, v2
    v_lshlrev_b32 v5, 8, v4
    v_and_b32 v4, 7, v4
    v_lshlrev_b32 v4, 1, v4
    v_and_b32 v6, 1, v0
    v_lshl_add_u32 v5, v6, 3, v5
    v_bfe_u32 v6, v0, 1, 1
    v_add_u32 v7, 0, v6
    v_xor_b32 v7, v7, v4
    v_lshl_add_u32 v16, v7, 4, v5
    v_add_u32 v24, 0x10000, v16
    v_add_u32 v7, 2, v6
    v_xor_b32 v7, v7, v4
    v_lshl_add_u32 v17, v7, 4, v5
    v_add_u32 v25, 0x10000, v17
    v_add_u32 v7, 4, v6
    v_xor_b32 v7, v7, v4
    v_lshl_add_u32 v18, v7, 4, v5
    v_add_u32 v26, 0x10000, v18
    v_add_u32 v7, 6, v6
    v_xor_b32 v7, v7, v4
    v_lshl_add_u32 v19, v7, 4, v5
    v_add_u32 v27, 0x10000, v19
    v_add_u32 v7, 8, v6
    v_xor_b32 v7, v7, v4
    v_lshl_add_u32 v20, v7, 4, v5
    v_add_u32 v28, 0x10000, v20
    v_add_u32 v7, 10, v6
    v_xor_b32 v7, v7, v4
    v_lshl_add_u32 v21, v7, 4, v5
    v_add_u32 v29, 0x10000, v21
    v_add_u32 v7, 12, v6
    v_xor_b32 v7, v7, v4
    v_lshl_add_u32 v22, v7, 4, v5
    v_add_u32 v30, 0x10000, v22
    v_add_u32 v7, 14, v6
    v_xor_b32 v7, v7, v4
    v_lshl_add_u32 v23, v7, 4, v5
    v_add_u32 v31, 0x10000, v23
    s_lshl_b32 s23, s21, 7
    s_lshl_b32 s24, s20, 2
    s_add_u32 s24, s23, s24
    s_add_u32 s25, s24, 0x4000
    v_mov_b32 v8, s25
    v_lshlrev_b32 v9, 4, v0
    v_lshlrev_b32 v11, 3, v0
    v_and_b32 v2, 1, v0
    v_lshlrev_b32 v2, 12, v2
    s_add_u32 s25, s24, 0x1000
    v_add_u32 v10, s25, v2
    s_add_u32 s25, s23, 0x3000
    v_mov_b32 v12, s25
    v_lshrrev_b32 v2, 4, v0
    v_lshlrev_b32 v2, 2, v2
    v_and_b32 v3, 15, v0
    v_add_u32 v4, 0, v2
    v_cmp_le_u32 s[64:65], v4, v3
    v_add_u32 v4, 1, v2
    v_cmp_le_u32 s[66:67], v4, v3
    v_add_u32 v4, 2, v2
    v_cmp_le_u32 s[68:69], v4, v3
    v_add_u32 v4, 3, v2
    v_cmp_le_u32 s[70:71], v4, v3
    v_cmp_gt_u32 vcc, 32, v0
    v_mov_b32 v2, 0x3f803f80
    v_mov_b32 v14, 0
    v_cndmask_b32 v14, v14, v2, vcc
    v_mov_b32 v15, v14
    v_mov_b32 v4, 0x3f803f80
    v_mov_b32 v5, 0x3f803f80
    v_mov_b32 v6, 0x3f803f80
    v_mov_b32 v7, 0x3f803f80
    v_mov_b32 v13, 0xf149f2ca
    s_mov_b32 s46, 0x3e0293ee
    s_mov_b32 s47, 0x3e0293ee
    s_waitcnt vmcnt(0)
    s_barrier
    s_mov_b32 s31, s20
    s_mov_b32 s32, 0
QA_LOOP:
    v_and_b32 v2, 3, v0
    v_lshlrev_b32 v2, 2, v2
    s_lshl_b32 s23, s31, 4
    s_mov_b32 s24, 32768
WLN_25:
    buffer_load_dword v3, v2, s[4:7], s23 offen sc1
    s_waitcnt vmcnt(0)
    v_cmp_eq_u32 vcc, 0, v3
    s_sub_u32 s24, s24, 1
    s_cbranch_scc1 WLNE_26
    s_nop 2
    s_cbranch_vccz WLNE_26
    s_sleep 1
    s_branch WLN_25
WLNE_26:
    s_lshl_b32 s33, s31, 15
    s_add_u32 s33, s33, 0x100000
    buffer_load_dwordx4 a[0:3], v9, s[4:7], s33 offen offset:0
    buffer_load_dwordx4 a[4:7], v9, s[4:7], s33 offen offset:1024
    buffer_load_dwordx4 a[8:11], v9, s[4:7], s33 offen offset:2048
    buffer_load_dwordx4 a[12:15], v9, s[4:7], s33 offen offset:3072
    s_add_u32 s33, s33, 4096
    buffer_load_dwordx4 a[16:19], v9, s[4:7], s33 offen offset:0
    buffer_load_dwordx4 a[20:23], v9, s[4:7], s33 offen offset:1024
    buffer_load_dwordx4 a[24:27], v9, s[4:7], s33 offen offset:2048
    buffer_load_dwordx4 a[28:31], v9, s[4:7], s33 offen offset:3072
    s_add_u32 s33, s33, 4096
    buffer_load_dwordx4 a[32:35], v9, s[4:7], s33 offen offset:0
    buffer_load_dwordx4 a[36:39], v9, s[4:7], s33 offen offset:1024
    buffer_load_dwordx4 a[40:43], v9, s[4:7], s33 offen offset:2048
    buffer_load_dwordx4 a[44:47], v9, s[4:7], s33 offen offset:3072
    s_add_u32 s33, s33, 4096
    buffer_load_dwordx4 a[48:51], v9, s[4:7], s33 offen offset:0
    buffer_load_dwordx4 a[52:55], v9, s[4:7], s33 offen offset:1024
    buffer_load_dwordx4 a[56:59], v9, s[4:7], s33 offen offset:2048
    buffer_load_dwordx4 a[60:63], v9, s[4:7], s33 offen offset:3072
    s_add_u32 s33, s33, 4096
    buffer_load_dwordx4 a[64:67], v9, s[4:7], s33 offen offset:0
    buffer_load_dwordx4 a[68:71], v9, s[4:7], s33 offen offset:1024
    buffer_load_dwordx4 a[72:75], v9, s[4:7], s33 offen offset:2048
    buffer_load_dwordx4 a[76:79], v9, s[4:7], s33 offen offset:3072
    s_add_u32 s33, s33, 4096
    buffer_load_dwordx4 a[80:83], v9, s[4:7], s33 offen offset:0
    buffer_load_dwordx4 a[84:87], v9, s[4:7], s33 offen offset:1024
    buffer_load_dwordx4 a[88:91], v9, s[4:7], s33 offen offset:2048
    buffer_load_dwordx4 a[92:95], v9, s[4:7], s33 offen offset:3072
    s_add_u32 s33, s33, 4096
    buffer_load_dwordx4 a[96:99], v9, s[4:7], s33 offen offset:0
    buffer_load_dwordx4 a[100:103], v9, s[4:7], s33 offen offset:1024
    buffer_load_dwordx4 a[104:107], v9, s[4:7], s33 offen offset:2048
    buffer_load_dwordx4 a[108:111], v9, s[4:7], s33 offen offset:3072
    s_add_u32 s33, s33, 4096
    buffer_load_dwordx4 a[112:115], v9, s[4:7], s33 offen offset:0
    buffer_load_dwordx4 a[116:119], v9, s[4:7], s33 offen offset:1024
    buffer_load_dwordx4 a[120:123], v9, s[4:7], s33 offen offset:2048
    buffer_load_dwordx4 a[124:127], v9, s[4:7], s33 offen offset:3072
    s_waitcnt vmcnt(0)
    ds_read_b64_tr_b16 v[32:33], v16 offset:0
    ds_read_b64_tr_b16 v[34:35], v16 offset:4096
    ds_read_b64_tr_b16 v[36:37], v17 offset:0
    ds_read_b64_tr_b16 v[38:39], v17 offset:4096
    ds_read_b64_tr_b16 v[40:41], v18 offset:0
    ds_read_b64_tr_b16 v[42:43], v18 offset:4096
    s_waitcnt lgkmcnt(4)
    v_mfma_f32_16x16x32_bf16 v[64:67], v[32:35], a[0:3], 0
    v_mfma_f32_16x16x32_bf16 v[96:99], v[32:35], a[64:67], 0
    ds_read_b64_tr_b16 v[44:45], v19 offset:0
    ds_read_b64_tr_b16 v[46:47], v19 offset:4096
    s_waitcnt lgkmcnt(4)
    v_mfma_f32_16x16x32_bf16 v[68:71], v[36:39], a[0:3], 0
    v_mfma_f32_16x16x32_bf16 v[100:103], v[36:39], a[64:67], 0
    ds_read_b64_tr_b16 v[32:33], v20 offset:0
    ds_read_b64_tr_b16 v[34:35], v20 offset:4096
    s_waitcnt lgkmcnt(4)
    v_mfma_f32_16x16x32_bf16 v[72:75], v[40:43], a[0:3], 0
    v_mfma_f32_16x16x32_bf16 v[104:107], v[40:43], a[64:67], 0
    ds_read_b64_tr_b16 v[36:37], v21 offset:0
    ds_read_b64_tr_b16 v[38:39], v21 offset:4096
    s_waitcnt lgkmcnt(4)
    v_mfma_f32_16x16x32_bf16 v[76:79], v[44:47], a[0:3], 0
    v_mfma_f32_16x16x32_bf16 v[108:111], v[44:47], a[64:67], 0
    ds_read_b64_tr_b16 v[40:41], v22 offset:0
    ds_read_b64_tr_b16 v[42:43], v22 offset:4096
    s_waitcnt lgkmcnt(4)
    v_mfma_f32_16x16x32_bf16 v[80:83], v[32:35], a[0:3], 0
    v_mfma_f32_16x16x32_bf16 v[112:115], v[32:35], a[64:67], 0
    ds_read_b64_tr_b16 v[44:45], v23 offset:0
    ds_read_b64_tr_b16 v[46:47], v23 offset:4096
    s_waitcnt lgkmcnt(4)
    v_mfma_f32_16x16x32_bf16 v[84:87], v[36:39], a[0:3], 0
    v_mfma_f32_16x16x32_bf16 v[116:119], v[36:39], a[64:67], 0
    ds_read_b64_tr_b16 v[32:33], v16 offset:8192
    ds_read_b64_tr_b16 v[34:35], v16 offset:12288
    s_waitcnt lgkmcnt(4)
    v_mfma_f32_16x16x32_bf16 v[88:91], v[40:43], a[0:3], 0
    v_mfma_f32_16x16x32_bf16 v[120:123], v[40:43], a[64:67], 0
    ds_read_b64_tr_b16 v[36:37], v17 offset:8192
    ds_read_b64_tr_b16 v[38:39], v17 offset:12288
    s_waitcnt lgkmcnt(4)
    v_mfma_f32_16x16x32_bf16 v[92:95], v[44:47], a[0:3], 0
    v_mfma_f32_16x16x32_bf16 v[124:127], v[44:47], a[64:67], 0
    ds_read_b64_tr_b16 v[40:41], v18 offset:8192
    ds_read_b64_tr_b16 v[42:43], v18 offset:12288
    s_waitcnt lgkmcnt(4)
    v_mfma_f32_16x16x32_bf16 v[64:67], v[32:35], a[4:7], v[64:67]
    v_mfma_f32_16x16x32_bf16 v[96:99], v[32:35], a[68:71], v[96:99]
    ds_read_b64_tr_b16 v[44:45], v19 offset:8192
    ds_read_b64_tr_b16 v[46:47], v19 offset:12288
    s_waitcnt lgkmcnt(4)
    v_mfma_f32_16x16x32_bf16 v[68:71], v[36:39], a[4:7], v[68:71]
    v_mfma_f32_16x16x32_bf16 v[100:103], v[36:39], a[68:71], v[100:103]
    ds_read_b64_tr_b16 v[32:33], v20 offset:8192
    ds_read_b64_tr_b16 v[34:35], v20 offset:12288
    s_waitcnt lgkmcnt(4)
    v_mfma_f32_16x16x32_bf16 v[72:75], v[40:43], a[4:7], v[72:75]
    v_mfma_f32_16x16x32_bf16 v[104:107], v[40:43], a[68:71], v[104:107]
    ds_read_b64_tr_b16 v[36:37], v21 offset:8192
    ds_read_b64_tr_b16 v[38:39], v21 offset:12288
    s_waitcnt lgkmcnt(4)
    v_mfma_f32_16x16x32_bf16 v[76:79], v[44:47], a[4:7], v[76:79]
    v_mfma_f32_16x16x32_bf16 v[108:111], v[44:47], a[68:71], v[108:111]
    ds_read_b64_tr_b16 v[40:41], v22 offset:8192
    ds_read_b64_tr_b16 v[42:43], v22 offset:12288
    s_waitcnt lgkmcnt(4)
    v_mfma_f32_16x16x32_bf16 v[80:83], v[32:35], a[4:7], v[80:83]
    v_mfma_f32_16x16x32_bf16 v[112:115], v[32:35], a[68:71], v[112:115]
    ds_read_b64_tr_b16 v[44:45], v23 offset:8192
    ds_read_b64_tr_b16 v[46:47], v23 offset:12288
    s_waitcnt lgkmcnt(4)
    v_mfma_f32_16x16x32_bf16 v[84:87], v[36:39], a[4:7], v[84:87]
    v_mfma_f32_16x16x32_bf16 v[116:119], v[36:39], a[68:71], v[116:119]
    ds_read_b64_tr_b16 v[32:33], v16 offset:16384
    ds_read_b64_tr_b16 v[34:35], v16 offset:20480
    s_waitcnt lgkmcnt(4)
    v_mfma_f32_16x16x32_bf16 v[88:91], v[40:43], a[4:7], v[88:91]
    v_mfma_f32_16x16x32_bf16 v[120:123], v[40:43], a[68:71], v[120:123]
    ds_read_b64_tr_b16 v[36:37], v17 offset:16384
    ds_read_b64_tr_b16 v[38:39], v17 offset:20480
    s_waitcnt lgkmcnt(4)
    v_mfma_f32_16x16x32_bf16 v[92:95], v[44:47], a[4:7], v[92:95]
    v_mfma_f32_16x16x32_bf16 v[124:127], v[44:47], a[68:71], v[124:127]
    ds_read_b64_tr_b16 v[40:41], v18 offset:16384
    ds_read_b64_tr_b16 v[42:43], v18 offset:20480
    s_waitcnt lgkmcnt(4)
    v_mfma_f32_16x16x32_bf16 v[64:67], v[32:35], a[8:11], v[64:67]
    v_mfma_f32_16x16x32_bf16 v[96:99], v[32:35], a[72:75], v[96:99]
    ds_read_b64_tr_b16 v[44:45], v19 offset:16384
    ds_read_b64_tr_b16 v[46:47], v19 offset:20480
    s_waitcnt lgkmcnt(4)
    v_mfma_f32_16x16x32_bf16 v[68:71], v[36:39], a[8:11], v[68:71]
    v_mfma_f32_16x16x32_bf16 v[100:103], v[36:39], a[72:75], v[100:103]
    ds_read_b64_tr_b16 v[32:33], v20 offset:16384
    ds_read_b64_tr_b16 v[34:35], v20 offset:20480
    s_waitcnt lgkmcnt(4)
    v_mfma_f32_16x16x32_bf16 v[72:75], v[40:43], a[8:11], v[72:75]
    v_mfma_f32_16x16x32_bf16 v[104:107], v[40:43], a[72:75], v[104:107]
    ds_read_b64_tr_b16 v[36:37], v21 offset:16384
    ds_read_b64_tr_b16 v[38:39], v21 offset:20480
    s_waitcnt lgkmcnt(4)
    v_mfma_f32_16x16x32_bf16 v[76:79], v[44:47], a[8:11], v[76:79]
    v_mfma_f32_16x16x32_bf16 v[108:111], v[44:47], a[72:75], v[108:111]
    ds_read_b64_tr_b16 v[40:41], v22 offset:16384
    ds_read_b64_tr_b16 v[42:43], v22 offset:20480
    s_waitcnt lgkmcnt(4)
    v_mfma_f32_16x16x32_bf16 v[80:83], v[32:35], a[8:11], v[80:83]
    v_mfma_f32_16x16x32_bf16 v[112:115], v[32:35], a[72:75], v[112:115]
    ds_read_b64_tr_b16 v[44:45], v23 offset:16384
    ds_read_b64_tr_b16 v[46:47], v23 offset:20480
    s_waitcnt lgkmcnt(4)
    v_mfma_f32_16x16x32_bf16 v[84:87], v[36:39], a[8:11], v[84:87]
    v_mfma_f32_16x16x32_bf16 v[116:119], v[36:39], a[72:75], v[116:119]
    ds_read_b64_tr_b16 v[32:33], v16 offset:24576
    ds_read_b64_tr_b16 v[34:35], v16 offset:28672
    s_waitcnt lgkmcnt(4)
    v_mfma_f32_16x16x32_bf16 v[88:91], v[40:43], a[8:11], v[88:91]
    v_mfma_f32_16x16x32_bf16 v[120:123], v[40:43], a[72:75], v[120:123]
    ds_read_b64_tr_b16 v[36:37], v17 offset:24576
    ds_read_b64_tr_b16 v[38:39], v17 offset:28672
    s_waitcnt lgkmcnt(4)
    v_mfma_f32_16x16x32_bf16 v[92:95], v[44:47], a[8:11], v[92:95]
    v_mfma_f32_16x16x32_bf16 v[124:127], v[44:47], a[72:75], v[124:127]
    ds_read_b64_tr_b16 v[40:41], v18 offset:24576
    ds_read_b64_tr_b16 v[42:43], v18 offset:28672
    s_waitcnt lgkmcnt(4)
    v_mfma_f32_16x16x32_bf16 v[64:67], v[32:35], a[12:15], v[64:67]
    v_mfma_f32_16x16x32_bf16 v[96:99], v[32:35], a[76:79], v[96:99]
    ds_read_b64_tr_b16 v[44:45], v19 offset:24576
    ds_read_b64_tr_b16 v[46:47], v19 offset:28672
    s_waitcnt lgkmcnt(4)
    v_mfma_f32_16x16x32_bf16 v[68:71], v[36:39], a[12:15], v[68:71]
    v_mfma_f32_16x16x32_bf16 v[100:103], v[36:39], a[76:79], v[100:103]
    ds_read_b64_tr_b16 v[32:33], v20 offset:24576
    ds_read_b64_tr_b16 v[34:35], v20 offset:28672
    s_waitcnt lgkmcnt(4)
    v_mfma_f32_16x16x32_bf16 v[72:75], v[40:43], a[12:15], v[72:75]
    v_mfma_f32_16x16x32_bf16 v[104:107], v[40:43], a[76:79], v[104:107]
    ds_read_b64_tr_b16 v[36:37], v21 offset:24576
    ds_read_b64_tr_b16 v[38:39], v21 offset:28672
    s_waitcnt lgkmcnt(4)
    v_mfma_f32_16x16x32_bf16 v[76:79], v[44:47], a[12:15], v[76:79]
    v_mfma_f32_16x16x32_bf16 v[108:111], v[44:47], a[76:79], v[108:111]
    ds_read_b64_tr_b16 v[40:41], v22 offset:24576
    ds_read_b64_tr_b16 v[42:43], v22 offset:28672
    s_waitcnt lgkmcnt(4)
    v_mfma_f32_16x16x32_bf16 v[80:83], v[32:35], a[12:15], v[80:83]
    v_mfma_f32_16x16x32_bf16 v[112:115], v[32:35], a[76:79], v[112:115]
    ds_read_b64_tr_b16 v[44:45], v23 offset:24576
    ds_read_b64_tr_b16 v[46:47], v23 offset:28672
    s_waitcnt lgkmcnt(4)
    v_mfma_f32_16x16x32_bf16 v[84:87], v[36:39], a[12:15], v[84:87]
    v_mfma_f32_16x16x32_bf16 v[116:119], v[36:39], a[76:79], v[116:119]
    ds_read_b64_tr_b16 v[32:33], v16 offset:32768
    ds_read_b64_tr_b16 v[34:35], v16 offset:36864
    s_waitcnt lgkmcnt(4)
    v_mfma_f32_16x16x32_bf16 v[88:91], v[40:43], a[12:15], v[88:91]
    v_mfma_f32_16x16x32_bf16 v[120:123], v[40:43], a[76:79], v[120:123]
    ds_read_b64_tr_b16 v[36:37], v17 offset:32768
    ds_read_b64_tr_b16 v[38:39], v17 offset:36864
    s_waitcnt lgkmcnt(4)
    v_mfma_f32_16x16x32_bf16 v[92:95], v[44:47], a[12:15], v[92:95]
    v_mfma_f32_16x16x32_bf16 v[124:127], v[44:47], a[76:79], v[124:127]
    ds_read_b64_tr_b16 v[40:41], v18 offset:32768
    ds_read_b64_tr_b16 v[42:43], v18 offset:36864
    s_waitcnt lgkmcnt(4)
    v_mfma_f32_16x16x32_bf16 v[64:67], v[32:35], a[16:19], v[64:67]
    v_mfma_f32_16x16x32_bf16 v[96:99], v[32:35], a[80:83], v[96:99]
    ds_read_b64_tr_b16 v[44:45], v19 offset:32768
    ds_read_b64_tr_b16 v[46:47], v19 offset:36864
    s_waitcnt lgkmcnt(4)
    v_mfma_f32_16x16x32_bf16 v[68:71], v[36:39], a[16:19], v[68:71]
    v_mfma_f32_16x16x32_bf16 v[100:103], v[36:39], a[80:83], v[100:103]
    ds_read_b64_tr_b16 v[32:33], v20 offset:32768
    ds_read_b64_tr_b16 v[34:35], v20 offset:36864
    s_waitcnt lgkmcnt(4)
    v_mfma_f32_16x16x32_bf16 v[72:75], v[40:43], a[16:19], v[72:75]
    v_mfma_f32_16x16x32_bf16 v[104:107], v[40:43], a[80:83], v[104:107]
    ds_read_b64_tr_b16 v[36:37], v21 offset:32768
    ds_read_b64_tr_b16 v[38:39], v21 offset:36864
    s_waitcnt lgkmcnt(4)
    v_mfma_f32_16x16x32_bf16 v[76:79], v[44:47], a[16:19], v[76:79]
    v_mfma_f32_16x16x32_bf16 v[108:111], v[44:47], a[80:83], v[108:111]
    ds_read_b64_tr_b16 v[40:41], v22 offset:32768
    ds_read_b64_tr_b16 v[42:43], v22 offset:36864
    s_waitcnt lgkmcnt(4)
    v_mfma_f32_16x16x32_bf16 v[80:83], v[32:35], a[16:19], v[80:83]
    v_mfma_f32_16x16x32_bf16 v[112:115], v[32:35], a[80:83], v[112:115]
    ds_read_b64_tr_b16 v[44:45], v23 offset:32768
    ds_read_b64_tr_b16 v[46:47], v23 offset:36864
    s_waitcnt lgkmcnt(4)
    v_mfma_f32_16x16x32_bf16 v[84:87], v[36:39], a[16:19], v[84:87]
    v_mfma_f32_16x16x32_bf16 v[116:119], v[36:39], a[80:83], v[116:119]
    ds_read_b64_tr_b16 v[32:33], v16 offset:40960
    ds_read_b64_tr_b16 v[34:35], v16 offset:45056
    s_waitcnt lgkmcnt(4)
    v_mfma_f32_16x16x32_bf16 v[88:91], v[40:43], a[16:19], v[88:91]
    v_mfma_f32_16x16x32_bf16 v[120:123], v[40:43], a[80:83], v[120:123]
    ds_read_b64_tr_b16 v[36:37], v17 offset:40960
    ds_read_b64_tr_b16 v[38:39], v17 offset:45056
    s_waitcnt lgkmcnt(4)
    v_mfma_f32_16x16x32_bf16 v[92:95], v[44:47], a[16:19], v[92:95]
    v_mfma_f32_16x16x32_bf16 v[124:127], v[44:47], a[80:83], v[124:127]
    ds_read_b64_tr_b16 v[40:41], v18 offset:40960
    ds_read_b64_tr_b16 v[42:43], v18 offset:45056
    s_waitcnt lgkmcnt(4)
    v_mfma_f32_16x16x32_bf16 v[64:67], v[32:35], a[20:23], v[64:67]
    v_mfma_f32_16x16x32_bf16 v[96:99], v[32:35], a[84:87], v[96:99]
    ds_read_b64_tr_b16 v[44:45], v19 offset:40960
    ds_read_b64_tr_b16 v[46:47], v19 offset:45056
    s_waitcnt lgkmcnt(4)
    v_mfma_f32_16x16x32_bf16 v[68:71], v[36:39], a[20:23], v[68:71]
    v_mfma_f32_16x16x32_bf16 v[100:103], v[36:39], a[84:87], v[100:103]
    ds_read_b64_tr_b16 v[32:33], v20 offset:40960
    ds_read_b64_tr_b16 v[34:35], v20 offset:45056
    s_waitcnt lgkmcnt(4)
    v_mfma_f32_16x16x32_bf16 v[72:75], v[40:43], a[20:23], v[72:75]
    v_mfma_f32_16x16x32_bf16 v[104:107], v[40:43], a[84:87], v[104:107]
    ds_read_b64_tr_b16 v[36:37], v21 offset:40960
    ds_read_b64_tr_b16 v[38:39], v21 offset:45056
    s_waitcnt lgkmcnt(4)
    v_mfma_f32_16x16x32_bf16 v[76:79], v[44:47], a[20:23], v[76:79]
    v_mfma_f32_16x16x32_bf16 v[108:111], v[44:47], a[84:87], v[108:111]
    ds_read_b64_tr_b16 v[40:41], v22 offset:40960
    ds_read_b64_tr_b16 v[42:43], v22 offset:45056
    s_waitcnt lgkmcnt(4)
    v_mfma_f32_16x16x32_bf16 v[80:83], v[32:35], a[20:23], v[80:83]
    v_mfma_f32_16x16x32_bf16 v[112:115], v[32:35], a[84:87], v[112:115]
    ds_read_b64_tr_b16 v[44:45], v23 offset:40960
    ds_read_b64_tr_b16 v[46:47], v23 offset:45056
    s_waitcnt lgkmcnt(4)
    v_mfma_f32_16x16x32_bf16 v[84:87], v[36:39], a[20:23], v[84:87]
    v_mfma_f32_16x16x32_bf16 v[116:119], v[36:39], a[84:87], v[116:119]
    ds_read_b64_tr_b16 v[32:33], v16 offset:49152
    ds_read_b64_tr_b16 v[34:35], v16 offset:53248
    s_waitcnt lgkmcnt(4)
    v_mfma_f32_16x16x32_bf16 v[88:91], v[40:43], a[20:23], v[88:91]
    v_mfma_f32_16x16x32_bf16 v[120:123], v[40:43], a[84:87], v[120:123]
    ds_read_b64_tr_b16 v[36:37], v17 offset:49152
    ds_read_b64_tr_b16 v[38:39], v17 offset:53248
    s_waitcnt lgkmcnt(4)
    v_mfma_f32_16x16x32_bf16 v[92:95], v[44:47], a[20:23], v[92:95]
    v_mfma_f32_16x16x32_bf16 v[124:127], v[44:47], a[84:87], v[124:127]
    ds_read_b64_tr_b16 v[40:41], v18 offset:49152
    ds_read_b64_tr_b16 v[42:43], v18 offset:53248
    s_waitcnt lgkmcnt(4)
    v_mfma_f32_16x16x32_bf16 v[64:67], v[32:35], a[24:27], v[64:67]
    v_mfma_f32_16x16x32_bf16 v[96:99], v[32:35], a[88:91], v[96:99]
    ds_read_b64_tr_b16 v[44:45], v19 offset:49152
    ds_read_b64_tr_b16 v[46:47], v19 offset:53248
    s_waitcnt lgkmcnt(4)
    v_mfma_f32_16x16x32_bf16 v[68:71], v[36:39], a[24:27], v[68:71]
    v_mfma_f32_16x16x32_bf16 v[100:103], v[36:39], a[88:91], v[100:103]
    ds_read_b64_tr_b16 v[32:33], v20 offset:49152
    ds_read_b64_tr_b16 v[34:35], v20 offset:53248
    s_waitcnt lgkmcnt(4)
    v_mfma_f32_16x16x32_bf16 v[72:75], v[40:43], a[24:27], v[72:75]
    v_mfma_f32_16x16x32_bf16 v[104:107], v[40:43], a[88:91], v[104:107]
    ds_read_b64_tr_b16 v[36:37], v21 offset:49152
    ds_read_b64_tr_b16 v[38:39], v21 offset:53248
    s_waitcnt lgkmcnt(4)
    v_mfma_f32_16x16x32_bf16 v[76:79], v[44:47], a[24:27], v[76:79]
    v_mfma_f32_16x16x32_bf16 v[108:111], v[44:47], a[88:91], v[108:111]
    ds_read_b64_tr_b16 v[40:41], v22 offset:49152
    ds_read_b64_tr_b16 v[42:43], v22 offset:53248
    s_waitcnt lgkmcnt(4)
    v_mfma_f32_16x16x32_bf16 v[80:83], v[32:35], a[24:27], v[80:83]
    v_mfma_f32_16x16x32_bf16 v[112:115], v[32:35], a[88:91], v[112:115]
    ds_read_b64_tr_b16 v[44:45], v23 offset:49152
    ds_read_b64_tr_b16 v[46:47], v23 offset:53248
    s_waitcnt lgkmcnt(4)
    v_mfma_f32_16x16x32_bf16 v[84:87], v[36:39], a[24:27], v[84:87]
    v_mfma_f32_16x16x32_bf16 v[116:119], v[36:39], a[88:91], v[116:119]
    ds_read_b64_tr_b16 v[32:33], v16 offset:57344
    ds_read_b64_tr_b16 v[34:35], v16 offset:61440
    s_waitcnt lgkmcnt(4)
    v_mfma_f32_16x16x32_bf16 v[88:91], v[40:43], a[24:27], v[88:91]
    v_mfma_f32_16x16x32_bf16 v[120:123], v[40:43], a[88:91], v[120:123]
    ds_read_b64_tr_b16 v[36:37], v17 offset:57344
    ds_read_b64_tr_b16 v[38:39], v17 offset:61440
    s_waitcnt lgkmcnt(4)
    v_mfma_f32_16x16x32_bf16 v[92:95], v[44:47], a[24:27], v[92:95]
    v_mfma_f32_16x16x32_bf16 v[124:127], v[44:47], a[88:91], v[124:127]
    ds_read_b64_tr_b16 v[40:41], v18 offset:57344
    ds_read_b64_tr_b16 v[42:43], v18 offset:61440
    s_waitcnt lgkmcnt(4)
    v_mfma_f32_16x16x32_bf16 v[64:67], v[32:35], a[28:31], v[64:67]
    v_mfma_f32_16x16x32_bf16 v[96:99], v[32:35], a[92:95], v[96:99]
    ds_read_b64_tr_b16 v[44:45], v19 offset:57344
    ds_read_b64_tr_b16 v[46:47], v19 offset:61440
    s_waitcnt lgkmcnt(4)
    v_mfma_f32_16x16x32_bf16 v[68:71], v[36:39], a[28:31], v[68:71]
    v_mfma_f32_16x16x32_bf16 v[100:103], v[36:39], a[92:95], v[100:103]
    ds_read_b64_tr_b16 v[32:33], v20 offset:57344
    ds_read_b64_tr_b16 v[34:35], v20 offset:61440
    s_waitcnt lgkmcnt(4)
    v_mfma_f32_16x16x32_bf16 v[72:75], v[40:43], a[28:31], v[72:75]
    v_mfma_f32_16x16x32_bf16 v[104:107], v[40:43], a[92:95], v[104:107]
    ds_read_b64_tr_b16 v[36:37], v21 offset:57344
    ds_read_b64_tr_b16 v[38:39], v21 offset:61440
    s_waitcnt lgkmcnt(4)
    v_mfma_f32_16x16x32_bf16 v[76:79], v[44:47], a[28:31], v[76:79]
    v_mfma_f32_16x16x32_bf16 v[108:111], v[44:47], a[92:95], v[108:111]
    ds_read_b64_tr_b16 v[40:41], v22 offset:57344
    ds_read_b64_tr_b16 v[42:43], v22 offset:61440
    s_waitcnt lgkmcnt(4)
    v_mfma_f32_16x16x32_bf16 v[80:83], v[32:35], a[28:31], v[80:83]
    v_mfma_f32_16x16x32_bf16 v[112:115], v[32:35], a[92:95], v[112:115]
    ds_read_b64_tr_b16 v[44:45], v23 offset:57344
    ds_read_b64_tr_b16 v[46:47], v23 offset:61440
    s_waitcnt lgkmcnt(4)
    v_mfma_f32_16x16x32_bf16 v[84:87], v[36:39], a[28:31], v[84:87]
    v_mfma_f32_16x16x32_bf16 v[116:119], v[36:39], a[92:95], v[116:119]
    ds_read_b64_tr_b16 v[32:33], v24 offset:0
    ds_read_b64_tr_b16 v[34:35], v24 offset:4096
    s_waitcnt lgkmcnt(4)
    v_mfma_f32_16x16x32_bf16 v[88:91], v[40:43], a[28:31], v[88:91]
    v_mfma_f32_16x16x32_bf16 v[120:123], v[40:43], a[92:95], v[120:123]
    ds_read_b64_tr_b16 v[36:37], v25 offset:0
    ds_read_b64_tr_b16 v[38:39], v25 offset:4096
    s_waitcnt lgkmcnt(4)
    v_mfma_f32_16x16x32_bf16 v[92:95], v[44:47], a[28:31], v[92:95]
    v_mfma_f32_16x16x32_bf16 v[124:127], v[44:47], a[92:95], v[124:127]
    ds_read_b64_tr_b16 v[40:41], v26 offset:0
    ds_read_b64_tr_b16 v[42:43], v26 offset:4096
    s_waitcnt lgkmcnt(4)
    v_mfma_f32_16x16x32_bf16 v[64:67], v[32:35], a[32:35], v[64:67]
    v_mfma_f32_16x16x32_bf16 v[96:99], v[32:35], a[96:99], v[96:99]
    ds_read_b64_tr_b16 v[44:45], v27 offset:0
    ds_read_b64_tr_b16 v[46:47], v27 offset:4096
    s_waitcnt lgkmcnt(4)
    v_mfma_f32_16x16x32_bf16 v[68:71], v[36:39], a[32:35], v[68:71]
    v_mfma_f32_16x16x32_bf16 v[100:103], v[36:39], a[96:99], v[100:103]
    ds_read_b64_tr_b16 v[32:33], v28 offset:0
    ds_read_b64_tr_b16 v[34:35], v28 offset:4096
    s_waitcnt lgkmcnt(4)
    v_mfma_f32_16x16x32_bf16 v[72:75], v[40:43], a[32:35], v[72:75]
    v_mfma_f32_16x16x32_bf16 v[104:107], v[40:43], a[96:99], v[104:107]
    ds_read_b64_tr_b16 v[36:37], v29 offset:0
    ds_read_b64_tr_b16 v[38:39], v29 offset:4096
    s_waitcnt lgkmcnt(4)
    v_mfma_f32_16x16x32_bf16 v[76:79], v[44:47], a[32:35], v[76:79]
    v_mfma_f32_16x16x32_bf16 v[108:111], v[44:47], a[96:99], v[108:111]
    ds_read_b64_tr_b16 v[40:41], v30 offset:0
    ds_read_b64_tr_b16 v[42:43], v30 offset:4096
    s_waitcnt lgkmcnt(4)
    v_mfma_f32_16x16x32_bf16 v[80:83], v[32:35], a[32:35], v[80:83]
    v_mfma_f32_16x16x32_bf16 v[112:115], v[32:35], a[96:99], v[112:115]
    ds_read_b64_tr_b16 v[44:45], v31 offset:0
    ds_read_b64_tr_b16 v[46:47], v31 offset:4096
    s_waitcnt lgkmcnt(4)
    v_mfma_f32_16x16x32_bf16 v[84:87], v[36:39], a[32:35], v[84:87]
    v_mfma_f32_16x16x32_bf16 v[116:119], v[36:39], a[96:99], v[116:119]
    ds_read_b64_tr_b16 v[32:33], v24 offset:8192
    ds_read_b64_tr_b16 v[34:35], v24 offset:12288
    s_waitcnt lgkmcnt(4)
    v_mfma_f32_16x16x32_bf16 v[88:91], v[40:43], a[32:35], v[88:91]
    v_mfma_f32_16x16x32_bf16 v[120:123], v[40:43], a[96:99], v[120:123]
    ds_read_b64_tr_b16 v[36:37], v25 offset:8192
    ds_read_b64_tr_b16 v[38:39], v25 offset:12288
    s_waitcnt lgkmcnt(4)
    v_mfma_f32_16x16x32_bf16 v[92:95], v[44:47], a[32:35], v[92:95]
    v_mfma_f32_16x16x32_bf16 v[124:127], v[44:47], a[96:99], v[124:127]
    ds_read_b64_tr_b16 v[40:41], v26 offset:8192
    ds_read_b64_tr_b16 v[42:43], v26 offset:12288
    s_waitcnt lgkmcnt(4)
    v_mfma_f32_16x16x32_bf16 v[64:67], v[32:35], a[36:39], v[64:67]
    v_mfma_f32_16x16x32_bf16 v[96:99], v[32:35], a[100:103], v[96:99]
    ds_read_b64_tr_b16 v[44:45], v27 offset:8192
    ds_read_b64_tr_b16 v[46:47], v27 offset:12288
    s_waitcnt lgkmcnt(4)
    v_mfma_f32_16x16x32_bf16 v[68:71], v[36:39], a[36:39], v[68:71]
    v_mfma_f32_16x16x32_bf16 v[100:103], v[36:39], a[100:103], v[100:103]
    ds_read_b64_tr_b16 v[32:33], v28 offset:8192
    ds_read_b64_tr_b16 v[34:35], v28 offset:12288
    s_waitcnt lgkmcnt(4)
    v_mfma_f32_16x16x32_bf16 v[72:75], v[40:43], a[36:39], v[72:75]
    v_mfma_f32_16x16x32_bf16 v[104:107], v[40:43], a[100:103], v[104:107]
    ds_read_b64_tr_b16 v[36:37], v29 offset:8192
    ds_read_b64_tr_b16 v[38:39], v29 offset:12288
    s_waitcnt lgkmcnt(4)
    v_mfma_f32_16x16x32_bf16 v[76:79], v[44:47], a[36:39], v[76:79]
    v_mfma_f32_16x16x32_bf16 v[108:111], v[44:47], a[100:103], v[108:111]
    ds_read_b64_tr_b16 v[40:41], v30 offset:8192
    ds_read_b64_tr_b16 v[42:43], v30 offset:12288
    s_waitcnt lgkmcnt(4)
    v_mfma_f32_16x16x32_bf16 v[80:83], v[32:35], a[36:39], v[80:83]
    v_mfma_f32_16x16x32_bf16 v[112:115], v[32:35], a[100:103], v[112:115]
    ds_read_b64_tr_b16 v[44:45], v31 offset:8192
    ds_read_b64_tr_b16 v[46:47], v31 offset:12288
    s_waitcnt lgkmcnt(4)
    v_mfma_f32_16x16x32_bf16 v[84:87], v[36:39], a[36:39], v[84:87]
    v_mfma_f32_16x16x32_bf16 v[116:119], v[36:39], a[100:103], v[116:119]
    ds_read_b64_tr_b16 v[32:33], v24 offset:16384
    ds_read_b64_tr_b16 v[34:35], v24 offset:20480
    s_waitcnt lgkmcnt(4)
    v_mfma_f32_16x16x32_bf16 v[88:91], v[40:43], a[36:39], v[88:91]
    v_mfma_f32_16x16x32_bf16 v[120:123], v[40:43], a[100:103], v[120:123]
    ds_read_b64_tr_b16 v[36:37], v25 offset:16384
    ds_read_b64_tr_b16 v[38:39], v25 offset:20480
    s_waitcnt lgkmcnt(4)
    v_mfma_f32_16x16x32_bf16 v[92:95], v[44:47], a[36:39], v[92:95]
    v_mfma_f32_16x16x32_bf16 v[124:127], v[44:47], a[100:103], v[124:127]
    ds_read_b64_tr_b16 v[40:41], v26 offset:16384
    ds_read_b64_tr_b16 v[42:43], v26 offset:20480
    s_waitcnt lgkmcnt(4)
    v_mfma_f32_16x16x32_bf16 v[64:67], v[32:35], a[40:43], v[64:67]
    v_mfma_f32_16x16x32_bf16 v[96:99], v[32:35], a[104:107], v[96:99]
    ds_read_b64_tr_b16 v[44:45], v27 offset:16384
    ds_read_b64_tr_b16 v[46:47], v27 offset:20480
    s_waitcnt lgkmcnt(4)
    v_mfma_f32_16x16x32_bf16 v[68:71], v[36:39], a[40:43], v[68:71]
    v_mfma_f32_16x16x32_bf16 v[100:103], v[36:39], a[104:107], v[100:103]
    ds_read_b64_tr_b16 v[32:33], v28 offset:16384
    ds_read_b64_tr_b16 v[34:35], v28 offset:20480
    s_waitcnt lgkmcnt(4)
    v_mfma_f32_16x16x32_bf16 v[72:75], v[40:43], a[40:43], v[72:75]
    v_mfma_f32_16x16x32_bf16 v[104:107], v[40:43], a[104:107], v[104:107]
    ds_read_b64_tr_b16 v[36:37], v29 offset:16384
    ds_read_b64_tr_b16 v[38:39], v29 offset:20480
    s_waitcnt lgkmcnt(4)
    v_mfma_f32_16x16x32_bf16 v[76:79], v[44:47], a[40:43], v[76:79]
    v_mfma_f32_16x16x32_bf16 v[108:111], v[44:47], a[104:107], v[108:111]
    ds_read_b64_tr_b16 v[40:41], v30 offset:16384
    ds_read_b64_tr_b16 v[42:43], v30 offset:20480
    s_waitcnt lgkmcnt(4)
    v_mfma_f32_16x16x32_bf16 v[80:83], v[32:35], a[40:43], v[80:83]
    v_mfma_f32_16x16x32_bf16 v[112:115], v[32:35], a[104:107], v[112:115]
    ds_read_b64_tr_b16 v[44:45], v31 offset:16384
    ds_read_b64_tr_b16 v[46:47], v31 offset:20480
    s_waitcnt lgkmcnt(4)
    v_mfma_f32_16x16x32_bf16 v[84:87], v[36:39], a[40:43], v[84:87]
    v_mfma_f32_16x16x32_bf16 v[116:119], v[36:39], a[104:107], v[116:119]
    ds_read_b64_tr_b16 v[32:33], v24 offset:24576
    ds_read_b64_tr_b16 v[34:35], v24 offset:28672
    s_waitcnt lgkmcnt(4)
    v_mfma_f32_16x16x32_bf16 v[88:91], v[40:43], a[40:43], v[88:91]
    v_mfma_f32_16x16x32_bf16 v[120:123], v[40:43], a[104:107], v[120:123]
    ds_read_b64_tr_b16 v[36:37], v25 offset:24576
    ds_read_b64_tr_b16 v[38:39], v25 offset:28672
    s_waitcnt lgkmcnt(4)
    v_mfma_f32_16x16x32_bf16 v[92:95], v[44:47], a[40:43], v[92:95]
    v_mfma_f32_16x16x32_bf16 v[124:127], v[44:47], a[104:107], v[124:127]
    ds_read_b64_tr_b16 v[40:41], v26 offset:24576
    ds_read_b64_tr_b16 v[42:43], v26 offset:28672
    s_waitcnt lgkmcnt(4)
    v_mfma_f32_16x16x32_bf16 v[64:67], v[32:35], a[44:47], v[64:67]
    v_mfma_f32_16x16x32_bf16 v[96:99], v[32:35], a[108:111], v[96:99]
    ds_read_b64_tr_b16 v[44:45], v27 offset:24576
    ds_read_b64_tr_b16 v[46:47], v27 offset:28672
    s_waitcnt lgkmcnt(4)
    v_mfma_f32_16x16x32_bf16 v[68:71], v[36:39], a[44:47], v[68:71]
    v_mfma_f32_16x16x32_bf16 v[100:103], v[36:39], a[108:111], v[100:103]
    ds_read_b64_tr_b16 v[32:33], v28 offset:24576
    ds_read_b64_tr_b16 v[34:35], v28 offset:28672
    s_waitcnt lgkmcnt(4)
    v_mfma_f32_16x16x32_bf16 v[72:75], v[40:43], a[44:47], v[72:75]
    v_mfma_f32_16x16x32_bf16 v[104:107], v[40:43], a[108:111], v[104:107]
    ds_read_b64_tr_b16 v[36:37], v29 offset:24576
    ds_read_b64_tr_b16 v[38:39], v29 offset:28672
    s_waitcnt lgkmcnt(4)
    v_mfma_f32_16x16x32_bf16 v[76:79], v[44:47], a[44:47], v[76:79]
    v_mfma_f32_16x16x32_bf16 v[108:111], v[44:47], a[108:111], v[108:111]
    ds_read_b64_tr_b16 v[40:41], v30 offset:24576
    ds_read_b64_tr_b16 v[42:43], v30 offset:28672
    s_waitcnt lgkmcnt(4)
    v_mfma_f32_16x16x32_bf16 v[80:83], v[32:35], a[44:47], v[80:83]
    v_mfma_f32_16x16x32_bf16 v[112:115], v[32:35], a[108:111], v[112:115]
    ds_read_b64_tr_b16 v[44:45], v31 offset:24576
    ds_read_b64_tr_b16 v[46:47], v31 offset:28672
    s_waitcnt lgkmcnt(4)
    v_mfma_f32_16x16x32_bf16 v[84:87], v[36:39], a[44:47], v[84:87]
    v_mfma_f32_16x16x32_bf16 v[116:119], v[36:39], a[108:111], v[116:119]
    ds_read_b64_tr_b16 v[32:33], v24 offset:32768
    ds_read_b64_tr_b16 v[34:35], v24 offset:36864
    s_waitcnt lgkmcnt(4)
    v_mfma_f32_16x16x32_bf16 v[88:91], v[40:43], a[44:47], v[88:91]
    v_mfma_f32_16x16x32_bf16 v[120:123], v[40:43], a[108:111], v[120:123]
    ds_read_b64_tr_b16 v[36:37], v25 offset:32768
    ds_read_b64_tr_b16 v[38:39], v25 offset:36864
    s_waitcnt lgkmcnt(4)
    v_mfma_f32_16x16x32_bf16 v[92:95], v[44:47], a[44:47], v[92:95]
    v_mfma_f32_16x16x32_bf16 v[124:127], v[44:47], a[108:111], v[124:127]
    ds_read_b64_tr_b16 v[40:41], v26 offset:32768
    ds_read_b64_tr_b16 v[42:43], v26 offset:36864
    s_waitcnt lgkmcnt(4)
    v_mfma_f32_16x16x32_bf16 v[64:67], v[32:35], a[48:51], v[64:67]
    v_mfma_f32_16x16x32_bf16 v[96:99], v[32:35], a[112:115], v[96:99]
    ds_read_b64_tr_b16 v[44:45], v27 offset:32768
    ds_read_b64_tr_b16 v[46:47], v27 offset:36864
    s_waitcnt lgkmcnt(4)
    v_mfma_f32_16x16x32_bf16 v[68:71], v[36:39], a[48:51], v[68:71]
    v_mfma_f32_16x16x32_bf16 v[100:103], v[36:39], a[112:115], v[100:103]
    ds_read_b64_tr_b16 v[32:33], v28 offset:32768
    ds_read_b64_tr_b16 v[34:35], v28 offset:36864
    s_waitcnt lgkmcnt(4)
    v_mfma_f32_16x16x32_bf16 v[72:75], v[40:43], a[48:51], v[72:75]
    v_mfma_f32_16x16x32_bf16 v[104:107], v[40:43], a[112:115], v[104:107]
    ds_read_b64_tr_b16 v[36:37], v29 offset:32768
    ds_read_b64_tr_b16 v[38:39], v29 offset:36864
    s_waitcnt lgkmcnt(4)
    v_mfma_f32_16x16x32_bf16 v[76:79], v[44:47], a[48:51], v[76:79]
    v_mfma_f32_16x16x32_bf16 v[108:111], v[44:47], a[112:115], v[108:111]
    ds_read_b64_tr_b16 v[40:41], v30 offset:32768
    ds_read_b64_tr_b16 v[42:43], v30 offset:36864
    s_waitcnt lgkmcnt(4)
    v_mfma_f32_16x16x32_bf16 v[80:83], v[32:35], a[48:51], v[80:83]
    v_mfma_f32_16x16x32_bf16 v[112:115], v[32:35], a[112:115], v[112:115]
    ds_read_b64_tr_b16 v[44:45], v31 offset:32768
    ds_read_b64_tr_b16 v[46:47], v31 offset:36864
    s_waitcnt lgkmcnt(4)
    v_mfma_f32_16x16x32_bf16 v[84:87], v[36:39], a[48:51], v[84:87]
    v_mfma_f32_16x16x32_bf16 v[116:119], v[36:39], a[112:115], v[116:119]
    ds_read_b64_tr_b16 v[32:33], v24 offset:40960
    ds_read_b64_tr_b16 v[34:35], v24 offset:45056
    s_waitcnt lgkmcnt(4)
    v_mfma_f32_16x16x32_bf16 v[88:91], v[40:43], a[48:51], v[88:91]
    v_mfma_f32_16x16x32_bf16 v[120:123], v[40:43], a[112:115], v[120:123]
    ds_read_b64_tr_b16 v[36:37], v25 offset:40960
    ds_read_b64_tr_b16 v[38:39], v25 offset:45056
    s_waitcnt lgkmcnt(4)
    v_mfma_f32_16x16x32_bf16 v[92:95], v[44:47], a[48:51], v[92:95]
    v_mfma_f32_16x16x32_bf16 v[124:127], v[44:47], a[112:115], v[124:127]
    ds_read_b64_tr_b16 v[40:41], v26 offset:40960
    ds_read_b64_tr_b16 v[42:43], v26 offset:45056
    s_waitcnt lgkmcnt(4)
    v_mfma_f32_16x16x32_bf16 v[64:67], v[32:35], a[52:55], v[64:67]
    v_mfma_f32_16x16x32_bf16 v[96:99], v[32:35], a[116:119], v[96:99]
    ds_read_b64_tr_b16 v[44:45], v27 offset:40960
    ds_read_b64_tr_b16 v[46:47], v27 offset:45056
    s_waitcnt lgkmcnt(4)
    v_mfma_f32_16x16x32_bf16 v[68:71], v[36:39], a[52:55], v[68:71]
    v_mfma_f32_16x16x32_bf16 v[100:103], v[36:39], a[116:119], v[100:103]
    ds_read_b64_tr_b16 v[32:33], v28 offset:40960
    ds_read_b64_tr_b16 v[34:35], v28 offset:45056
    s_waitcnt lgkmcnt(4)
    v_mfma_f32_16x16x32_bf16 v[72:75], v[40:43], a[52:55], v[72:75]
    v_mfma_f32_16x16x32_bf16 v[104:107], v[40:43], a[116:119], v[104:107]
    ds_read_b64_tr_b16 v[36:37], v29 offset:40960
    ds_read_b64_tr_b16 v[38:39], v29 offset:45056
    s_waitcnt lgkmcnt(4)
    v_mfma_f32_16x16x32_bf16 v[76:79], v[44:47], a[52:55], v[76:79]
    v_mfma_f32_16x16x32_bf16 v[108:111], v[44:47], a[116:119], v[108:111]
    ds_read_b64_tr_b16 v[40:41], v30 offset:40960
    ds_read_b64_tr_b16 v[42:43], v30 offset:45056
    s_waitcnt lgkmcnt(4)
    v_mfma_f32_16x16x32_bf16 v[80:83], v[32:35], a[52:55], v[80:83]
    v_mfma_f32_16x16x32_bf16 v[112:115], v[32:35], a[116:119], v[112:115]
    ds_read_b64_tr_b16 v[44:45], v31 offset:40960
    ds_read_b64_tr_b16 v[46:47], v31 offset:45056
    s_waitcnt lgkmcnt(4)
    v_mfma_f32_16x16x32_bf16 v[84:87], v[36:39], a[52:55], v[84:87]
    v_mfma_f32_16x16x32_bf16 v[116:119], v[36:39], a[116:119], v[116:119]
    ds_read_b64_tr_b16 v[32:33], v24 offset:49152
    ds_read_b64_tr_b16 v[34:35], v24 offset:53248
    s_waitcnt lgkmcnt(4)
    v_mfma_f32_16x16x32_bf16 v[88:91], v[40:43], a[52:55], v[88:91]
    v_mfma_f32_16x16x32_bf16 v[120:123], v[40:43], a[116:119], v[120:123]
    ds_read_b64_tr_b16 v[36:37], v25 offset:49152
    ds_read_b64_tr_b16 v[38:39], v25 offset:53248
    s_waitcnt lgkmcnt(4)
    v_mfma_f32_16x16x32_bf16 v[92:95], v[44:47], a[52:55], v[92:95]
    v_mfma_f32_16x16x32_bf16 v[124:127], v[44:47], a[116:119], v[124:127]
    ds_read_b64_tr_b16 v[40:41], v26 offset:49152
    ds_read_b64_tr_b16 v[42:43], v26 offset:53248
    s_waitcnt lgkmcnt(4)
    v_mfma_f32_16x16x32_bf16 v[64:67], v[32:35], a[56:59], v[64:67]
    v_mfma_f32_16x16x32_bf16 v[96:99], v[32:35], a[120:123], v[96:99]
    ds_read_b64_tr_b16 v[44:45], v27 offset:49152
    ds_read_b64_tr_b16 v[46:47], v27 offset:53248
    s_waitcnt lgkmcnt(4)
    v_mfma_f32_16x16x32_bf16 v[68:71], v[36:39], a[56:59], v[68:71]
    v_mfma_f32_16x16x32_bf16 v[100:103], v[36:39], a[120:123], v[100:103]
    ds_read_b64_tr_b16 v[32:33], v28 offset:49152
    ds_read_b64_tr_b16 v[34:35], v28 offset:53248
    s_waitcnt lgkmcnt(4)
    v_mfma_f32_16x16x32_bf16 v[72:75], v[40:43], a[56:59], v[72:75]
    v_mfma_f32_16x16x32_bf16 v[104:107], v[40:43], a[120:123], v[104:107]
    ds_read_b64_tr_b16 v[36:37], v29 offset:49152
    ds_read_b64_tr_b16 v[38:39], v29 offset:53248
    s_waitcnt lgkmcnt(4)
    v_mfma_f32_16x16x32_bf16 v[76:79], v[44:47], a[56:59], v[76:79]
    v_mfma_f32_16x16x32_bf16 v[108:111], v[44:47], a[120:123], v[108:111]
    ds_read_b64_tr_b16 v[40:41], v30 offset:49152
    ds_read_b64_tr_b16 v[42:43], v30 offset:53248
    s_waitcnt lgkmcnt(4)
    v_mfma_f32_16x16x32_bf16 v[80:83], v[32:35], a[56:59], v[80:83]
    v_mfma_f32_16x16x32_bf16 v[112:115], v[32:35], a[120:123], v[112:115]
    ds_read_b64_tr_b16 v[44:45], v31 offset:49152
    ds_read_b64_tr_b16 v[46:47], v31 offset:53248
    s_waitcnt lgkmcnt(4)
    v_mfma_f32_16x16x32_bf16 v[84:87], v[36:39], a[56:59], v[84:87]
    v_mfma_f32_16x16x32_bf16 v[116:119], v[36:39], a[120:123], v[116:119]
    ds_read_b64_tr_b16 v[32:33], v24 offset:57344
    ds_read_b64_tr_b16 v[34:35], v24 offset:61440
    s_waitcnt lgkmcnt(4)
    v_mfma_f32_16x16x32_bf16 v[88:91], v[40:43], a[56:59], v[88:91]
    v_mfma_f32_16x16x32_bf16 v[120:123], v[40:43], a[120:123], v[120:123]
    ds_read_b64_tr_b16 v[36:37], v25 offset:57344
    ds_read_b64_tr_b16 v[38:39], v25 offset:61440
    s_waitcnt lgkmcnt(4)
    v_mfma_f32_16x16x32_bf16 v[92:95], v[44:47], a[56:59], v[92:95]
    v_mfma_f32_16x16x32_bf16 v[124:127], v[44:47], a[120:123], v[124:127]
    ds_read_b64_tr_b16 v[40:41], v26 offset:57344
    ds_read_b64_tr_b16 v[42:43], v26 offset:61440
    s_waitcnt lgkmcnt(4)
    v_mfma_f32_16x16x32_bf16 v[64:67], v[32:35], a[60:63], v[64:67]
    v_mfma_f32_16x16x32_bf16 v[96:99], v[32:35], a[124:127], v[96:99]
    ds_read_b64_tr_b16 v[44:45], v27 offset:57344
    ds_read_b64_tr_b16 v[46:47], v27 offset:61440
    s_waitcnt lgkmcnt(4)
    v_mfma_f32_16x16x32_bf16 v[68:71], v[36:39], a[60:63], v[68:71]
    v_mfma_f32_16x16x32_bf16 v[100:103], v[36:39], a[124:127], v[100:103]
    ds_read_b64_tr_b16 v[32:33], v28 offset:57344
    ds_read_b64_tr_b16 v[34:35], v28 offset:61440
    s_waitcnt lgkmcnt(4)
    v_mfma_f32_16x16x32_bf16 v[72:75], v[40:43], a[60:63], v[72:75]
    v_mfma_f32_16x16x32_bf16 v[104:107], v[40:43], a[124:127], v[104:107]
    ds_read_b64_tr_b16 v[36:37], v29 offset:57344
    ds_read_b64_tr_b16 v[38:39], v29 offset:61440
    s_waitcnt lgkmcnt(4)
    v_mfma_f32_16x16x32_bf16 v[76:79], v[44:47], a[60:63], v[76:79]
    v_mfma_f32_16x16x32_bf16 v[108:111], v[44:47], a[124:127], v[108:111]
    ds_read_b64_tr_b16 v[40:41], v30 offset:57344
    ds_read_b64_tr_b16 v[42:43], v30 offset:61440
    s_waitcnt lgkmcnt(4)
    v_mfma_f32_16x16x32_bf16 v[80:83], v[32:35], a[60:63], v[80:83]
    v_mfma_f32_16x16x32_bf16 v[112:115], v[32:35], a[124:127], v[112:115]
    ds_read_b64_tr_b16 v[44:45], v31 offset:57344
    ds_read_b64_tr_b16 v[46:47], v31 offset:61440
    s_waitcnt lgkmcnt(4)
    v_mfma_f32_16x16x32_bf16 v[84:87], v[36:39], a[60:63], v[84:87]
    v_mfma_f32_16x16x32_bf16 v[116:119], v[36:39], a[124:127], v[116:119]
    s_waitcnt lgkmcnt(2)
    v_mfma_f32_16x16x32_bf16 v[88:91], v[40:43], a[60:63], v[88:91]
    v_mfma_f32_16x16x32_bf16 v[120:123], v[40:43], a[124:127], v[120:123]
    s_waitcnt lgkmcnt(0)
    v_mfma_f32_16x16x32_bf16 v[92:95], v[44:47], a[60:63], v[92:95]
    v_mfma_f32_16x16x32_bf16 v[124:127], v[44:47], a[124:127], v[124:127]
    v_cvt_pk_bf16_f32 v128, v64, v65
    v_cvt_pk_bf16_f32 v129, v66, v67
    v_cvt_pk_bf16_f32 v130, v68, v69
    v_cvt_pk_bf16_f32 v131, v70, v71
    v_cvt_pk_bf16_f32 v132, v72, v73
    v_cvt_pk_bf16_f32 v133, v74, v75
    v_cvt_pk_bf16_f32 v134, v76, v77
    v_cvt_pk_bf16_f32 v135, v78, v79
    v_cvt_pk_bf16_f32 v136, v80, v81
    v_cvt_pk_bf16_f32 v137, v82, v83
    v_cvt_pk_bf16_f32 v138, v84, v85
    v_cvt_pk_bf16_f32 v139, v86, v87
    v_cvt_pk_bf16_f32 v140, v88, v89
    v_cvt_pk_bf16_f32 v141, v90, v91
    v_cvt_pk_bf16_f32 v142, v92, v93
    v_cvt_pk_bf16_f32 v143, v94, v95
    v_cvt_pk_bf16_f32 v144, v96, v97
    v_cvt_pk_bf16_f32 v145, v98, v99
    v_cvt_pk_bf16_f32 v146, v100, v101
    v_cvt_pk_bf16_f32 v147, v102, v103
    v_cvt_pk_bf16_f32 v148, v104, v105
    v_cvt_pk_bf16_f32 v149, v106, v107
    v_cvt_pk_bf16_f32 v150, v108, v109
    v_cvt_pk_bf16_f32 v151, v110, v111
    v_cvt_pk_bf16_f32 v152, v112, v113
    v_cvt_pk_bf16_f32 v153, v114, v115
    v_cvt_pk_bf16_f32 v154, v116, v117
    v_cvt_pk_bf16_f32 v155, v118, v119
    v_cvt_pk_bf16_f32 v156, v120, v121
    v_cvt_pk_bf16_f32 v157, v122, v123
    v_cvt_pk_bf16_f32 v158, v124, v125
    v_cvt_pk_bf16_f32 v159, v126, v127
    s_add_u32 s34, s32, 1
    s_mov_b32 s24, 32768
WF_27:
    buffer_load_dword v3, v10, s[4:7], 0 offen sc1
    s_waitcnt vmcnt(0)
    v_cmp_gt_u32 vcc, s34, v3
    s_sub_u32 s24, s24, 1
    s_cbranch_scc1 WFE_28
    s_nop 2
    s_cbranch_vccz WFE_28
    s_sleep 1
    s_branch WF_27
WFE_28:
    s_lshl_b32 s35, s31, 18
    s_lshl_b32 s36, s21, 13
    s_add_u32 s35, s35, s36
    s_add_u32 s36, s35, 0x1000000
    buffer_load_dwordx4 v[160:163], v9, s[4:7], s36 offen offset:0
    buffer_load_dwordx4 v[164:167], v9, s[4:7], s36 offen offset:1024
    buffer_load_dwordx4 v[168:171], v9, s[4:7], s36 offen offset:2048
    buffer_load_dwordx4 v[172:175], v9, s[4:7], s36 offen offset:3072
    s_add_u32 s36, s36, 4096
    buffer_load_dwordx4 v[176:179], v9, s[4:7], s36 offen offset:0
    buffer_load_dwordx4 v[180:183], v9, s[4:7], s36 offen offset:1024
    buffer_load_dwordx4 v[184:187], v9, s[4:7], s36 offen offset:2048
    buffer_load_dwordx4 v[188:191], v9, s[4:7], s36 offen offset:3072
    s_add_u32 s36, s35, 0x2000000
    buffer_load_dwordx4 v[208:211], v9, s[4:7], s36 offen offset:0
    buffer_load_dwordx4 v[212:215], v9, s[4:7], s36 offen offset:1024
    buffer_load_dwordx4 v[216:219], v9, s[4:7], s36 offen offset:2048
    buffer_load_dwordx4 v[220:223], v9, s[4:7], s36 offen offset:3072
    s_add_u32 s36, s36, 4096
    buffer_load_dwordx4 v[224:227], v9, s[4:7], s36 offen offset:0
    buffer_load_dwordx4 v[228:231], v9, s[4:7], s36 offen offset:1024
    buffer_load_dwordx4 v[232:235], v9, s[4:7], s36 offen offset:2048
    buffer_load_dwordx4 v[236:239], v9, s[4:7], s36 offen offset:3072
    s_cmp_ge_u32 s31, 62
    s_cbranch_scc1 QA_LAST
    s_add_u32 s34, s31, 1
    s_mov_b32 s24, 32768
WF_29:
    buffer_load_dword v3, v12, s[4:7], 0 offen sc1
    s_waitcnt vmcnt(0)
    v_cmp_gt_u32 vcc, s34, v3
    s_sub_u32 s24, s24, 1
    s_cbranch_scc1 WFE_30
    s_nop 2
    s_cbranch_vccz WFE_30
    s_sleep 1
    s_branch WF_29
WFE_30:
    s_lshl_b32 s35, s31, 17
    s_lshl_b32 s36, s21, 12
    s_add_u32 s35, s35, s36
    s_add_u32 s36, s35, 0x7000000
    buffer_load_dwordx4 v[192:195], v9, s[4:7], s36 offen offset:0
    buffer_load_dwordx4 v[196:199], v9, s[4:7], s36 offen offset:1024
    buffer_load_dwordx4 v[200:203], v9, s[4:7], s36 offen offset:2048
    buffer_load_dwordx4 v[204:207], v9, s[4:7], s36 offen offset:3072
    s_add_u32 s36, s35, 0x7800000
    buffer_load_dwordx2 v[240:241], v11, s[4:7], s36 offen offset:0
    buffer_load_dwordx2 v[242:243], v11, s[4:7], s36 offen offset:512
    buffer_load_dwordx2 v[244:245], v11, s[4:7], s36 offen offset:1024
    buffer_load_dwordx2 v[246:247], v11, s[4:7], s36 offen offset:1536
    buffer_load_dwordx2 v[248:249], v11, s[4:7], s36 offen offset:2048
    buffer_load_dwordx2 v[250:251], v11, s[4:7], s36 offen offset:2560
    buffer_load_dwordx2 v[252:253], v11, s[4:7], s36 offen offset:3072
    buffer_load_dwordx2 v[254:255], v11, s[4:7], s36 offen offset:3584
QA_GO:
    v_mfma_f32_16x16x32_bf16 v[68:71], v[160:163], v[128:131], 0
    v_mfma_f32_16x16x32_bf16 v[76:79], v[160:163], v[144:147], 0
    v_mfma_f32_16x16x32_bf16 v[80:83], v[176:179], v[144:147], 0
    v_mfma_f32_16x16x32_bf16 v[68:71], v[164:167], v[132:135], v[68:71]
    v_mfma_f32_16x16x32_bf16 v[76:79], v[164:167], v[148:151], v[76:79]
    v_mfma_f32_16x16x32_bf16 v[80:83], v[180:183], v[148:151], v[80:83]
    v_mfma_f32_16x16x32_bf16 v[68:71], v[168:171], v[136:139], v[68:71]
    v_mfma_f32_16x16x32_bf16 v[76:79], v[168:171], v[152:155], v[76:79]
    v_mfma_f32_16x16x32_bf16 v[80:83], v[184:187], v[152:155], v[80:83]
    v_mfma_f32_16x16x32_bf16 v[68:71], v[172:175], v[140:143], v[68:71]
    v_mfma_f32_16x16x32_bf16 v[76:79], v[172:175], v[156:159], v[76:79]
    v_mfma_f32_16x16x32_bf16 v[80:83], v[188:191], v[156:159], v[80:83]
    s_waitcnt vmcnt(8)
    v_mfma_f32_16x16x32_bf16 v[64:67], v[192:195], v[128:131], 0
    v_mfma_f32_16x16x32_bf16 v[72:75], v[192:195], v[144:147], 0
    v_mfma_f32_16x16x32_bf16 v[64:67], v[196:199], v[132:135], v[64:67]
    v_mfma_f32_16x16x32_bf16 v[72:75], v[196:199], v[148:151], v[72:75]
    v_mfma_f32_16x16x32_bf16 v[64:67], v[200:203], v[136:139], v[64:67]
    v_mfma_f32_16x16x32_bf16 v[72:75], v[200:203], v[152:155], v[72:75]
    v_mfma_f32_16x16x32_bf16 v[64:67], v[204:207], v[140:143], v[64:67]
    v_mfma_f32_16x16x32_bf16 v[72:75], v[204:207], v[156:159], v[72:75]
    v_cndmask_b32 v68, v13, v68, s[64:65]
    v_cndmask_b32 v69, v13, v69, s[66:67]
    v_cndmask_b32 v70, v13, v70, s[68:69]
    v_cndmask_b32 v71, v13, v71, s[70:71]
    v_cndmask_b32 v80, v13, v80, s[64:65]
    v_cndmask_b32 v81, v13, v81, s[66:67]
    v_cndmask_b32 v82, v13, v82, s[68:69]
    v_cndmask_b32 v83, v13, v83, s[70:71]
    v_max3_f32 v92, v64, v65, v66
    v_max3_f32 v93, v67, v68, v69
    v_max3_f32 v92, v92, v70, v71
    v_max_f32 v92, v92, v93
    v_max3_f32 v94, v72, v73, v74
    v_max3_f32 v95, v75, v76, v77
    v_max3_f32 v94, v94, v78, v79
    v_max3_f32 v95, v95, v80, v81
    v_max3_f32 v94, v94, v82, v83
    v_max_f32 v94, v94, v95
    v_mov_b32 v93, v92
    v_mov_b32 v95, v94
    s_nop 0
    v_permlane32_swap_b32 v92, v93
    s_nop 0
    v_permlane32_swap_b32 v94, v95
    v_max_f32 v92, v92, v93
    v_max_f32 v94, v94, v95
    v_mov_b32 v93, v92
    v_mov_b32 v95, v94
    s_nop 0
    v_permlane16_swap_b32 v92, v93
    s_nop 0
    v_permlane16_swap_b32 v94, v95
    v_max_f32 v92, v92, v93
    v_max_f32 v94, v94, v95
    v_mul_f32 v92, s46, v92
    v_sub_f32 v92, 0, v92
    v_mul_f32 v94, s46, v94
    v_sub_f32 v94, 0, v94
    v_pk_fma_f32 v[64:65], v[64:65], s[46:47], v[92:93] op_sel_hi:[1,1,0]
    v_pk_fma_f32 v[66:67], v[66:67], s[46:47], v[92:93] op_sel_hi:[1,1,0]
    v_pk_fma_f32 v[68:69], v[68:69], s[46:47], v[92:93] op_sel_hi:[1,1,0]
    v_pk_fma_f32 v[70:71], v[70:71], s[46:47], v[92:93] op_sel_hi:[1,1,0]
    v_pk_fma_f32 v[72:73], v[72:73], s[46:47], v[94:95] op_sel_hi:[1,1,0]
    v_pk_fma_f32 v[74:75], v[74:75], s[46:47], v[94:95] op_sel_hi:[1,1,0]
    v_pk_fma_f32 v[76:77], v[76:77], s[46:47], v[94:95] op_sel_hi:[1,1,0]
    v_pk_fma_f32 v[78:79], v[78:79], s[46:47], v[94:95] op_sel_hi:[1,1,0]
    v_pk_fma_f32 v[80:81], v[80:81], s[46:47], v[94:95] op_sel_hi:[1,1,0]
    v_pk_fma_f32 v[82:83], v[82:83], s[46:47], v[94:95] op_sel_hi:[1,1,0]
    v_exp_f32 v64, v64
    v_exp_f32 v65, v65
    v_exp_f32 v66, v66
    v_exp_f32 v67, v67
    v_exp_f32 v68, v68
    v_exp_f32 v69, v69
    v_exp_f32 v70, v70
    v_exp_f32 v71, v71
    v_exp_f32 v72, v72
    v_exp_f32 v73, v73
    v_exp_f32 v74, v74
    v_exp_f32 v75, v75
    v_exp_f32 v76, v76
    v_exp_f32 v77, v77
    v_exp_f32 v78, v78
    v_exp_f32 v79, v79
    v_exp_f32 v80, v80
    v_exp_f32 v81, v81
    v_exp_f32 v82, v82
    v_exp_f32 v83, v83
    v_cvt_pk_bf16_f32 v32, v68, v69
    v_cvt_pk_bf16_f32 v33, v70, v71
    v_mov_b32 v34, 0
    v_mov_b32 v35, 0
    v_cvt_pk_bf16_f32 v36, v64, v65
    v_cvt_pk_bf16_f32 v37, v66, v67
    v_cvt_pk_bf16_f32 v40, v76, v77
    v_cvt_pk_bf16_f32 v41, v78, v79
    v_cvt_pk_bf16_f32 v42, v80, v81
    v_cvt_pk_bf16_f32 v43, v82, v83
    v_cvt_pk_bf16_f32 v44, v72, v73
    v_cvt_pk_bf16_f32 v45, v74, v75
    s_waitcnt vmcnt(0)
    v_mfma_f32_16x16x32_bf16 v[84:87], v[4:7], v[32:35], 0
    v_mfma_f32_16x16x32_bf16 v[96:99], v[208:211], v[32:35], 0
    v_mfma_f32_16x16x32_bf16 v[100:103], v[212:215], v[32:35], 0
    v_mfma_f32_16x16x32_bf16 v[104:107], v[216:219], v[32:35], 0
    v_mfma_f32_16x16x32_bf16 v[108:111], v[220:223], v[32:35], 0
    v_mfma_f32_16x16x32_bf16 v[112:115], v[224:227], v[32:35], 0
    v_mfma_f32_16x16x32_bf16 v[116:119], v[228:231], v[32:35], 0
    v_mfma_f32_16x16x32_bf16 v[120:123], v[232:235], v[32:35], 0
    v_mfma_f32_16x16x32_bf16 v[124:127], v[236:239], v[32:35], 0
    v_mfma_f32_16x16x16_bf16 v[84:87], v[14:15], v[36:37], v[84:87]
    v_mfma_f32_16x16x16_bf16 v[96:99], v[240:241], v[36:37], v[96:99]
    v_mfma_f32_16x16x16_bf16 v[100:103], v[242:243], v[36:37], v[100:103]
    v_mfma_f32_16x16x16_bf16 v[104:107], v[244:245], v[36:37], v[104:107]
    v_mfma_f32_16x16x16_bf16 v[108:111], v[246:247], v[36:37], v[108:111]
    v_mfma_f32_16x16x16_bf16 v[112:115], v[248:249], v[36:37], v[112:115]
    v_mfma_f32_16x16x16_bf16 v[116:119], v[250:251], v[36:37], v[116:119]
    v_mfma_f32_16x16x16_bf16 v[120:123], v[252:253], v[36:37], v[120:123]
    v_mfma_f32_16x16x16_bf16 v[124:127], v[254:255], v[36:37], v[124:127]
    v_mfma_f32_16x16x32_bf16 v[88:91], v[4:7], v[40:43], 0
    v_mfma_f32_16x16x32_bf16 v[128:131], v[208:211], v[40:43], 0
    v_mfma_f32_16x16x32_bf16 v[132:135], v[212:215], v[40:43], 0
    v_mfma_f32_16x16x32_bf16 v[136:139], v[216:219], v[40:43], 0
    v_mfma_f32_16x16x32_bf16 v[140:143], v[220:223], v[40:43], 0
    v_mfma_f32_16x16x32_bf16 v[144:147], v[224:227], v[40:43], 0
    v_mfma_f32_16x16x32_bf16 v[148:151], v[228:231], v[40:43], 0
    v_mfma_f32_16x16x32_bf16 v[152:155], v[232:235], v[40:43], 0
    v_mfma_f32_16x16x32_bf16 v[156:159], v[236:239], v[40:43], 0
    v_mfma_f32_16x16x16_bf16 v[88:91], v[14:15], v[44:45], v[88:91]
    v_mfma_f32_16x16x16_bf16 v[128:131], v[240:241], v[44:45], v[128:131]
    v_mfma_f32_16x16x16_bf16 v[132:135], v[242:243], v[44:45], v[132:135]
    v_mfma_f32_16x16x16_bf16 v[136:139], v[244:245], v[44:45], v[136:139]
    v_mfma_f32_16x16x16_bf16 v[140:143], v[246:247], v[44:45], v[140:143]
    v_mfma_f32_16x16x16_bf16 v[144:147], v[248:249], v[44:45], v[144:147]
    v_mfma_f32_16x16x16_bf16 v[148:151], v[250:251], v[44:45], v[148:151]
    v_mfma_f32_16x16x16_bf16 v[152:155], v[252:253], v[44:45], v[152:155]
    v_mfma_f32_16x16x16_bf16 v[156:159], v[254:255], v[44:45], v[156:159]
    s_lshl_b32 s35, s31, 18
    s_lshl_b32 s36, s21, 12
    s_add_u32 s35, s35, s36
    s_add_u32 s35, s35, 0x3000000
    v_rcp_f32 v84, v84
    s_nop 0
    v_pk_mul_f32 v[96:97], v[96:97], v[84:85] op_sel_hi:[1,0]
    v_pk_mul_f32 v[98:99], v[98:99], v[84:85] op_sel_hi:[1,0]
    v_pk_mul_f32 v[100:101], v[100:101], v[84:85] op_sel_hi:[1,0]
    v_pk_mul_f32 v[102:103], v[102:103], v[84:85] op_sel_hi:[1,0]
    v_pk_mul_f32 v[104:105], v[104:105], v[84:85] op_sel_hi:[1,0]
    v_pk_mul_f32 v[106:107], v[106:107], v[84:85] op_sel_hi:[1,0]
    v_pk_mul_f32 v[108:109], v[108:109], v[84:85] op_sel_hi:[1,0]
    v_pk_mul_f32 v[110:111], v[110:111], v[84:85] op_sel_hi:[1,0]
    v_pk_mul_f32 v[112:113], v[112:113], v[84:85] op_sel_hi:[1,0]
    v_pk_mul_f32 v[114:115], v[114:115], v[84:85] op_sel_hi:[1,0]
    v_pk_mul_f32 v[116:117], v[116:117], v[84:85] op_sel_hi:[1,0]
    v_pk_mul_f32 v[118:119], v[118:119], v[84:85] op_sel_hi:[1,0]
    v_pk_mul_f32 v[120:121], v[120:121], v[84:85] op_sel_hi:[1,0]
    v_pk_mul_f32 v[122:123], v[122:123], v[84:85] op_sel_hi:[1,0]
    v_pk_mul_f32 v[124:125], v[124:125], v[84:85] op_sel_hi:[1,0]
    v_pk_mul_f32 v[126:127], v[126:127], v[84:85] op_sel_hi:[1,0]
    v_cvt_pk_bf16_f32 v48, v96, v97
    v_cvt_pk_bf16_f32 v49, v98, v99
    v_cvt_pk_bf16_f32 v50, v100, v101
    v_cvt_pk_bf16_f32 v51, v102, v103
    buffer_store_dwordx4 v[48:51], v9, s[4:7], s35 offen offset:0 sc1
    v_cvt_pk_bf16_f32 v52, v104, v105
    v_cvt_pk_bf16_f32 v53, v106, v107
    v_cvt_pk_bf16_f32 v54, v108, v109
    v_cvt_pk_bf16_f32 v55, v110, v111
    buffer_store_dwordx4 v[52:55], v9, s[4:7], s35 offen offset:1024 sc1
    v_cvt_pk_bf16_f32 v56, v112, v113
    v_cvt_pk_bf16_f32 v57, v114, v115
    v_cvt_pk_bf16_f32 v58, v116, v117
    v_cvt_pk_bf16_f32 v59, v118, v119
    buffer_store_dwordx4 v[56:59], v9, s[4:7], s35 offen offset:2048 sc1
    v_cvt_pk_bf16_f32 v60, v120, v121
    v_cvt_pk_bf16_f32 v61, v122, v123
    v_cvt_pk_bf16_f32 v62, v124, v125
    v_cvt_pk_bf16_f32 v63, v126, v127
    buffer_store_dwordx4 v[60:63], v9, s[4:7], s35 offen offset:3072 sc1
    v_rcp_f32 v88, v88
    s_nop 0
    v_pk_mul_f32 v[128:129], v[128:129], v[88:89] op_sel_hi:[1,0]
    v_pk_mul_f32 v[130:131], v[130:131], v[88:89] op_sel_hi:[1,0]
    v_pk_mul_f32 v[132:133], v[132:133], v[88:89] op_sel_hi:[1,0]
    v_pk_mul_f32 v[134:135], v[134:135], v[88:89] op_sel_hi:[1,0]
    v_pk_mul_f32 v[136:137], v[136:137], v[88:89] op_sel_hi:[1,0]
    v_pk_mul_f32 v[138:139], v[138:139], v[88:89] op_sel_hi:[1,0]
    v_pk_mul_f32 v[140:141], v[140:141], v[88:89] op_sel_hi:[1,0]
    v_pk_mul_f32 v[142:143], v[142:143], v[88:89] op_sel_hi:[1,0]
    v_pk_mul_f32 v[144:145], v[144:145], v[88:89] op_sel_hi:[1,0]
    v_pk_mul_f32 v[146:147], v[146:147], v[88:89] op_sel_hi:[1,0]
    v_pk_mul_f32 v[148:149], v[148:149], v[88:89] op_sel_hi:[1,0]
    v_pk_mul_f32 v[150:151], v[150:151], v[88:89] op_sel_hi:[1,0]
    v_pk_mul_f32 v[152:153], v[152:153], v[88:89] op_sel_hi:[1,0]
    v_pk_mul_f32 v[154:155], v[154:155], v[88:89] op_sel_hi:[1,0]
    v_pk_mul_f32 v[156:157], v[156:157], v[88:89] op_sel_hi:[1,0]
    v_pk_mul_f32 v[158:159], v[158:159], v[88:89] op_sel_hi:[1,0]
    s_add_u32 s35, s35, 0x20000
    v_cvt_pk_bf16_f32 v48, v128, v129
    v_cvt_pk_bf16_f32 v49, v130, v131
    v_cvt_pk_bf16_f32 v50, v132, v133
    v_cvt_pk_bf16_f32 v51, v134, v135
    buffer_store_dwordx4 v[48:51], v9, s[4:7], s35 offen offset:0 sc1
    v_cvt_pk_bf16_f32 v52, v136, v137
    v_cvt_pk_bf16_f32 v53, v138, v139
    v_cvt_pk_bf16_f32 v54, v140, v141
    v_cvt_pk_bf16_f32 v55, v142, v143
    buffer_store_dwordx4 v[52:55], v9, s[4:7], s35 offen offset:1024 sc1
    v_cvt_pk_bf16_f32 v56, v144, v145
    v_cvt_pk_bf16_f32 v57, v146, v147
    v_cvt_pk_bf16_f32 v58, v148, v149
    v_cvt_pk_bf16_f32 v59, v150, v151
    buffer_store_dwordx4 v[56:59], v9, s[4:7], s35 offen offset:2048 sc1
    v_cvt_pk_bf16_f32 v60, v152, v153
    v_cvt_pk_bf16_f32 v61, v154, v155
    v_cvt_pk_bf16_f32 v62, v156, v157
    v_cvt_pk_bf16_f32 v63, v158, v159
    buffer_store_dwordx4 v[60:63], v9, s[4:7], s35 offen offset:3072 sc1
    s_add_u32 s32, s32, 1
    s_waitcnt vmcnt(0)
    v_mov_b32 v3, s32
    s_mov_b64 exec, 1
    buffer_store_dword v3, v8, s[4:7], 0 offen sc1
    s_mov_b64 exec, -1
    s_add_u32 s31, s31, 4
    s_cmp_lt_u32 s31, 64
    s_cbranch_scc1 QA_LOOP
    s_endpgm
QA_LAST:
    s_mov_b32 s34, s31
    s_mov_b32 s24, 32768
WF_31:
    buffer_load_dword v3, v12, s[4:7], 0 offen sc1
    s_waitcnt vmcnt(0)
    v_cmp_gt_u32 vcc, s34, v3
    s_sub_u32 s24, s24, 1
    s_cbranch_scc1 WFE_32
    s_nop 2
    s_cbranch_vccz WFE_32
    s_sleep 1
    s_branch WF_31
WFE_32:
    s_mov_b32 s34, 32768
QA_LPOLL:
    s_lshl_b32 s35, s31, 17
    s_lshl_b32 s36, s21, 12
    s_add_u32 s35, s35, s36
    s_add_u32 s36, s35, 0x7000000
    buffer_load_dwordx4 v[192:195], v9, s[4:7], s36 offen offset:0 sc1
    buffer_load_dwordx4 v[196:199], v9, s[4:7], s36 offen offset:1024 sc1
    buffer_load_dwordx4 v[200:203], v9, s[4:7], s36 offen offset:2048 sc1
    buffer_load_dwordx4 v[204:207], v9, s[4:7], s36 offen offset:3072 sc1
    s_add_u32 s36, s35, 0x7800000
    buffer_load_dwordx2 v[240:241], v11, s[4:7], s36 offen offset:0 sc1
    buffer_load_dwordx2 v[242:243], v11, s[4:7], s36 offen offset:512 sc1
    buffer_load_dwordx2 v[244:245], v11, s[4:7], s36 offen offset:1024 sc1
    buffer_load_dwordx2 v[246:247], v11, s[4:7], s36 offen offset:1536 sc1
    buffer_load_dwordx2 v[248:249], v11, s[4:7], s36 offen offset:2048 sc1
    buffer_load_dwordx2 v[250:251], v11, s[4:7], s36 offen offset:2560 sc1
    buffer_load_dwordx2 v[252:253], v11, s[4:7], s36 offen offset:3072 sc1
    buffer_load_dwordx2 v[254:255], v11, s[4:7], s36 offen offset:3584 sc1
    s_waitcnt vmcnt(0)
    v_max3_u32 v2, v192, v193, v194
    v_max3_u32 v2, v2, v195, v196
    v_max3_u32 v2, v2, v197, v198
    v_max3_u32 v2, v2, v199, v200
    v_max3_u32 v2, v2, v201, v202
    v_max3_u32 v2, v2, v203, v204
    v_max3_u32 v2, v2, v205, v206
    v_max_u32 v2, v2, v207
    v_max3_u32 v3, v240, v241, v242
    v_max3_u32 v3, v3, v243, v244
    v_max3_u32 v3, v3, v245, v246
    v_max3_u32 v3, v3, v247, v248
    v_max3_u32 v3, v3, v249, v250
    v_max3_u32 v3, v3, v251, v252
    v_max3_u32 v3, v3, v253, v254
    v_max_u32 v3, v3, v255
    v_max_u32 v2, v2, v3
    v_cmp_eq_u32 vcc, -1, v2
    s_sub_u32 s34, s34, 1
    s_cbranch_scc1 QA_LEND
    s_nop 2
    s_cbranch_vccnz QA_LPOLL
QA_LEND:
    s_branch QA_GO
ROLE_UP:
    s_and_b32 s23, s21, 31
    s_lshl_b32 s23, s23, 7
    s_add_u32 s23, s23, 0x9000
    v_mov_b32 v2, s23
    s_mov_b32 s25, 1
    s_mov_b32 s24, 32768
WF_33:
    buffer_load_dword v3, v2, s[4:7], 0 offen sc1
    s_waitcnt vmcnt(0)
    v_cmp_gt_u32 vcc, s25, v3
    s_sub_u32 s24, s24, 1
    s_cbranch_scc1 WFE_34
    s_nop 2
    s_cbranch_vccz WFE_34
    s_sleep 32
    s_branch WF_33
WFE_34:
    s_load_dwordx2 s[8:9], s[0:1], 64
    s_mov_b32 s10, 0x158000
    s_mov_b32 s11, 0x20000
    s_load_dwordx2 s[12:13], s[0:1], 72
    s_mov_b32 s14, 0x158000
    s_mov_b32 s15, 0x20000
    s_waitcnt lgkmcnt(0)
    s_lshl_b32 s30, s21, 7
    v_lshrrev_b32 v2, 3, v0
    v_bfe_u32 v3, v0, 4, 2
    v_bfe_u32 v4, v0, 1, 2
    v_xor_b32 v4, v4, v3
    v_lshlrev_b32 v4, 5, v4
    v_and_b32 v3, 1, v0
    v_lshl_add_u32 v4, v3, 4, v4
    s_mov_b32 s23, 2752
    v_mul_lo_u32 v2, v2, s23
    v_add_u32 v2, v2, v4
    s_mul_i32 s24, s20, 22016
    s_add_u32 s24, s24, s30
    s_lshl_b32 s25, s20, 10
    s_add_u32 s25, s25, 0
    s_mov_b32 s27, 16
DMA_35:
    s_mov_b32 m0, s25
    s_add_u32 s25, s25, 4096
    buffer_load_dwordx4 v2, s[8:11], s24 offen lds
    s_add_u32 s24, s24, 88064
    s_sub_u32 s27, s27, 1
    s_cmp_lg_u32 s27, 0
    s_cbranch_scc1 DMA_35
    v_lshrrev_b32 v2, 3, v0
    v_bfe_u32 v3, v0, 4, 2
    v_bfe_u32 v4, v0, 1, 2
    v_xor_b32 v4, v4, v3
    v_lshlrev_b32 v4, 5, v4
    v_and_b32 v3, 1, v0
    v_lshl_add_u32 v4, v3, 4, v4
    s_mov_b32 s23, 2752
    v_mul_lo_u32 v2, v2, s23
    v_add_u32 v2, v2, v4
    s_mul_i32 s24, s20, 22016
    s_add_u32 s24, s24, s30
    s_lshl_b32 s25, s20, 10
    s_add_u32 s25, s25, 65536
    s_mov_b32 s27, 16
DMA_36:
    s_mov_b32 m0, s25
    s_add_u32 s25, s25, 4096
    buffer_load_dwordx4 v2, s[12:15], s24 offen lds
    s_add_u32 s24, s24, 88064
    s_sub_u32 s27, s27, 1
    s_cmp_lg_u32 s27, 0
    s_cbranch_scc1 DMA_36
    v_bfe_u32 v2, v0, 2, 2
    v_lshrrev_b32 v3, 4, v0
    v_lshl_add_u32 v4, v3, 2, v2
    v_lshlrev_b32 v5, 7, v4
    v_bfe_u32 v4, v4, 1, 2
    v_and_b32 v6, 3, v0
    v_lshl_add_u32 v5, v6, 3, v5
    v_xor_b32 v7, 0, v4
    v_lshl_add_u32 v16, v7, 5, v5
    v_add_u32 v20, 0x10000, v16
    v_xor_b32 v7, 1, v4
    v_lshl_add_u32 v17, v7, 5, v5
    v_add_u32 v21, 0x10000, v17
    v_xor_b32 v7, 2, v4
    v_lshl_add_u32 v18, v7, 5, v5
    v_add_u32 v22, 0x10000, v18
    v_xor_b32 v7, 3, v4
    v_lshl_add_u32 v19, v7, 5, v5
    v_add_u32 v23, 0x10000, v19
    s_lshl_b32 s24, s20, 2
    s_add_u32 s24, s24, 0x6000
    s_lshl_b32 s23, s21, 7
    s_add_u32 s24, s24, s23
    v_mov_b32 v8, s24
    v_lshlrev_b32 v9, 4, v0
    s_waitcnt vmcnt(0)
    s_barrier
    s_mov_b32 s31, s20
    s_mov_b32 s32, 0
UP_LOOP:
    v_and_b32 v2, 3, v0
    v_lshlrev_b32 v2, 2, v2
    s_lshl_b32 s23, s31, 4
    s_mov_b32 s24, 32768
WLN_37:
    buffer_load_dword v3, v2, s[4:7], s23 offen sc1
    s_waitcnt vmcnt(0)
    v_cmp_eq_u32 vcc, 0, v3
    s_sub_u32 s24, s24, 1
    s_cbranch_scc1 WLNE_38
    s_nop 2
    s_cbranch_vccz WLNE_38
    s_sleep 1
    s_branch WLN_37
WLNE_38:
    s_lshl_b32 s33, s31, 15
    s_add_u32 s33, s33, 0x100000
    buffer_load_dwordx4 a[0:3], v9, s[4:7], s33 offen offset:0
    buffer_load_dwordx4 a[4:7], v9, s[4:7], s33 offen offset:1024
    buffer_load_dwordx4 a[8:11], v9, s[4:7], s33 offen offset:2048
    buffer_load_dwordx4 a[12:15], v9, s[4:7], s33 offen offset:3072
    s_add_u32 s33, s33, 4096
    buffer_load_dwordx4 a[16:19], v9, s[4:7], s33 offen offset:0
    buffer_load_dwordx4 a[20:23], v9, s[4:7], s33 offen offset:1024
    buffer_load_dwordx4 a[24:27], v9, s[4:7], s33 offen offset:2048
    buffer_load_dwordx4 a[28:31], v9, s[4:7], s33 offen offset:3072
    s_add_u32 s33, s33, 4096
    buffer_load_dwordx4 a[32:35], v9, s[4:7], s33 offen offset:0
    buffer_load_dwordx4 a[36:39], v9, s[4:7], s33 offen offset:1024
    buffer_load_dwordx4 a[40:43], v9, s[4:7], s33 offen offset:2048
    buffer_load_dwordx4 a[44:47], v9, s[4:7], s33 offen offset:3072
    s_add_u32 s33, s33, 4096
    buffer_load_dwordx4 a[48:51], v9, s[4:7], s33 offen offset:0
    buffer_load_dwordx4 a[52:55], v9, s[4:7], s33 offen offset:1024
    buffer_load_dwordx4 a[56:59], v9, s[4:7], s33 offen offset:2048
    buffer_load_dwordx4 a[60:63], v9, s[4:7], s33 offen offset:3072
    s_add_u32 s33, s33, 4096
    buffer_load_dwordx4 a[64:67], v9, s[4:7], s33 offen offset:0
    buffer_load_dwordx4 a[68:71], v9, s[4:7], s33 offen offset:1024
    buffer_load_dwordx4 a[72:75], v9, s[4:7], s33 offen offset:2048
    buffer_load_dwordx4 a[76:79], v9, s[4:7], s33 offen offset:3072
    s_add_u32 s33, s33, 4096
    buffer_load_dwordx4 a[80:83], v9, s[4:7], s33 offen offset:0
    buffer_load_dwordx4 a[84:87], v9, s[4:7], s33 offen offset:1024
    buffer_load_dwordx4 a[88:91], v9, s[4:7], s33 offen offset:2048
    buffer_load_dwordx4 a[92:95], v9, s[4:7], s33 offen offset:3072
    s_add_u32 s33, s33, 4096
    buffer_load_dwordx4 a[96:99], v9, s[4:7], s33 offen offset:0
    buffer_load_dwordx4 a[100:103], v9, s[4:7], s33 offen offset:1024
    buffer_load_dwordx4 a[104:107], v9, s[4:7], s33 offen offset:2048
    buffer_load_dwordx4 a[108:111], v9, s[4:7], s33 offen offset:3072
    s_add_u32 s33, s33, 4096
    buffer_load_dwordx4 a[112:115], v9, s[4:7], s33 offen offset:0
    buffer_load_dwordx4 a[116:119], v9, s[4:7], s33 offen offset:1024
    buffer_load_dwordx4 a[120:123], v9, s[4:7], s33 offen offset:2048
    buffer_load_dwordx4 a[124:127], v9, s[4:7], s33 offen offset:3072
    s_waitcnt vmcnt(0)
    ds_read_b64_tr_b16 v[32:33], v16 offset:0
    ds_read_b64_tr_b16 v[34:35], v16 offset:2048
    ds_read_b64_tr_b16 v[36:37], v17 offset:0
    ds_read_b64_tr_b16 v[38:39], v17 offset:2048
    ds_read_b64_tr_b16 v[40:41], v18 offset:0
    ds_read_b64_tr_b16 v[42:43], v18 offset:2048
    s_waitcnt lgkmcnt(4)
    v_mfma_f32_16x16x32_bf16 v[64:67], v[32:35], a[0:3], 0
    v_mfma_f32_16x16x32_bf16 v[96:99], v[32:35], a[64:67], 0
    ds_read_b64_tr_b16 v[44:45], v19 offset:0
    ds_read_b64_tr_b16 v[46:47], v19 offset:2048
    s_waitcnt lgkmcnt(4)
    v_mfma_f32_16x16x32_bf16 v[68:71], v[36:39], a[0:3], 0
    v_mfma_f32_16x16x32_bf16 v[100:103], v[36:39], a[64:67], 0
    ds_read_b64_tr_b16 v[32:33], v20 offset:0
    ds_read_b64_tr_b16 v[34:35], v20 offset:2048
    s_waitcnt lgkmcnt(4)
    v_mfma_f32_16x16x32_bf16 v[72:75], v[40:43], a[0:3], 0
    v_mfma_f32_16x16x32_bf16 v[104:107], v[40:43], a[64:67], 0
    ds_read_b64_tr_b16 v[36:37], v21 offset:0
    ds_read_b64_tr_b16 v[38:39], v21 offset:2048
    s_waitcnt lgkmcnt(4)
    v_mfma_f32_16x16x32_bf16 v[76:79], v[44:47], a[0:3], 0
    v_mfma_f32_16x16x32_bf16 v[108:111], v[44:47], a[64:67], 0
    ds_read_b64_tr_b16 v[40:41], v22 offset:0
    ds_read_b64_tr_b16 v[42:43], v22 offset:2048
    s_waitcnt lgkmcnt(4)
    v_mfma_f32_16x16x32_bf16 v[80:83], v[32:35], a[0:3], 0
    v_mfma_f32_16x16x32_bf16 v[112:115], v[32:35], a[64:67], 0
    ds_read_b64_tr_b16 v[44:45], v23 offset:0
    ds_read_b64_tr_b16 v[46:47], v23 offset:2048
    s_waitcnt lgkmcnt(4)
    v_mfma_f32_16x16x32_bf16 v[84:87], v[36:39], a[0:3], 0
    v_mfma_f32_16x16x32_bf16 v[116:119], v[36:39], a[64:67], 0
    ds_read_b64_tr_b16 v[32:33], v16 offset:4096
    ds_read_b64_tr_b16 v[34:35], v16 offset:6144
    s_waitcnt lgkmcnt(4)
    v_mfma_f32_16x16x32_bf16 v[88:91], v[40:43], a[0:3], 0
    v_mfma_f32_16x16x32_bf16 v[120:123], v[40:43], a[64:67], 0
    ds_read_b64_tr_b16 v[36:37], v17 offset:4096
    ds_read_b64_tr_b16 v[38:39], v17 offset:6144
    s_waitcnt lgkmcnt(4)
    v_mfma_f32_16x16x32_bf16 v[92:95], v[44:47], a[0:3], 0
    v_mfma_f32_16x16x32_bf16 v[124:127], v[44:47], a[64:67], 0
    ds_read_b64_tr_b16 v[40:41], v18 offset:4096
    ds_read_b64_tr_b16 v[42:43], v18 offset:6144
    s_waitcnt lgkmcnt(4)
    v_mfma_f32_16x16x32_bf16 v[64:67], v[32:35], a[4:7], v[64:67]
    v_mfma_f32_16x16x32_bf16 v[96:99], v[32:35], a[68:71], v[96:99]
    ds_read_b64_tr_b16 v[44:45], v19 offset:4096
    ds_read_b64_tr_b16 v[46:47], v19 offset:6144
    s_waitcnt lgkmcnt(4)
    v_mfma_f32_16x16x32_bf16 v[68:71], v[36:39], a[4:7], v[68:71]
    v_mfma_f32_16x16x32_bf16 v[100:103], v[36:39], a[68:71], v[100:103]
    ds_read_b64_tr_b16 v[32:33], v20 offset:4096
    ds_read_b64_tr_b16 v[34:35], v20 offset:6144
    s_waitcnt lgkmcnt(4)
    v_mfma_f32_16x16x32_bf16 v[72:75], v[40:43], a[4:7], v[72:75]
    v_mfma_f32_16x16x32_bf16 v[104:107], v[40:43], a[68:71], v[104:107]
    ds_read_b64_tr_b16 v[36:37], v21 offset:4096
    ds_read_b64_tr_b16 v[38:39], v21 offset:6144
    s_waitcnt lgkmcnt(4)
    v_mfma_f32_16x16x32_bf16 v[76:79], v[44:47], a[4:7], v[76:79]
    v_mfma_f32_16x16x32_bf16 v[108:111], v[44:47], a[68:71], v[108:111]
    ds_read_b64_tr_b16 v[40:41], v22 offset:4096
    ds_read_b64_tr_b16 v[42:43], v22 offset:6144
    s_waitcnt lgkmcnt(4)
    v_mfma_f32_16x16x32_bf16 v[80:83], v[32:35], a[4:7], v[80:83]
    v_mfma_f32_16x16x32_bf16 v[112:115], v[32:35], a[68:71], v[112:115]
    ds_read_b64_tr_b16 v[44:45], v23 offset:4096
    ds_read_b64_tr_b16 v[46:47], v23 offset:6144
    s_waitcnt lgkmcnt(4)
    v_mfma_f32_16x16x32_bf16 v[84:87], v[36:39], a[4:7], v[84:87]
    v_mfma_f32_16x16x32_bf16 v[116:119], v[36:39], a[68:71], v[116:119]
    ds_read_b64_tr_b16 v[32:33], v16 offset:8192
    ds_read_b64_tr_b16 v[34:35], v16 offset:10240
    s_waitcnt lgkmcnt(4)
    v_mfma_f32_16x16x32_bf16 v[88:91], v[40:43], a[4:7], v[88:91]
    v_mfma_f32_16x16x32_bf16 v[120:123], v[40:43], a[68:71], v[120:123]
    ds_read_b64_tr_b16 v[36:37], v17 offset:8192
    ds_read_b64_tr_b16 v[38:39], v17 offset:10240
    s_waitcnt lgkmcnt(4)
    v_mfma_f32_16x16x32_bf16 v[92:95], v[44:47], a[4:7], v[92:95]
    v_mfma_f32_16x16x32_bf16 v[124:127], v[44:47], a[68:71], v[124:127]
    ds_read_b64_tr_b16 v[40:41], v18 offset:8192
    ds_read_b64_tr_b16 v[42:43], v18 offset:10240
    s_waitcnt lgkmcnt(4)
    v_mfma_f32_16x16x32_bf16 v[64:67], v[32:35], a[8:11], v[64:67]
    v_mfma_f32_16x16x32_bf16 v[96:99], v[32:35], a[72:75], v[96:99]
    ds_read_b64_tr_b16 v[44:45], v19 offset:8192
    ds_read_b64_tr_b16 v[46:47], v19 offset:10240
    s_waitcnt lgkmcnt(4)
    v_mfma_f32_16x16x32_bf16 v[68:71], v[36:39], a[8:11], v[68:71]
    v_mfma_f32_16x16x32_bf16 v[100:103], v[36:39], a[72:75], v[100:103]
    ds_read_b64_tr_b16 v[32:33], v20 offset:8192
    ds_read_b64_tr_b16 v[34:35], v20 offset:10240
    s_waitcnt lgkmcnt(4)
    v_mfma_f32_16x16x32_bf16 v[72:75], v[40:43], a[8:11], v[72:75]
    v_mfma_f32_16x16x32_bf16 v[104:107], v[40:43], a[72:75], v[104:107]
    ds_read_b64_tr_b16 v[36:37], v21 offset:8192
    ds_read_b64_tr_b16 v[38:39], v21 offset:10240
    s_waitcnt lgkmcnt(4)
    v_mfma_f32_16x16x32_bf16 v[76:79], v[44:47], a[8:11], v[76:79]
    v_mfma_f32_16x16x32_bf16 v[108:111], v[44:47], a[72:75], v[108:111]
    ds_read_b64_tr_b16 v[40:41], v22 offset:8192
    ds_read_b64_tr_b16 v[42:43], v22 offset:10240
    s_waitcnt lgkmcnt(4)
    v_mfma_f32_16x16x32_bf16 v[80:83], v[32:35], a[8:11], v[80:83]
    v_mfma_f32_16x16x32_bf16 v[112:115], v[32:35], a[72:75], v[112:115]
    ds_read_b64_tr_b16 v[44:45], v23 offset:8192
    ds_read_b64_tr_b16 v[46:47], v23 offset:10240
    s_waitcnt lgkmcnt(4)
    v_mfma_f32_16x16x32_bf16 v[84:87], v[36:39], a[8:11], v[84:87]
    v_mfma_f32_16x16x32_bf16 v[116:119], v[36:39], a[72:75], v[116:119]
    ds_read_b64_tr_b16 v[32:33], v16 offset:12288
    ds_read_b64_tr_b16 v[34:35], v16 offset:14336
    s_waitcnt lgkmcnt(4)
    v_mfma_f32_16x16x32_bf16 v[88:91], v[40:43], a[8:11], v[88:91]
    v_mfma_f32_16x16x32_bf16 v[120:123], v[40:43], a[72:75], v[120:123]
    ds_read_b64_tr_b16 v[36:37], v17 offset:12288
    ds_read_b64_tr_b16 v[38:39], v17 offset:14336
    s_waitcnt lgkmcnt(4)
    v_mfma_f32_16x16x32_bf16 v[92:95], v[44:47], a[8:11], v[92:95]
    v_mfma_f32_16x16x32_bf16 v[124:127], v[44:47], a[72:75], v[124:127]
    ds_read_b64_tr_b16 v[40:41], v18 offset:12288
    ds_read_b64_tr_b16 v[42:43], v18 offset:14336
    s_waitcnt lgkmcnt(4)
    v_mfma_f32_16x16x32_bf16 v[64:67], v[32:35], a[12:15], v[64:67]
    v_mfma_f32_16x16x32_bf16 v[96:99], v[32:35], a[76:79], v[96:99]
    ds_read_b64_tr_b16 v[44:45], v19 offset:12288
    ds_read_b64_tr_b16 v[46:47], v19 offset:14336
    s_waitcnt lgkmcnt(4)
    v_mfma_f32_16x16x32_bf16 v[68:71], v[36:39], a[12:15], v[68:71]
    v_mfma_f32_16x16x32_bf16 v[100:103], v[36:39], a[76:79], v[100:103]
    ds_read_b64_tr_b16 v[32:33], v20 offset:12288
    ds_read_b64_tr_b16 v[34:35], v20 offset:14336
    s_waitcnt lgkmcnt(4)
    v_mfma_f32_16x16x32_bf16 v[72:75], v[40:43], a[12:15], v[72:75]
    v_mfma_f32_16x16x32_bf16 v[104:107], v[40:43], a[76:79], v[104:107]
    ds_read_b64_tr_b16 v[36:37], v21 offset:12288
    ds_read_b64_tr_b16 v[38:39], v21 offset:14336
    s_waitcnt lgkmcnt(4)
    v_mfma_f32_16x16x32_bf16 v[76:79], v[44:47], a[12:15], v[76:79]
    v_mfma_f32_16x16x32_bf16 v[108:111], v[44:47], a[76:79], v[108:111]
    ds_read_b64_tr_b16 v[40:41], v22 offset:12288
    ds_read_b64_tr_b16 v[42:43], v22 offset:14336
    s_waitcnt lgkmcnt(4)
    v_mfma_f32_16x16x32_bf16 v[80:83], v[32:35], a[12:15], v[80:83]
    v_mfma_f32_16x16x32_bf16 v[112:115], v[32:35], a[76:79], v[112:115]
    ds_read_b64_tr_b16 v[44:45], v23 offset:12288
    ds_read_b64_tr_b16 v[46:47], v23 offset:14336
    s_waitcnt lgkmcnt(4)
    v_mfma_f32_16x16x32_bf16 v[84:87], v[36:39], a[12:15], v[84:87]
    v_mfma_f32_16x16x32_bf16 v[116:119], v[36:39], a[76:79], v[116:119]
    ds_read_b64_tr_b16 v[32:33], v16 offset:16384
    ds_read_b64_tr_b16 v[34:35], v16 offset:18432
    s_waitcnt lgkmcnt(4)
    v_mfma_f32_16x16x32_bf16 v[88:91], v[40:43], a[12:15], v[88:91]
    v_mfma_f32_16x16x32_bf16 v[120:123], v[40:43], a[76:79], v[120:123]
    ds_read_b64_tr_b16 v[36:37], v17 offset:16384
    ds_read_b64_tr_b16 v[38:39], v17 offset:18432
    s_waitcnt lgkmcnt(4)
    v_mfma_f32_16x16x32_bf16 v[92:95], v[44:47], a[12:15], v[92:95]
    v_mfma_f32_16x16x32_bf16 v[124:127], v[44:47], a[76:79], v[124:127]
    ds_read_b64_tr_b16 v[40:41], v18 offset:16384
    ds_read_b64_tr_b16 v[42:43], v18 offset:18432
    s_waitcnt lgkmcnt(4)
    v_mfma_f32_16x16x32_bf16 v[64:67], v[32:35], a[16:19], v[64:67]
    v_mfma_f32_16x16x32_bf16 v[96:99], v[32:35], a[80:83], v[96:99]
    ds_read_b64_tr_b16 v[44:45], v19 offset:16384
    ds_read_b64_tr_b16 v[46:47], v19 offset:18432
    s_waitcnt lgkmcnt(4)
    v_mfma_f32_16x16x32_bf16 v[68:71], v[36:39], a[16:19], v[68:71]
    v_mfma_f32_16x16x32_bf16 v[100:103], v[36:39], a[80:83], v[100:103]
    ds_read_b64_tr_b16 v[32:33], v20 offset:16384
    ds_read_b64_tr_b16 v[34:35], v20 offset:18432
    s_waitcnt lgkmcnt(4)
    v_mfma_f32_16x16x32_bf16 v[72:75], v[40:43], a[16:19], v[72:75]
    v_mfma_f32_16x16x32_bf16 v[104:107], v[40:43], a[80:83], v[104:107]
    ds_read_b64_tr_b16 v[36:37], v21 offset:16384
    ds_read_b64_tr_b16 v[38:39], v21 offset:18432
    s_waitcnt lgkmcnt(4)
    v_mfma_f32_16x16x32_bf16 v[76:79], v[44:47], a[16:19], v[76:79]
    v_mfma_f32_16x16x32_bf16 v[108:111], v[44:47], a[80:83], v[108:111]
    ds_read_b64_tr_b16 v[40:41], v22 offset:16384
    ds_read_b64_tr_b16 v[42:43], v22 offset:18432
    s_waitcnt lgkmcnt(4)
    v_mfma_f32_16x16x32_bf16 v[80:83], v[32:35], a[16:19], v[80:83]
    v_mfma_f32_16x16x32_bf16 v[112:115], v[32:35], a[80:83], v[112:115]
    ds_read_b64_tr_b16 v[44:45], v23 offset:16384
    ds_read_b64_tr_b16 v[46:47], v23 offset:18432
    s_waitcnt lgkmcnt(4)
    v_mfma_f32_16x16x32_bf16 v[84:87], v[36:39], a[16:19], v[84:87]
    v_mfma_f32_16x16x32_bf16 v[116:119], v[36:39], a[80:83], v[116:119]
    ds_read_b64_tr_b16 v[32:33], v16 offset:20480
    ds_read_b64_tr_b16 v[34:35], v16 offset:22528
    s_waitcnt lgkmcnt(4)
    v_mfma_f32_16x16x32_bf16 v[88:91], v[40:43], a[16:19], v[88:91]
    v_mfma_f32_16x16x32_bf16 v[120:123], v[40:43], a[80:83], v[120:123]
    ds_read_b64_tr_b16 v[36:37], v17 offset:20480
    ds_read_b64_tr_b16 v[38:39], v17 offset:22528
    s_waitcnt lgkmcnt(4)
    v_mfma_f32_16x16x32_bf16 v[92:95], v[44:47], a[16:19], v[92:95]
    v_mfma_f32_16x16x32_bf16 v[124:127], v[44:47], a[80:83], v[124:127]
    ds_read_b64_tr_b16 v[40:41], v18 offset:20480
    ds_read_b64_tr_b16 v[42:43], v18 offset:22528
    s_waitcnt lgkmcnt(4)
    v_mfma_f32_16x16x32_bf16 v[64:67], v[32:35], a[20:23], v[64:67]
    v_mfma_f32_16x16x32_bf16 v[96:99], v[32:35], a[84:87], v[96:99]
    ds_read_b64_tr_b16 v[44:45], v19 offset:20480
    ds_read_b64_tr_b16 v[46:47], v19 offset:22528
    s_waitcnt lgkmcnt(4)
    v_mfma_f32_16x16x32_bf16 v[68:71], v[36:39], a[20:23], v[68:71]
    v_mfma_f32_16x16x32_bf16 v[100:103], v[36:39], a[84:87], v[100:103]
    ds_read_b64_tr_b16 v[32:33], v20 offset:20480
    ds_read_b64_tr_b16 v[34:35], v20 offset:22528
    s_waitcnt lgkmcnt(4)
    v_mfma_f32_16x16x32_bf16 v[72:75], v[40:43], a[20:23], v[72:75]
    v_mfma_f32_16x16x32_bf16 v[104:107], v[40:43], a[84:87], v[104:107]
    ds_read_b64_tr_b16 v[36:37], v21 offset:20480
    ds_read_b64_tr_b16 v[38:39], v21 offset:22528
    s_waitcnt lgkmcnt(4)
    v_mfma_f32_16x16x32_bf16 v[76:79], v[44:47], a[20:23], v[76:79]
    v_mfma_f32_16x16x32_bf16 v[108:111], v[44:47], a[84:87], v[108:111]
    ds_read_b64_tr_b16 v[40:41], v22 offset:20480
    ds_read_b64_tr_b16 v[42:43], v22 offset:22528
    s_waitcnt lgkmcnt(4)
    v_mfma_f32_16x16x32_bf16 v[80:83], v[32:35], a[20:23], v[80:83]
    v_mfma_f32_16x16x32_bf16 v[112:115], v[32:35], a[84:87], v[112:115]
    ds_read_b64_tr_b16 v[44:45], v23 offset:20480
    ds_read_b64_tr_b16 v[46:47], v23 offset:22528
    s_waitcnt lgkmcnt(4)
    v_mfma_f32_16x16x32_bf16 v[84:87], v[36:39], a[20:23], v[84:87]
    v_mfma_f32_16x16x32_bf16 v[116:119], v[36:39], a[84:87], v[116:119]
    ds_read_b64_tr_b16 v[32:33], v16 offset:24576
    ds_read_b64_tr_b16 v[34:35], v16 offset:26624
    s_waitcnt lgkmcnt(4)
    v_mfma_f32_16x16x32_bf16 v[88:91], v[40:43], a[20:23], v[88:91]
    v_mfma_f32_16x16x32_bf16 v[120:123], v[40:43], a[84:87], v[120:123]
    ds_read_b64_tr_b16 v[36:37], v17 offset:24576
    ds_read_b64_tr_b16 v[38:39], v17 offset:26624
    s_waitcnt lgkmcnt(4)
    v_mfma_f32_16x16x32_bf16 v[92:95], v[44:47], a[20:23], v[92:95]
    v_mfma_f32_16x16x32_bf16 v[124:127], v[44:47], a[84:87], v[124:127]
    ds_read_b64_tr_b16 v[40:41], v18 offset:24576
    ds_read_b64_tr_b16 v[42:43], v18 offset:26624
    s_waitcnt lgkmcnt(4)
    v_mfma_f32_16x16x32_bf16 v[64:67], v[32:35], a[24:27], v[64:67]
    v_mfma_f32_16x16x32_bf16 v[96:99], v[32:35], a[88:91], v[96:99]
    ds_read_b64_tr_b16 v[44:45], v19 offset:24576
    ds_read_b64_tr_b16 v[46:47], v19 offset:26624
    s_waitcnt lgkmcnt(4)
    v_mfma_f32_16x16x32_bf16 v[68:71], v[36:39], a[24:27], v[68:71]
    v_mfma_f32_16x16x32_bf16 v[100:103], v[36:39], a[88:91], v[100:103]
    ds_read_b64_tr_b16 v[32:33], v20 offset:24576
    ds_read_b64_tr_b16 v[34:35], v20 offset:26624
    s_waitcnt lgkmcnt(4)
    v_mfma_f32_16x16x32_bf16 v[72:75], v[40:43], a[24:27], v[72:75]
    v_mfma_f32_16x16x32_bf16 v[104:107], v[40:43], a[88:91], v[104:107]
    ds_read_b64_tr_b16 v[36:37], v21 offset:24576
    ds_read_b64_tr_b16 v[38:39], v21 offset:26624
    s_waitcnt lgkmcnt(4)
    v_mfma_f32_16x16x32_bf16 v[76:79], v[44:47], a[24:27], v[76:79]
    v_mfma_f32_16x16x32_bf16 v[108:111], v[44:47], a[88:91], v[108:111]
    ds_read_b64_tr_b16 v[40:41], v22 offset:24576
    ds_read_b64_tr_b16 v[42:43], v22 offset:26624
    s_waitcnt lgkmcnt(4)
    v_mfma_f32_16x16x32_bf16 v[80:83], v[32:35], a[24:27], v[80:83]
    v_mfma_f32_16x16x32_bf16 v[112:115], v[32:35], a[88:91], v[112:115]
    ds_read_b64_tr_b16 v[44:45], v23 offset:24576
    ds_read_b64_tr_b16 v[46:47], v23 offset:26624
    s_waitcnt lgkmcnt(4)
    v_mfma_f32_16x16x32_bf16 v[84:87], v[36:39], a[24:27], v[84:87]
    v_mfma_f32_16x16x32_bf16 v[116:119], v[36:39], a[88:91], v[116:119]
    ds_read_b64_tr_b16 v[32:33], v16 offset:28672
    ds_read_b64_tr_b16 v[34:35], v16 offset:30720
    s_waitcnt lgkmcnt(4)
    v_mfma_f32_16x16x32_bf16 v[88:91], v[40:43], a[24:27], v[88:91]
    v_mfma_f32_16x16x32_bf16 v[120:123], v[40:43], a[88:91], v[120:123]
    ds_read_b64_tr_b16 v[36:37], v17 offset:28672
    ds_read_b64_tr_b16 v[38:39], v17 offset:30720
    s_waitcnt lgkmcnt(4)
    v_mfma_f32_16x16x32_bf16 v[92:95], v[44:47], a[24:27], v[92:95]
    v_mfma_f32_16x16x32_bf16 v[124:127], v[44:47], a[88:91], v[124:127]
    ds_read_b64_tr_b16 v[40:41], v18 offset:28672
    ds_read_b64_tr_b16 v[42:43], v18 offset:30720
    s_waitcnt lgkmcnt(4)
    v_mfma_f32_16x16x32_bf16 v[64:67], v[32:35], a[28:31], v[64:67]
    v_mfma_f32_16x16x32_bf16 v[96:99], v[32:35], a[92:95], v[96:99]
    ds_read_b64_tr_b16 v[44:45], v19 offset:28672
    ds_read_b64_tr_b16 v[46:47], v19 offset:30720
    s_waitcnt lgkmcnt(4)
    v_mfma_f32_16x16x32_bf16 v[68:71], v[36:39], a[28:31], v[68:71]
    v_mfma_f32_16x16x32_bf16 v[100:103], v[36:39], a[92:95], v[100:103]
    ds_read_b64_tr_b16 v[32:33], v20 offset:28672
    ds_read_b64_tr_b16 v[34:35], v20 offset:30720
    s_waitcnt lgkmcnt(4)
    v_mfma_f32_16x16x32_bf16 v[72:75], v[40:43], a[28:31], v[72:75]
    v_mfma_f32_16x16x32_bf16 v[104:107], v[40:43], a[92:95], v[104:107]
    ds_read_b64_tr_b16 v[36:37], v21 offset:28672
    ds_read_b64_tr_b16 v[38:39], v21 offset:30720
    s_waitcnt lgkmcnt(4)
    v_mfma_f32_16x16x32_bf16 v[76:79], v[44:47], a[28:31], v[76:79]
    v_mfma_f32_16x16x32_bf16 v[108:111], v[44:47], a[92:95], v[108:111]
    ds_read_b64_tr_b16 v[40:41], v22 offset:28672
    ds_read_b64_tr_b16 v[42:43], v22 offset:30720
    s_waitcnt lgkmcnt(4)
    v_mfma_f32_16x16x32_bf16 v[80:83], v[32:35], a[28:31], v[80:83]
    v_mfma_f32_16x16x32_bf16 v[112:115], v[32:35], a[92:95], v[112:115]
    ds_read_b64_tr_b16 v[44:45], v23 offset:28672
    ds_read_b64_tr_b16 v[46:47], v23 offset:30720
    s_waitcnt lgkmcnt(4)
    v_mfma_f32_16x16x32_bf16 v[84:87], v[36:39], a[28:31], v[84:87]
    v_mfma_f32_16x16x32_bf16 v[116:119], v[36:39], a[92:95], v[116:119]
    ds_read_b64_tr_b16 v[32:33], v16 offset:32768
    ds_read_b64_tr_b16 v[34:35], v16 offset:34816
    s_waitcnt lgkmcnt(4)
    v_mfma_f32_16x16x32_bf16 v[88:91], v[40:43], a[28:31], v[88:91]
    v_mfma_f32_16x16x32_bf16 v[120:123], v[40:43], a[92:95], v[120:123]
    ds_read_b64_tr_b16 v[36:37], v17 offset:32768
    ds_read_b64_tr_b16 v[38:39], v17 offset:34816
    s_waitcnt lgkmcnt(4)
    v_mfma_f32_16x16x32_bf16 v[92:95], v[44:47], a[28:31], v[92:95]
    v_mfma_f32_16x16x32_bf16 v[124:127], v[44:47], a[92:95], v[124:127]
    ds_read_b64_tr_b16 v[40:41], v18 offset:32768
    ds_read_b64_tr_b16 v[42:43], v18 offset:34816
    s_waitcnt lgkmcnt(4)
    v_mfma_f32_16x16x32_bf16 v[64:67], v[32:35], a[32:35], v[64:67]
    v_mfma_f32_16x16x32_bf16 v[96:99], v[32:35], a[96:99], v[96:99]
    ds_read_b64_tr_b16 v[44:45], v19 offset:32768
    ds_read_b64_tr_b16 v[46:47], v19 offset:34816
    s_waitcnt lgkmcnt(4)
    v_mfma_f32_16x16x32_bf16 v[68:71], v[36:39], a[32:35], v[68:71]
    v_mfma_f32_16x16x32_bf16 v[100:103], v[36:39], a[96:99], v[100:103]
    ds_read_b64_tr_b16 v[32:33], v20 offset:32768
    ds_read_b64_tr_b16 v[34:35], v20 offset:34816
    s_waitcnt lgkmcnt(4)
    v_mfma_f32_16x16x32_bf16 v[72:75], v[40:43], a[32:35], v[72:75]
    v_mfma_f32_16x16x32_bf16 v[104:107], v[40:43], a[96:99], v[104:107]
    ds_read_b64_tr_b16 v[36:37], v21 offset:32768
    ds_read_b64_tr_b16 v[38:39], v21 offset:34816
    s_waitcnt lgkmcnt(4)
    v_mfma_f32_16x16x32_bf16 v[76:79], v[44:47], a[32:35], v[76:79]
    v_mfma_f32_16x16x32_bf16 v[108:111], v[44:47], a[96:99], v[108:111]
    ds_read_b64_tr_b16 v[40:41], v22 offset:32768
    ds_read_b64_tr_b16 v[42:43], v22 offset:34816
    s_waitcnt lgkmcnt(4)
    v_mfma_f32_16x16x32_bf16 v[80:83], v[32:35], a[32:35], v[80:83]
    v_mfma_f32_16x16x32_bf16 v[112:115], v[32:35], a[96:99], v[112:115]
    ds_read_b64_tr_b16 v[44:45], v23 offset:32768
    ds_read_b64_tr_b16 v[46:47], v23 offset:34816
    s_waitcnt lgkmcnt(4)
    v_mfma_f32_16x16x32_bf16 v[84:87], v[36:39], a[32:35], v[84:87]
    v_mfma_f32_16x16x32_bf16 v[116:119], v[36:39], a[96:99], v[116:119]
    ds_read_b64_tr_b16 v[32:33], v16 offset:36864
    ds_read_b64_tr_b16 v[34:35], v16 offset:38912
    s_waitcnt lgkmcnt(4)
    v_mfma_f32_16x16x32_bf16 v[88:91], v[40:43], a[32:35], v[88:91]
    v_mfma_f32_16x16x32_bf16 v[120:123], v[40:43], a[96:99], v[120:123]
    ds_read_b64_tr_b16 v[36:37], v17 offset:36864
    ds_read_b64_tr_b16 v[38:39], v17 offset:38912
    s_waitcnt lgkmcnt(4)
    v_mfma_f32_16x16x32_bf16 v[92:95], v[44:47], a[32:35], v[92:95]
    v_mfma_f32_16x16x32_bf16 v[124:127], v[44:47], a[96:99], v[124:127]
    ds_read_b64_tr_b16 v[40:41], v18 offset:36864
    ds_read_b64_tr_b16 v[42:43], v18 offset:38912
    s_waitcnt lgkmcnt(4)
    v_mfma_f32_16x16x32_bf16 v[64:67], v[32:35], a[36:39], v[64:67]
    v_mfma_f32_16x16x32_bf16 v[96:99], v[32:35], a[100:103], v[96:99]
    ds_read_b64_tr_b16 v[44:45], v19 offset:36864
    ds_read_b64_tr_b16 v[46:47], v19 offset:38912
    s_waitcnt lgkmcnt(4)
    v_mfma_f32_16x16x32_bf16 v[68:71], v[36:39], a[36:39], v[68:71]
    v_mfma_f32_16x16x32_bf16 v[100:103], v[36:39], a[100:103], v[100:103]
    ds_read_b64_tr_b16 v[32:33], v20 offset:36864
    ds_read_b64_tr_b16 v[34:35], v20 offset:38912
    s_waitcnt lgkmcnt(4)
    v_mfma_f32_16x16x32_bf16 v[72:75], v[40:43], a[36:39], v[72:75]
    v_mfma_f32_16x16x32_bf16 v[104:107], v[40:43], a[100:103], v[104:107]
    ds_read_b64_tr_b16 v[36:37], v21 offset:36864
    ds_read_b64_tr_b16 v[38:39], v21 offset:38912
    s_waitcnt lgkmcnt(4)
    v_mfma_f32_16x16x32_bf16 v[76:79], v[44:47], a[36:39], v[76:79]
    v_mfma_f32_16x16x32_bf16 v[108:111], v[44:47], a[100:103], v[108:111]
    ds_read_b64_tr_b16 v[40:41], v22 offset:36864
    ds_read_b64_tr_b16 v[42:43], v22 offset:38912
    s_waitcnt lgkmcnt(4)
    v_mfma_f32_16x16x32_bf16 v[80:83], v[32:35], a[36:39], v[80:83]
    v_mfma_f32_16x16x32_bf16 v[112:115], v[32:35], a[100:103], v[112:115]
    ds_read_b64_tr_b16 v[44:45], v23 offset:36864
    ds_read_b64_tr_b16 v[46:47], v23 offset:38912
    s_waitcnt lgkmcnt(4)
    v_mfma_f32_16x16x32_bf16 v[84:87], v[36:39], a[36:39], v[84:87]
    v_mfma_f32_16x16x32_bf16 v[116:119], v[36:39], a[100:103], v[116:119]
    ds_read_b64_tr_b16 v[32:33], v16 offset:40960
    ds_read_b64_tr_b16 v[34:35], v16 offset:43008
    s_waitcnt lgkmcnt(4)
    v_mfma_f32_16x16x32_bf16 v[88:91], v[40:43], a[36:39], v[88:91]
    v_mfma_f32_16x16x32_bf16 v[120:123], v[40:43], a[100:103], v[120:123]
    ds_read_b64_tr_b16 v[36:37], v17 offset:40960
    ds_read_b64_tr_b16 v[38:39], v17 offset:43008
    s_waitcnt lgkmcnt(4)
    v_mfma_f32_16x16x32_bf16 v[92:95], v[44:47], a[36:39], v[92:95]
    v_mfma_f32_16x16x32_bf16 v[124:127], v[44:47], a[100:103], v[124:127]
    ds_read_b64_tr_b16 v[40:41], v18 offset:40960
    ds_read_b64_tr_b16 v[42:43], v18 offset:43008
    s_waitcnt lgkmcnt(4)
    v_mfma_f32_16x16x32_bf16 v[64:67], v[32:35], a[40:43], v[64:67]
    v_mfma_f32_16x16x32_bf16 v[96:99], v[32:35], a[104:107], v[96:99]
    ds_read_b64_tr_b16 v[44:45], v19 offset:40960
    ds_read_b64_tr_b16 v[46:47], v19 offset:43008
    s_waitcnt lgkmcnt(4)
    v_mfma_f32_16x16x32_bf16 v[68:71], v[36:39], a[40:43], v[68:71]
    v_mfma_f32_16x16x32_bf16 v[100:103], v[36:39], a[104:107], v[100:103]
    ds_read_b64_tr_b16 v[32:33], v20 offset:40960
    ds_read_b64_tr_b16 v[34:35], v20 offset:43008
    s_waitcnt lgkmcnt(4)
    v_mfma_f32_16x16x32_bf16 v[72:75], v[40:43], a[40:43], v[72:75]
    v_mfma_f32_16x16x32_bf16 v[104:107], v[40:43], a[104:107], v[104:107]
    ds_read_b64_tr_b16 v[36:37], v21 offset:40960
    ds_read_b64_tr_b16 v[38:39], v21 offset:43008
    s_waitcnt lgkmcnt(4)
    v_mfma_f32_16x16x32_bf16 v[76:79], v[44:47], a[40:43], v[76:79]
    v_mfma_f32_16x16x32_bf16 v[108:111], v[44:47], a[104:107], v[108:111]
    ds_read_b64_tr_b16 v[40:41], v22 offset:40960
    ds_read_b64_tr_b16 v[42:43], v22 offset:43008
    s_waitcnt lgkmcnt(4)
    v_mfma_f32_16x16x32_bf16 v[80:83], v[32:35], a[40:43], v[80:83]
    v_mfma_f32_16x16x32_bf16 v[112:115], v[32:35], a[104:107], v[112:115]
    ds_read_b64_tr_b16 v[44:45], v23 offset:40960
    ds_read_b64_tr_b16 v[46:47], v23 offset:43008
    s_waitcnt lgkmcnt(4)
    v_mfma_f32_16x16x32_bf16 v[84:87], v[36:39], a[40:43], v[84:87]
    v_mfma_f32_16x16x32_bf16 v[116:119], v[36:39], a[104:107], v[116:119]
    ds_read_b64_tr_b16 v[32:33], v16 offset:45056
    ds_read_b64_tr_b16 v[34:35], v16 offset:47104
    s_waitcnt lgkmcnt(4)
    v_mfma_f32_16x16x32_bf16 v[88:91], v[40:43], a[40:43], v[88:91]
    v_mfma_f32_16x16x32_bf16 v[120:123], v[40:43], a[104:107], v[120:123]
    ds_read_b64_tr_b16 v[36:37], v17 offset:45056
    ds_read_b64_tr_b16 v[38:39], v17 offset:47104
    s_waitcnt lgkmcnt(4)
    v_mfma_f32_16x16x32_bf16 v[92:95], v[44:47], a[40:43], v[92:95]
    v_mfma_f32_16x16x32_bf16 v[124:127], v[44:47], a[104:107], v[124:127]
    ds_read_b64_tr_b16 v[40:41], v18 offset:45056
    ds_read_b64_tr_b16 v[42:43], v18 offset:47104
    s_waitcnt lgkmcnt(4)
    v_mfma_f32_16x16x32_bf16 v[64:67], v[32:35], a[44:47], v[64:67]
    v_mfma_f32_16x16x32_bf16 v[96:99], v[32:35], a[108:111], v[96:99]
    ds_read_b64_tr_b16 v[44:45], v19 offset:45056
    ds_read_b64_tr_b16 v[46:47], v19 offset:47104
    s_waitcnt lgkmcnt(4)
    v_mfma_f32_16x16x32_bf16 v[68:71], v[36:39], a[44:47], v[68:71]
    v_mfma_f32_16x16x32_bf16 v[100:103], v[36:39], a[108:111], v[100:103]
    ds_read_b64_tr_b16 v[32:33], v20 offset:45056
    ds_read_b64_tr_b16 v[34:35], v20 offset:47104
    s_waitcnt lgkmcnt(4)
    v_mfma_f32_16x16x32_bf16 v[72:75], v[40:43], a[44:47], v[72:75]
    v_mfma_f32_16x16x32_bf16 v[104:107], v[40:43], a[108:111], v[104:107]
    ds_read_b64_tr_b16 v[36:37], v21 offset:45056
    ds_read_b64_tr_b16 v[38:39], v21 offset:47104
    s_waitcnt lgkmcnt(4)
    v_mfma_f32_16x16x32_bf16 v[76:79], v[44:47], a[44:47], v[76:79]
    v_mfma_f32_16x16x32_bf16 v[108:111], v[44:47], a[108:111], v[108:111]
    ds_read_b64_tr_b16 v[40:41], v22 offset:45056
    ds_read_b64_tr_b16 v[42:43], v22 offset:47104
    s_waitcnt lgkmcnt(4)
    v_mfma_f32_16x16x32_bf16 v[80:83], v[32:35], a[44:47], v[80:83]
    v_mfma_f32_16x16x32_bf16 v[112:115], v[32:35], a[108:111], v[112:115]
    ds_read_b64_tr_b16 v[44:45], v23 offset:45056
    ds_read_b64_tr_b16 v[46:47], v23 offset:47104
    s_waitcnt lgkmcnt(4)
    v_mfma_f32_16x16x32_bf16 v[84:87], v[36:39], a[44:47], v[84:87]
    v_mfma_f32_16x16x32_bf16 v[116:119], v[36:39], a[108:111], v[116:119]
    ds_read_b64_tr_b16 v[32:33], v16 offset:49152
    ds_read_b64_tr_b16 v[34:35], v16 offset:51200
    s_waitcnt lgkmcnt(4)
    v_mfma_f32_16x16x32_bf16 v[88:91], v[40:43], a[44:47], v[88:91]
    v_mfma_f32_16x16x32_bf16 v[120:123], v[40:43], a[108:111], v[120:123]
    ds_read_b64_tr_b16 v[36:37], v17 offset:49152
    ds_read_b64_tr_b16 v[38:39], v17 offset:51200
    s_waitcnt lgkmcnt(4)
    v_mfma_f32_16x16x32_bf16 v[92:95], v[44:47], a[44:47], v[92:95]
    v_mfma_f32_16x16x32_bf16 v[124:127], v[44:47], a[108:111], v[124:127]
    ds_read_b64_tr_b16 v[40:41], v18 offset:49152
    ds_read_b64_tr_b16 v[42:43], v18 offset:51200
    s_waitcnt lgkmcnt(4)
    v_mfma_f32_16x16x32_bf16 v[64:67], v[32:35], a[48:51], v[64:67]
    v_mfma_f32_16x16x32_bf16 v[96:99], v[32:35], a[112:115], v[96:99]
    ds_read_b64_tr_b16 v[44:45], v19 offset:49152
    ds_read_b64_tr_b16 v[46:47], v19 offset:51200
    s_waitcnt lgkmcnt(4)
    v_mfma_f32_16x16x32_bf16 v[68:71], v[36:39], a[48:51], v[68:71]
    v_mfma_f32_16x16x32_bf16 v[100:103], v[36:39], a[112:115], v[100:103]
    ds_read_b64_tr_b16 v[32:33], v20 offset:49152
    ds_read_b64_tr_b16 v[34:35], v20 offset:51200
    s_waitcnt lgkmcnt(4)
    v_mfma_f32_16x16x32_bf16 v[72:75], v[40:43], a[48:51], v[72:75]
    v_mfma_f32_16x16x32_bf16 v[104:107], v[40:43], a[112:115], v[104:107]
    ds_read_b64_tr_b16 v[36:37], v21 offset:49152
    ds_read_b64_tr_b16 v[38:39], v21 offset:51200
    s_waitcnt lgkmcnt(4)
    v_mfma_f32_16x16x32_bf16 v[76:79], v[44:47], a[48:51], v[76:79]
    v_mfma_f32_16x16x32_bf16 v[108:111], v[44:47], a[112:115], v[108:111]
    ds_read_b64_tr_b16 v[40:41], v22 offset:49152
    ds_read_b64_tr_b16 v[42:43], v22 offset:51200
    s_waitcnt lgkmcnt(4)
    v_mfma_f32_16x16x32_bf16 v[80:83], v[32:35], a[48:51], v[80:83]
    v_mfma_f32_16x16x32_bf16 v[112:115], v[32:35], a[112:115], v[112:115]
    ds_read_b64_tr_b16 v[44:45], v23 offset:49152
    ds_read_b64_tr_b16 v[46:47], v23 offset:51200
    s_waitcnt lgkmcnt(4)
    v_mfma_f32_16x16x32_bf16 v[84:87], v[36:39], a[48:51], v[84:87]
    v_mfma_f32_16x16x32_bf16 v[116:119], v[36:39], a[112:115], v[116:119]
    ds_read_b64_tr_b16 v[32:33], v16 offset:53248
    ds_read_b64_tr_b16 v[34:35], v16 offset:55296
    s_waitcnt lgkmcnt(4)
    v_mfma_f32_16x16x32_bf16 v[88:91], v[40:43], a[48:51], v[88:91]
    v_mfma_f32_16x16x32_bf16 v[120:123], v[40:43], a[112:115], v[120:123]
    ds_read_b64_tr_b16 v[36:37], v17 offset:53248
    ds_read_b64_tr_b16 v[38:39], v17 offset:55296
    s_waitcnt lgkmcnt(4)
    v_mfma_f32_16x16x32_bf16 v[92:95], v[44:47], a[48:51], v[92:95]
    v_mfma_f32_16x16x32_bf16 v[124:127], v[44:47], a[112:115], v[124:127]
    ds_read_b64_tr_b16 v[40:41], v18 offset:53248
    ds_read_b64_tr_b16 v[42:43], v18 offset:55296
    s_waitcnt lgkmcnt(4)
    v_mfma_f32_16x16x32_bf16 v[64:67], v[32:35], a[52:55], v[64:67]
    v_mfma_f32_16x16x32_bf16 v[96:99], v[32:35], a[116:119], v[96:99]
    ds_read_b64_tr_b16 v[44:45], v19 offset:53248
    ds_read_b64_tr_b16 v[46:47], v19 offset:55296
    s_waitcnt lgkmcnt(4)
    v_mfma_f32_16x16x32_bf16 v[68:71], v[36:39], a[52:55], v[68:71]
    v_mfma_f32_16x16x32_bf16 v[100:103], v[36:39], a[116:119], v[100:103]
    ds_read_b64_tr_b16 v[32:33], v20 offset:53248
    ds_read_b64_tr_b16 v[34:35], v20 offset:55296
    s_waitcnt lgkmcnt(4)
    v_mfma_f32_16x16x32_bf16 v[72:75], v[40:43], a[52:55], v[72:75]
    v_mfma_f32_16x16x32_bf16 v[104:107], v[40:43], a[116:119], v[104:107]
    ds_read_b64_tr_b16 v[36:37], v21 offset:53248
    ds_read_b64_tr_b16 v[38:39], v21 offset:55296
    s_waitcnt lgkmcnt(4)
    v_mfma_f32_16x16x32_bf16 v[76:79], v[44:47], a[52:55], v[76:79]
    v_mfma_f32_16x16x32_bf16 v[108:111], v[44:47], a[116:119], v[108:111]
    ds_read_b64_tr_b16 v[40:41], v22 offset:53248
    ds_read_b64_tr_b16 v[42:43], v22 offset:55296
    s_waitcnt lgkmcnt(4)
    v_mfma_f32_16x16x32_bf16 v[80:83], v[32:35], a[52:55], v[80:83]
    v_mfma_f32_16x16x32_bf16 v[112:115], v[32:35], a[116:119], v[112:115]
    ds_read_b64_tr_b16 v[44:45], v23 offset:53248
    ds_read_b64_tr_b16 v[46:47], v23 offset:55296
    s_waitcnt lgkmcnt(4)
    v_mfma_f32_16x16x32_bf16 v[84:87], v[36:39], a[52:55], v[84:87]
    v_mfma_f32_16x16x32_bf16 v[116:119], v[36:39], a[116:119], v[116:119]
    ds_read_b64_tr_b16 v[32:33], v16 offset:57344
    ds_read_b64_tr_b16 v[34:35], v16 offset:59392
    s_waitcnt lgkmcnt(4)
    v_mfma_f32_16x16x32_bf16 v[88:91], v[40:43], a[52:55], v[88:91]
    v_mfma_f32_16x16x32_bf16 v[120:123], v[40:43], a[116:119], v[120:123]
    ds_read_b64_tr_b16 v[36:37], v17 offset:57344
    ds_read_b64_tr_b16 v[38:39], v17 offset:59392
    s_waitcnt lgkmcnt(4)
    v_mfma_f32_16x16x32_bf16 v[92:95], v[44:47], a[52:55], v[92:95]
    v_mfma_f32_16x16x32_bf16 v[124:127], v[44:47], a[116:119], v[124:127]
    ds_read_b64_tr_b16 v[40:41], v18 offset:57344
    ds_read_b64_tr_b16 v[42:43], v18 offset:59392
    s_waitcnt lgkmcnt(4)
    v_mfma_f32_16x16x32_bf16 v[64:67], v[32:35], a[56:59], v[64:67]
    v_mfma_f32_16x16x32_bf16 v[96:99], v[32:35], a[120:123], v[96:99]
    ds_read_b64_tr_b16 v[44:45], v19 offset:57344
    ds_read_b64_tr_b16 v[46:47], v19 offset:59392
    s_waitcnt lgkmcnt(4)
    v_mfma_f32_16x16x32_bf16 v[68:71], v[36:39], a[56:59], v[68:71]
    v_mfma_f32_16x16x32_bf16 v[100:103], v[36:39], a[120:123], v[100:103]
    ds_read_b64_tr_b16 v[32:33], v20 offset:57344
    ds_read_b64_tr_b16 v[34:35], v20 offset:59392
    s_waitcnt lgkmcnt(4)
    v_mfma_f32_16x16x32_bf16 v[72:75], v[40:43], a[56:59], v[72:75]
    v_mfma_f32_16x16x32_bf16 v[104:107], v[40:43], a[120:123], v[104:107]
    ds_read_b64_tr_b16 v[36:37], v21 offset:57344
    ds_read_b64_tr_b16 v[38:39], v21 offset:59392
    s_waitcnt lgkmcnt(4)
    v_mfma_f32_16x16x32_bf16 v[76:79], v[44:47], a[56:59], v[76:79]
    v_mfma_f32_16x16x32_bf16 v[108:111], v[44:47], a[120:123], v[108:111]
    ds_read_b64_tr_b16 v[40:41], v22 offset:57344
    ds_read_b64_tr_b16 v[42:43], v22 offset:59392
    s_waitcnt lgkmcnt(4)
    v_mfma_f32_16x16x32_bf16 v[80:83], v[32:35], a[56:59], v[80:83]
    v_mfma_f32_16x16x32_bf16 v[112:115], v[32:35], a[120:123], v[112:115]
    ds_read_b64_tr_b16 v[44:45], v23 offset:57344
    ds_read_b64_tr_b16 v[46:47], v23 offset:59392
    s_waitcnt lgkmcnt(4)
    v_mfma_f32_16x16x32_bf16 v[84:87], v[36:39], a[56:59], v[84:87]
    v_mfma_f32_16x16x32_bf16 v[116:119], v[36:39], a[120:123], v[116:119]
    ds_read_b64_tr_b16 v[32:33], v16 offset:61440
    ds_read_b64_tr_b16 v[34:35], v16 offset:63488
    s_waitcnt lgkmcnt(4)
    v_mfma_f32_16x16x32_bf16 v[88:91], v[40:43], a[56:59], v[88:91]
    v_mfma_f32_16x16x32_bf16 v[120:123], v[40:43], a[120:123], v[120:123]
    ds_read_b64_tr_b16 v[36:37], v17 offset:61440
    ds_read_b64_tr_b16 v[38:39], v17 offset:63488
    s_waitcnt lgkmcnt(4)
    v_mfma_f32_16x16x32_bf16 v[92:95], v[44:47], a[56:59], v[92:95]
    v_mfma_f32_16x16x32_bf16 v[124:127], v[44:47], a[120:123], v[124:127]
    ds_read_b64_tr_b16 v[40:41], v18 offset:61440
    ds_read_b64_tr_b16 v[42:43], v18 offset:63488
    s_waitcnt lgkmcnt(4)
    v_mfma_f32_16x16x32_bf16 v[64:67], v[32:35], a[60:63], v[64:67]
    v_mfma_f32_16x16x32_bf16 v[96:99], v[32:35], a[124:127], v[96:99]
    ds_read_b64_tr_b16 v[44:45], v19 offset:61440
    ds_read_b64_tr_b16 v[46:47], v19 offset:63488
    s_waitcnt lgkmcnt(4)
    v_mfma_f32_16x16x32_bf16 v[68:71], v[36:39], a[60:63], v[68:71]
    v_mfma_f32_16x16x32_bf16 v[100:103], v[36:39], a[124:127], v[100:103]
    ds_read_b64_tr_b16 v[32:33], v20 offset:61440
    ds_read_b64_tr_b16 v[34:35], v20 offset:63488
    s_waitcnt lgkmcnt(4)
    v_mfma_f32_16x16x32_bf16 v[72:75], v[40:43], a[60:63], v[72:75]
    v_mfma_f32_16x16x32_bf16 v[104:107], v[40:43], a[124:127], v[104:107]
    ds_read_b64_tr_b16 v[36:37], v21 offset:61440
    ds_read_b64_tr_b16 v[38:39], v21 offset:63488
    s_waitcnt lgkmcnt(4)
    v_mfma_f32_16x16x32_bf16 v[76:79], v[44:47], a[60:63], v[76:79]
    v_mfma_f32_16x16x32_bf16 v[108:111], v[44:47], a[124:127], v[108:111]
    ds_read_b64_tr_b16 v[40:41], v22 offset:61440
    ds_read_b64_tr_b16 v[42:43], v22 offset:63488
    s_waitcnt lgkmcnt(4)
    v_mfma_f32_16x16x32_bf16 v[80:83], v[32:35], a[60:63], v[80:83]
    v_mfma_f32_16x16x32_bf16 v[112:115], v[32:35], a[124:127], v[112:115]
    ds_read_b64_tr_b16 v[44:45], v23 offset:61440
    ds_read_b64_tr_b16 v[46:47], v23 offset:63488
    s_waitcnt lgkmcnt(4)
    v_mfma_f32_16x16x32_bf16 v[84:87], v[36:39], a[60:63], v[84:87]
    v_mfma_f32_16x16x32_bf16 v[116:119], v[36:39], a[124:127], v[116:119]
    s_waitcnt lgkmcnt(2)
    v_mfma_f32_16x16x32_bf16 v[88:91], v[40:43], a[60:63], v[88:91]
    v_mfma_f32_16x16x32_bf16 v[120:123], v[40:43], a[124:127], v[120:123]
    s_waitcnt lgkmcnt(0)
    v_mfma_f32_16x16x32_bf16 v[92:95], v[44:47], a[60:63], v[92:95]
    v_mfma_f32_16x16x32_bf16 v[124:127], v[44:47], a[124:127], v[124:127]
    s_mul_i32 s33, s31, 88064
    s_lshl_b32 s34, s21, 11
    s_add_u32 s33, s33, s34
    s_add_u32 s33, s33, 0x4000000
    v_cvt_pk_bf16_f32 v40, v64, v65
    v_cvt_pk_bf16_f32 v41, v80, v81
    v_lshlrev_b32 v42, 16, v40
    v_and_b32 v43, 0xffff0000, v40
    v_lshlrev_b32 v44, 16, v41
    v_and_b32 v45, 0xffff0000, v41
    v_pk_mul_f32 v[42:43], v[42:43], v[44:45]
    v_cvt_pk_bf16_f32 v48, v42, v43
    v_cvt_pk_bf16_f32 v40, v66, v67
    v_cvt_pk_bf16_f32 v41, v82, v83
    v_lshlrev_b32 v42, 16, v40
    v_and_b32 v43, 0xffff0000, v40
    v_lshlrev_b32 v44, 16, v41
    v_and_b32 v45, 0xffff0000, v41
    v_pk_mul_f32 v[42:43], v[42:43], v[44:45]
    v_cvt_pk_bf16_f32 v49, v42, v43
    v_cvt_pk_bf16_f32 v40, v68, v69
    v_cvt_pk_bf16_f32 v41, v84, v85
    v_lshlrev_b32 v42, 16, v40
    v_and_b32 v43, 0xffff0000, v40
    v_lshlrev_b32 v44, 16, v41
    v_and_b32 v45, 0xffff0000, v41
    v_pk_mul_f32 v[42:43], v[42:43], v[44:45]
    v_cvt_pk_bf16_f32 v50, v42, v43
    v_cvt_pk_bf16_f32 v40, v70, v71
    v_cvt_pk_bf16_f32 v41, v86, v87
    v_lshlrev_b32 v42, 16, v40
    v_and_b32 v43, 0xffff0000, v40
    v_lshlrev_b32 v44, 16, v41
    v_and_b32 v45, 0xffff0000, v41
    v_pk_mul_f32 v[42:43], v[42:43], v[44:45]
    v_cvt_pk_bf16_f32 v51, v42, v43
    buffer_store_dwordx4 v[48:51], v9, s[4:7], s33 offen sc1
    v_cvt_pk_bf16_f32 v40, v72, v73
    v_cvt_pk_bf16_f32 v41, v88, v89
    v_lshlrev_b32 v42, 16, v40
    v_and_b32 v43, 0xffff0000, v40
    v_lshlrev_b32 v44, 16, v41
    v_and_b32 v45, 0xffff0000, v41
    v_pk_mul_f32 v[42:43], v[42:43], v[44:45]
    v_cvt_pk_bf16_f32 v52, v42, v43
    v_cvt_pk_bf16_f32 v40, v74, v75
    v_cvt_pk_bf16_f32 v41, v90, v91
    v_lshlrev_b32 v42, 16, v40
    v_and_b32 v43, 0xffff0000, v40
    v_lshlrev_b32 v44, 16, v41
    v_and_b32 v45, 0xffff0000, v41
    v_pk_mul_f32 v[42:43], v[42:43], v[44:45]
    v_cvt_pk_bf16_f32 v53, v42, v43
    v_cvt_pk_bf16_f32 v40, v76, v77
    v_cvt_pk_bf16_f32 v41, v92, v93
    v_lshlrev_b32 v42, 16, v40
    v_and_b32 v43, 0xffff0000, v40
    v_lshlrev_b32 v44, 16, v41
    v_and_b32 v45, 0xffff0000, v41
    v_pk_mul_f32 v[42:43], v[42:43], v[44:45]
    v_cvt_pk_bf16_f32 v54, v42, v43
    v_cvt_pk_bf16_f32 v40, v78, v79
    v_cvt_pk_bf16_f32 v41, v94, v95
    v_lshlrev_b32 v42, 16, v40
    v_and_b32 v43, 0xffff0000, v40
    v_lshlrev_b32 v44, 16, v41
    v_and_b32 v45, 0xffff0000, v41
    v_pk_mul_f32 v[42:43], v[42:43], v[44:45]
    v_cvt_pk_bf16_f32 v55, v42, v43
    s_cmp_eq_u32 s21, 21
    s_cbranch_scc1 UPSK_39
    buffer_store_dwordx4 v[52:55], v9, s[4:7], s33 offen offset:1024 sc1
UPSK_39:
    v_cvt_pk_bf16_f32 v40, v96, v97
    v_cvt_pk_bf16_f32 v41, v112, v113
    v_lshlrev_b32 v42, 16, v40
    v_and_b32 v43, 0xffff0000, v40
    v_lshlrev_b32 v44, 16, v41
    v_and_b32 v45, 0xffff0000, v41
    v_pk_mul_f32 v[42:43], v[42:43], v[44:45]
    v_cvt_pk_bf16_f32 v56, v42, v43
    v_cvt_pk_bf16_f32 v40, v98, v99
    v_cvt_pk_bf16_f32 v41, v114, v115
    v_lshlrev_b32 v42, 16, v40
    v_and_b32 v43, 0xffff0000, v40
    v_lshlrev_b32 v44, 16, v41
    v_and_b32 v45, 0xffff0000, v41
    v_pk_mul_f32 v[42:43], v[42:43], v[44:45]
    v_cvt_pk_bf16_f32 v57, v42, v43
    v_cvt_pk_bf16_f32 v40, v100, v101
    v_cvt_pk_bf16_f32 v41, v116, v117
    v_lshlrev_b32 v42, 16, v40
    v_and_b32 v43, 0xffff0000, v40
    v_lshlrev_b32 v44, 16, v41
    v_and_b32 v45, 0xffff0000, v41
    v_pk_mul_f32 v[42:43], v[42:43], v[44:45]
    v_cvt_pk_bf16_f32 v58, v42, v43
    v_cvt_pk_bf16_f32 v40, v102, v103
    v_cvt_pk_bf16_f32 v41, v118, v119
    v_lshlrev_b32 v42, 16, v40
    v_and_b32 v43, 0xffff0000, v40
    v_lshlrev_b32 v44, 16, v41
    v_and_b32 v45, 0xffff0000, v41
    v_pk_mul_f32 v[42:43], v[42:43], v[44:45]
    v_cvt_pk_bf16_f32 v59, v42, v43
    s_add_u32 s33, s33, 44032
    buffer_store_dwordx4 v[56:59], v9, s[4:7], s33 offen sc1
    v_cvt_pk_bf16_f32 v40, v104, v105
    v_cvt_pk_bf16_f32 v41, v120, v121
    v_lshlrev_b32 v42, 16, v40
    v_and_b32 v43, 0xffff0000, v40
    v_lshlrev_b32 v44, 16, v41
    v_and_b32 v45, 0xffff0000, v41
    v_pk_mul_f32 v[42:43], v[42:43], v[44:45]
    v_cvt_pk_bf16_f32 v60, v42, v43
    v_cvt_pk_bf16_f32 v40, v106, v107
    v_cvt_pk_bf16_f32 v41, v122, v123
    v_lshlrev_b32 v42, 16, v40
    v_and_b32 v43, 0xffff0000, v40
    v_lshlrev_b32 v44, 16, v41
    v_and_b32 v45, 0xffff0000, v41
    v_pk_mul_f32 v[42:43], v[42:43], v[44:45]
    v_cvt_pk_bf16_f32 v61, v42, v43
    v_cvt_pk_bf16_f32 v40, v108, v109
    v_cvt_pk_bf16_f32 v41, v124, v125
    v_lshlrev_b32 v42, 16, v40
    v_and_b32 v43, 0xffff0000, v40
    v_lshlrev_b32 v44, 16, v41
    v_and_b32 v45, 0xffff0000, v41
    v_pk_mul_f32 v[42:43], v[42:43], v[44:45]
    v_cvt_pk_bf16_f32 v62, v42, v43
    v_cvt_pk_bf16_f32 v40, v110, v111
    v_cvt_pk_bf16_f32 v41, v126, v127
    v_lshlrev_b32 v42, 16, v40
    v_and_b32 v43, 0xffff0000, v40
    v_lshlrev_b32 v44, 16, v41
    v_and_b32 v45, 0xffff0000, v41
    v_pk_mul_f32 v[42:43], v[42:43], v[44:45]
    v_cvt_pk_bf16_f32 v63, v42, v43
    s_cmp_eq_u32 s21, 21
    s_cbranch_scc1 UPSK_40
    buffer_store_dwordx4 v[60:63], v9, s[4:7], s33 offen offset:1024 sc1
UPSK_40:
    s_add_u32 s32, s32, 1
    s_waitcnt vmcnt(0)
    v_mov_b32 v3, s32
    s_mov_b64 exec, 1
    buffer_store_dword v3, v8, s[4:7], 0 offen sc1
    s_mov_b64 exec, -1
    s_add_u32 s31, s31, 4
    s_cmp_lt_u32 s31, 64
    s_cbranch_scc1 UP_LOOP
    s_endpgm
ROLE_DN:
    s_and_b32 s23, s21, 31
    s_lshl_b32 s23, s23, 7
    s_add_u32 s23, s23, 0x9000
    v_mov_b32 v2, s23
    s_mov_b32 s25, 1
    s_mov_b32 s24, 32768
WF_41:
    buffer_load_dword v3, v2, s[4:7], 0 offen sc1
    s_waitcnt vmcnt(0)
    v_cmp_gt_u32 vcc, s25, v3
    s_sub_u32 s24, s24, 1
    s_cbranch_scc1 WFE_42
    s_nop 2
    s_cbranch_vccz WFE_42
    s_sleep 32
    s_branch WF_41
WFE_42:
    s_load_dwordx2 s[8:9], s[0:1], 80
    s_mov_b32 s10, 0x158000
    s_mov_b32 s11, 0x20000
    s_waitcnt lgkmcnt(0)
    s_lshr_b32 s37, s21, 3
    s_and_b32 s39, s21, 7
    s_add_u32 s38, s37, 4
    s_mul_i32 s30, s37, 720896
    s_lshl_b32 s23, s39, 7
    s_add_u32 s30, s30, s23
    v_lshrrev_b32 v2, 3, v0
    v_bfe_u32 v3, v0, 4, 2
    v_bfe_u32 v4, v0, 1, 2
    v_xor_b32 v4, v4, v3
    v_lshlrev_b32 v4, 5, v4
    v_and_b32 v3, 1, v0
    v_lshl_add_u32 v4, v3, 4, v4
    s_mov_b32 s23, 1024
    v_mul_lo_u32 v2, v2, s23
    v_add_u32 v2, v2, v4
    s_mul_i32 s24, s20, 8192
    s_add_u32 s24, s24, s30
    s_lshl_b32 s25, s20, 10
    s_add_u32 s25, s25, 0
    s_mov_b32 s27, 22
DMA_43:
    s_mov_b32 m0, s25
    s_add_u32 s25, s25, 4096
    buffer_load_dwordx4 v2, s[8:11], s24 offen lds
    s_add_u32 s24, s24, 32768
    s_sub_u32 s27, s27, 1
    s_cmp_lg_u32 s27, 0
    s_cbranch_scc1 DMA_43
    v_bfe_u32 v2, v0, 2, 2
    v_lshrrev_b32 v3, 4, v0
    v_lshl_add_u32 v4, v3, 2, v2
    v_lshlrev_b32 v5, 7, v4
    v_bfe_u32 v4, v4, 1, 2
    v_and_b32 v6, 3, v0
    v_lshl_add_u32 v5, v6, 3, v5
    v_xor_b32 v7, 0, v4
    v_lshl_add_u32 v16, v7, 5, v5
    v_add_u32 v20, 0x10000, v16
    v_xor_b32 v7, 1, v4
    v_lshl_add_u32 v17, v7, 5, v5
    v_add_u32 v21, 0x10000, v17
    v_xor_b32 v7, 2, v4
    v_lshl_add_u32 v18, v7, 5, v5
    v_add_u32 v22, 0x10000, v18
    v_xor_b32 v7, 3, v4
    v_lshl_add_u32 v19, v7, 5, v5
    v_add_u32 v23, 0x10000, v19
    s_lshl_b32 s24, s20, 2
    s_add_u32 s24, s24, 0x8000
    s_lshl_b32 s23, s21, 7
    s_add_u32 s24, s24, s23
    v_mov_b32 v8, s24
    v_lshlrev_b32 v9, 4, v0
    v_and_b32 v2, 15, v0
    v_min_u32 v2, 10, v2
    s_mul_i32 s23, s37, 11
    v_add_u32 v2, s23, v2
    s_lshl_b32 s24, s20, 2
    s_add_u32 s24, s24, 0x6000
    v_lshlrev_b32 v10, 7, v2
    v_add_u32 v10, s24, v10
    s_waitcnt vmcnt(0)
    s_barrier
    s_mov_b32 s31, s20
    s_mov_b32 s32, 0
DN_LOOP:
    s_add_u32 s34, s32, 1
    s_mov_b32 s24, 32768
WF_44:
    buffer_load_dword v3, v10, s[4:7], 0 offen sc1
    s_waitcnt vmcnt(0)
    v_cmp_gt_u32 vcc, s34, v3
    s_sub_u32 s24, s24, 1
    s_cbranch_scc1 WFE_45
    s_nop 2
    s_cbranch_vccz WFE_45
    s_sleep 1
    s_branch WF_44
WFE_45:
    s_mul_i32 s33, s31, 88064
    s_mul_i32 s34, s37, 22528
    s_add_u32 s33, s33, s34
    s_add_u32 s33, s33, 0x4000000
    s_cmp_eq_u32 s37, 0
    s_cbranch_scc0 DN_B
    s_mov_b32 s35, s33
    buffer_load_dwordx4 a[0:3], v9, s[4:7], s35 offen offset:0
    buffer_load_dwordx4 a[4:7], v9, s[4:7], s35 offen offset:1024
    buffer_load_dwordx4 a[8:11], v9, s[4:7], s35 offen offset:2048
    buffer_load_dwordx4 a[12:15], v9, s[4:7], s35 offen offset:3072
    s_add_u32 s35, s35, 4096
    buffer_load_dwordx4 a[16:19], v9, s[4:7], s35 offen offset:0
    buffer_load_dwordx4 a[20:23], v9, s[4:7], s35 offen offset:1024
    buffer_load_dwordx4 a[24:27], v9, s[4:7], s35 offen offset:2048
    buffer_load_dwordx4 a[28:31], v9, s[4:7], s35 offen offset:3072
    s_add_u32 s35, s35, 4096
    buffer_load_dwordx4 a[32:35], v9, s[4:7], s35 offen offset:0
    buffer_load_dwordx4 a[36:39], v9, s[4:7], s35 offen offset:1024
    buffer_load_dwordx4 a[40:43], v9, s[4:7], s35 offen offset:2048
    buffer_load_dwordx4 a[44:47], v9, s[4:7], s35 offen offset:3072
    s_add_u32 s35, s35, 4096
    buffer_load_dwordx4 a[48:51], v9, s[4:7], s35 offen offset:0
    buffer_load_dwordx4 a[52:55], v9, s[4:7], s35 offen offset:1024
    buffer_load_dwordx4 a[56:59], v9, s[4:7], s35 offen offset:2048
    buffer_load_dwordx4 a[60:63], v9, s[4:7], s35 offen offset:3072
    s_add_u32 s35, s35, 4096
    buffer_load_dwordx4 a[64:67], v9, s[4:7], s35 offen offset:0
    buffer_load_dwordx4 a[68:71], v9, s[4:7], s35 offen offset:1024
    buffer_load_dwordx4 a[72:75], v9, s[4:7], s35 offen offset:2048
    buffer_load_dwordx4 a[76:79], v9, s[4:7], s35 offen offset:3072
    s_add_u32 s35, s35, 4096
    buffer_load_dwordx4 a[80:83], v9, s[4:7], s35 offen offset:0
    buffer_load_dwordx4 a[84:87], v9, s[4:7], s35 offen offset:1024
    s_add_u32 s35, s33, 44032
    buffer_load_dwordx4 a[88:91], v9, s[4:7], s35 offen offset:0
    buffer_load_dwordx4 a[92:95], v9, s[4:7], s35 offen offset:1024
    buffer_load_dwordx4 a[96:99], v9, s[4:7], s35 offen offset:2048
    buffer_load_dwordx4 a[100:103], v9, s[4:7], s35 offen offset:3072
    s_add_u32 s35, s35, 4096
    buffer_load_dwordx4 a[104:107], v9, s[4:7], s35 offen offset:0
    buffer_load_dwordx4 a[108:111], v9, s[4:7], s35 offen offset:1024
    buffer_load_dwordx4 a[112:115], v9, s[4:7], s35 offen offset:2048
    buffer_load_dwordx4 a[116:119], v9, s[4:7], s35 offen offset:3072
    s_add_u32 s35, s35, 4096
    buffer_load_dwordx4 a[120:123], v9, s[4:7], s35 offen offset:0
    buffer_load_dwordx4 a[124:127], v9, s[4:7], s35 offen offset:1024
    buffer_load_dwordx4 a[128:131], v9, s[4:7], s35 offen offset:2048
    buffer_load_dwordx4 a[132:135], v9, s[4:7], s35 offen offset:3072
    s_add_u32 s35, s35, 4096
    buffer_load_dwordx4 a[136:139], v9, s[4:7], s35 offen offset:0
    buffer_load_dwordx4 a[140:143], v9, s[4:7], s35 offen offset:1024
    buffer_load_dwordx4 a[144:147], v9, s[4:7], s35 offen offset:2048
    buffer_load_dwordx4 a[148:151], v9, s[4:7], s35 offen offset:3072
    s_add_u32 s35, s35, 4096
    buffer_load_dwordx4 a[152:155], v9, s[4:7], s35 offen offset:0
    buffer_load_dwordx4 a[156:159], v9, s[4:7], s35 offen offset:1024
    buffer_load_dwordx4 a[160:163], v9, s[4:7], s35 offen offset:2048
    buffer_load_dwordx4 a[164:167], v9, s[4:7], s35 offen offset:3072
    s_add_u32 s35, s35, 4096
    buffer_load_dwordx4 a[168:171], v9, s[4:7], s35 offen offset:0
    buffer_load_dwordx4 a[172:175], v9, s[4:7], s35 offen offset:1024
    s_waitcnt vmcnt(0)
    ds_read_b64_tr_b16 v[32:33], v16 offset:0
    ds_read_b64_tr_b16 v[34:35], v16 offset:2048
    ds_read_b64_tr_b16 v[36:37], v17 offset:0
    ds_read_b64_tr_b16 v[38:39], v17 offset:2048
    ds_read_b64_tr_b16 v[40:41], v18 offset:0
    ds_read_b64_tr_b16 v[42:43], v18 offset:2048
    s_waitcnt lgkmcnt(4)
    v_mfma_f32_16x16x32_bf16 v[64:67], v[32:35], a[0:3], 0
    v_mfma_f32_16x16x32_bf16 v[80:83], v[32:35], a[88:91], 0
    ds_read_b64_tr_b16 v[44:45], v19 offset:0
    ds_read_b64_tr_b16 v[46:47], v19 offset:2048
    s_waitcnt lgkmcnt(4)
    v_mfma_f32_16x16x32_bf16 v[68:71], v[36:39], a[0:3], 0
    v_mfma_f32_16x16x32_bf16 v[84:87], v[36:39], a[88:91], 0
    ds_read_b64_tr_b16 v[32:33], v16 offset:4096
    ds_read_b64_tr_b16 v[34:35], v16 offset:6144
    s_waitcnt lgkmcnt(4)
    v_mfma_f32_16x16x32_bf16 v[72:75], v[40:43], a[0:3], 0
    v_mfma_f32_16x16x32_bf16 v[88:91], v[40:43], a[88:91], 0
    ds_read_b64_tr_b16 v[36:37], v17 offset:4096
    ds_read_b64_tr_b16 v[38:39], v17 offset:6144
    s_waitcnt lgkmcnt(4)
    v_mfma_f32_16x16x32_bf16 v[76:79], v[44:47], a[0:3], 0
    v_mfma_f32_16x16x32_bf16 v[92:95], v[44:47], a[88:91], 0
    ds_read_b64_tr_b16 v[40:41], v18 offset:4096
    ds_read_b64_tr_b16 v[42:43], v18 offset:6144
    s_waitcnt lgkmcnt(4)
    v_mfma_f32_16x16x32_bf16 v[64:67], v[32:35], a[4:7], v[64:67]
    v_mfma_f32_16x16x32_bf16 v[80:83], v[32:35], a[92:95], v[80:83]
    ds_read_b64_tr_b16 v[44:45], v19 offset:4096
    ds_read_b64_tr_b16 v[46:47], v19 offset:6144
    s_waitcnt lgkmcnt(4)
    v_mfma_f32_16x16x32_bf16 v[68:71], v[36:39], a[4:7], v[68:71]
    v_mfma_f32_16x16x32_bf16 v[84:87], v[36:39], a[92:95], v[84:87]
    ds_read_b64_tr_b16 v[32:33], v16 offset:8192
    ds_read_b64_tr_b16 v[34:35], v16 offset:10240
    s_waitcnt lgkmcnt(4)
    v_mfma_f32_16x16x32_bf16 v[72:75], v[40:43], a[4:7], v[72:75]
    v_mfma_f32_16x16x32_bf16 v[88:91], v[40:43], a[92:95], v[88:91]
    ds_read_b64_tr_b16 v[36:37], v17 offset:8192
    ds_read_b64_tr_b16 v[38:39], v17 offset:10240
    s_waitcnt lgkmcnt(4)
    v_mfma_f32_16x16x32_bf16 v[76:79], v[44:47], a[4:7], v[76:79]
    v_mfma_f32_16x16x32_bf16 v[92:95], v[44:47], a[92:95], v[92:95]
    ds_read_b64_tr_b16 v[40:41], v18 offset:8192
    ds_read_b64_tr_b16 v[42:43], v18 offset:10240
    s_waitcnt lgkmcnt(4)
    v_mfma_f32_16x16x32_bf16 v[64:67], v[32:35], a[8:11], v[64:67]
    v_mfma_f32_16x16x32_bf16 v[80:83], v[32:35], a[96:99], v[80:83]
    ds_read_b64_tr_b16 v[44:45], v19 offset:8192
    ds_read_b64_tr_b16 v[46:47], v19 offset:10240
    s_waitcnt lgkmcnt(4)
    v_mfma_f32_16x16x32_bf16 v[68:71], v[36:39], a[8:11], v[68:71]
    v_mfma_f32_16x16x32_bf16 v[84:87], v[36:39], a[96:99], v[84:87]
    ds_read_b64_tr_b16 v[32:33], v16 offset:12288
    ds_read_b64_tr_b16 v[34:35], v16 offset:14336
    s_waitcnt lgkmcnt(4)
    v_mfma_f32_16x16x32_bf16 v[72:75], v[40:43], a[8:11], v[72:75]
    v_mfma_f32_16x16x32_bf16 v[88:91], v[40:43], a[96:99], v[88:91]
    ds_read_b64_tr_b16 v[36:37], v17 offset:12288
    ds_read_b64_tr_b16 v[38:39], v17 offset:14336
    s_waitcnt lgkmcnt(4)
    v_mfma_f32_16x16x32_bf16 v[76:79], v[44:47], a[8:11], v[76:79]
    v_mfma_f32_16x16x32_bf16 v[92:95], v[44:47], a[96:99], v[92:95]
    ds_read_b64_tr_b16 v[40:41], v18 offset:12288
    ds_read_b64_tr_b16 v[42:43], v18 offset:14336
    s_waitcnt lgkmcnt(4)
    v_mfma_f32_16x16x32_bf16 v[64:67], v[32:35], a[12:15], v[64:67]
    v_mfma_f32_16x16x32_bf16 v[80:83], v[32:35], a[100:103], v[80:83]
    ds_read_b64_tr_b16 v[44:45], v19 offset:12288
    ds_read_b64_tr_b16 v[46:47], v19 offset:14336
    s_waitcnt lgkmcnt(4)
    v_mfma_f32_16x16x32_bf16 v[68:71], v[36:39], a[12:15], v[68:71]
    v_mfma_f32_16x16x32_bf16 v[84:87], v[36:39], a[100:103], v[84:87]
    ds_read_b64_tr_b16 v[32:33], v16 offset:16384
    ds_read_b64_tr_b16 v[34:35], v16 offset:18432
    s_waitcnt lgkmcnt(4)
    v_mfma_f32_16x16x32_bf16 v[72:75], v[40:43], a[12:15], v[72:75]
    v_mfma_f32_16x16x32_bf16 v[88:91], v[40:43], a[100:103], v[88:91]
    ds_read_b64_tr_b16 v[36:37], v17 offset:16384
    ds_read_b64_tr_b16 v[38:39], v17 offset:18432
    s_waitcnt lgkmcnt(4)
    v_mfma_f32_16x16x32_bf16 v[76:79], v[44:47], a[12:15], v[76:79]
    v_mfma_f32_16x16x32_bf16 v[92:95], v[44:47], a[100:103], v[92:95]
    ds_read_b64_tr_b16 v[40:41], v18 offset:16384
    ds_read_b64_tr_b16 v[42:43], v18 offset:18432
    s_waitcnt lgkmcnt(4)
    v_mfma_f32_16x16x32_bf16 v[64:67], v[32:35], a[16:19], v[64:67]
    v_mfma_f32_16x16x32_bf16 v[80:83], v[32:35], a[104:107], v[80:83]
    ds_read_b64_tr_b16 v[44:45], v19 offset:16384
    ds_read_b64_tr_b16 v[46:47], v19 offset:18432
    s_waitcnt lgkmcnt(4)
    v_mfma_f32_16x16x32_bf16 v[68:71], v[36:39], a[16:19], v[68:71]
    v_mfma_f32_16x16x32_bf16 v[84:87], v[36:39], a[104:107], v[84:87]
    ds_read_b64_tr_b16 v[32:33], v16 offset:20480
    ds_read_b64_tr_b16 v[34:35], v16 offset:22528
    s_waitcnt lgkmcnt(4)
    v_mfma_f32_16x16x32_bf16 v[72:75], v[40:43], a[16:19], v[72:75]
    v_mfma_f32_16x16x32_bf16 v[88:91], v[40:43], a[104:107], v[88:91]
    ds_read_b64_tr_b16 v[36:37], v17 offset:20480
    ds_read_b64_tr_b16 v[38:39], v17 offset:22528
    s_waitcnt lgkmcnt(4)
    v_mfma_f32_16x16x32_bf16 v[76:79], v[44:47], a[16:19], v[76:79]
    v_mfma_f32_16x16x32_bf16 v[92:95], v[44:47], a[104:107], v[92:95]
    ds_read_b64_tr_b16 v[40:41], v18 offset:20480
    ds_read_b64_tr_b16 v[42:43], v18 offset:22528
    s_waitcnt lgkmcnt(4)
    v_mfma_f32_16x16x32_bf16 v[64:67], v[32:35], a[20:23], v[64:67]
    v_mfma_f32_16x16x32_bf16 v[80:83], v[32:35], a[108:111], v[80:83]
    ds_read_b64_tr_b16 v[44:45], v19 offset:20480
    ds_read_b64_tr_b16 v[46:47], v19 offset:22528
    s_waitcnt lgkmcnt(4)
    v_mfma_f32_16x16x32_bf16 v[68:71], v[36:39], a[20:23], v[68:71]
    v_mfma_f32_16x16x32_bf16 v[84:87], v[36:39], a[108:111], v[84:87]
    ds_read_b64_tr_b16 v[32:33], v16 offset:24576
    ds_read_b64_tr_b16 v[34:35], v16 offset:26624
    s_waitcnt lgkmcnt(4)
    v_mfma_f32_16x16x32_bf16 v[72:75], v[40:43], a[20:23], v[72:75]
    v_mfma_f32_16x16x32_bf16 v[88:91], v[40:43], a[108:111], v[88:91]
    ds_read_b64_tr_b16 v[36:37], v17 offset:24576
    ds_read_b64_tr_b16 v[38:39], v17 offset:26624
    s_waitcnt lgkmcnt(4)
    v_mfma_f32_16x16x32_bf16 v[76:79], v[44:47], a[20:23], v[76:79]
    v_mfma_f32_16x16x32_bf16 v[92:95], v[44:47], a[108:111], v[92:95]
    ds_read_b64_tr_b16 v[40:41], v18 offset:24576
    ds_read_b64_tr_b16 v[42:43], v18 offset:26624
    s_waitcnt lgkmcnt(4)
    v_mfma_f32_16x16x32_bf16 v[64:67], v[32:35], a[24:27], v[64:67]
    v_mfma_f32_16x16x32_bf16 v[80:83], v[32:35], a[112:115], v[80:83]
    ds_read_b64_tr_b16 v[44:45], v19 offset:24576
    ds_read_b64_tr_b16 v[46:47], v19 offset:26624
    s_waitcnt lgkmcnt(4)
    v_mfma_f32_16x16x32_bf16 v[68:71], v[36:39], a[24:27], v[68:71]
    v_mfma_f32_16x16x32_bf16 v[84:87], v[36:39], a[112:115], v[84:87]
    ds_read_b64_tr_b16 v[32:33], v16 offset:28672
    ds_read_b64_tr_b16 v[34:35], v16 offset:30720
    s_waitcnt lgkmcnt(4)
    v_mfma_f32_16x16x32_bf16 v[72:75], v[40:43], a[24:27], v[72:75]
    v_mfma_f32_16x16x32_bf16 v[88:91], v[40:43], a[112:115], v[88:91]
    ds_read_b64_tr_b16 v[36:37], v17 offset:28672
    ds_read_b64_tr_b16 v[38:39], v17 offset:30720
    s_waitcnt lgkmcnt(4)
    v_mfma_f32_16x16x32_bf16 v[76:79], v[44:47], a[24:27], v[76:79]
    v_mfma_f32_16x16x32_bf16 v[92:95], v[44:47], a[112:115], v[92:95]
    ds_read_b64_tr_b16 v[40:41], v18 offset:28672
    ds_read_b64_tr_b16 v[42:43], v18 offset:30720
    s_waitcnt lgkmcnt(4)
    v_mfma_f32_16x16x32_bf16 v[64:67], v[32:35], a[28:31], v[64:67]
    v_mfma_f32_16x16x32_bf16 v[80:83], v[32:35], a[116:119], v[80:83]
    ds_read_b64_tr_b16 v[44:45], v19 offset:28672
    ds_read_b64_tr_b16 v[46:47], v19 offset:30720
    s_waitcnt lgkmcnt(4)
    v_mfma_f32_16x16x32_bf16 v[68:71], v[36:39], a[28:31], v[68:71]
    v_mfma_f32_16x16x32_bf16 v[84:87], v[36:39], a[116:119], v[84:87]
    ds_read_b64_tr_b16 v[32:33], v16 offset:32768
    ds_read_b64_tr_b16 v[34:35], v16 offset:34816
    s_waitcnt lgkmcnt(4)
    v_mfma_f32_16x16x32_bf16 v[72:75], v[40:43], a[28:31], v[72:75]
    v_mfma_f32_16x16x32_bf16 v[88:91], v[40:43], a[116:119], v[88:91]
    ds_read_b64_tr_b16 v[36:37], v17 offset:32768
    ds_read_b64_tr_b16 v[38:39], v17 offset:34816
    s_waitcnt lgkmcnt(4)
    v_mfma_f32_16x16x32_bf16 v[76:79], v[44:47], a[28:31], v[76:79]
    v_mfma_f32_16x16x32_bf16 v[92:95], v[44:47], a[116:119], v[92:95]
    ds_read_b64_tr_b16 v[40:41], v18 offset:32768
    ds_read_b64_tr_b16 v[42:43], v18 offset:34816
    s_waitcnt lgkmcnt(4)
    v_mfma_f32_16x16x32_bf16 v[64:67], v[32:35], a[32:35], v[64:67]
    v_mfma_f32_16x16x32_bf16 v[80:83], v[32:35], a[120:123], v[80:83]
    ds_read_b64_tr_b16 v[44:45], v19 offset:32768
    ds_read_b64_tr_b16 v[46:47], v19 offset:34816
    s_waitcnt lgkmcnt(4)
    v_mfma_f32_16x16x32_bf16 v[68:71], v[36:39], a[32:35], v[68:71]
    v_mfma_f32_16x16x32_bf16 v[84:87], v[36:39], a[120:123], v[84:87]
    ds_read_b64_tr_b16 v[32:33], v16 offset:36864
    ds_read_b64_tr_b16 v[34:35], v16 offset:38912
    s_waitcnt lgkmcnt(4)
    v_mfma_f32_16x16x32_bf16 v[72:75], v[40:43], a[32:35], v[72:75]
    v_mfma_f32_16x16x32_bf16 v[88:91], v[40:43], a[120:123], v[88:91]
    ds_read_b64_tr_b16 v[36:37], v17 offset:36864
    ds_read_b64_tr_b16 v[38:39], v17 offset:38912
    s_waitcnt lgkmcnt(4)
    v_mfma_f32_16x16x32_bf16 v[76:79], v[44:47], a[32:35], v[76:79]
    v_mfma_f32_16x16x32_bf16 v[92:95], v[44:47], a[120:123], v[92:95]
    ds_read_b64_tr_b16 v[40:41], v18 offset:36864
    ds_read_b64_tr_b16 v[42:43], v18 offset:38912
    s_waitcnt lgkmcnt(4)
    v_mfma_f32_16x16x32_bf16 v[64:67], v[32:35], a[36:39], v[64:67]
    v_mfma_f32_16x16x32_bf16 v[80:83], v[32:35], a[124:127], v[80:83]
    ds_read_b64_tr_b16 v[44:45], v19 offset:36864
    ds_read_b64_tr_b16 v[46:47], v19 offset:38912
    s_waitcnt lgkmcnt(4)
    v_mfma_f32_16x16x32_bf16 v[68:71], v[36:39], a[36:39], v[68:71]
    v_mfma_f32_16x16x32_bf16 v[84:87], v[36:39], a[124:127], v[84:87]
    ds_read_b64_tr_b16 v[32:33], v16 offset:40960
    ds_read_b64_tr_b16 v[34:35], v16 offset:43008
    s_waitcnt lgkmcnt(4)
    v_mfma_f32_16x16x32_bf16 v[72:75], v[40:43], a[36:39], v[72:75]
    v_mfma_f32_16x16x32_bf16 v[88:91], v[40:43], a[124:127], v[88:91]
    ds_read_b64_tr_b16 v[36:37], v17 offset:40960
    ds_read_b64_tr_b16 v[38:39], v17 offset:43008
    s_waitcnt lgkmcnt(4)
    v_mfma_f32_16x16x32_bf16 v[76:79], v[44:47], a[36:39], v[76:79]
    v_mfma_f32_16x16x32_bf16 v[92:95], v[44:47], a[124:127], v[92:95]
    ds_read_b64_tr_b16 v[40:41], v18 offset:40960
    ds_read_b64_tr_b16 v[42:43], v18 offset:43008
    s_waitcnt lgkmcnt(4)
    v_mfma_f32_16x16x32_bf16 v[64:67], v[32:35], a[40:43], v[64:67]
    v_mfma_f32_16x16x32_bf16 v[80:83], v[32:35], a[128:131], v[80:83]
    ds_read_b64_tr_b16 v[44:45], v19 offset:40960
    ds_read_b64_tr_b16 v[46:47], v19 offset:43008
    s_waitcnt lgkmcnt(4)
    v_mfma_f32_16x16x32_bf16 v[68:71], v[36:39], a[40:43], v[68:71]
    v_mfma_f32_16x16x32_bf16 v[84:87], v[36:39], a[128:131], v[84:87]
    ds_read_b64_tr_b16 v[32:33], v16 offset:45056
    ds_read_b64_tr_b16 v[34:35], v16 offset:47104
    s_waitcnt lgkmcnt(4)
    v_mfma_f32_16x16x32_bf16 v[72:75], v[40:43], a[40:43], v[72:75]
    v_mfma_f32_16x16x32_bf16 v[88:91], v[40:43], a[128:131], v[88:91]
    ds_read_b64_tr_b16 v[36:37], v17 offset:45056
    ds_read_b64_tr_b16 v[38:39], v17 offset:47104
    s_waitcnt lgkmcnt(4)
    v_mfma_f32_16x16x32_bf16 v[76:79], v[44:47], a[40:43], v[76:79]
    v_mfma_f32_16x16x32_bf16 v[92:95], v[44:47], a[128:131], v[92:95]
    ds_read_b64_tr_b16 v[40:41], v18 offset:45056
    ds_read_b64_tr_b16 v[42:43], v18 offset:47104
    s_waitcnt lgkmcnt(4)
    v_mfma_f32_16x16x32_bf16 v[64:67], v[32:35], a[44:47], v[64:67]
    v_mfma_f32_16x16x32_bf16 v[80:83], v[32:35], a[132:135], v[80:83]
    ds_read_b64_tr_b16 v[44:45], v19 offset:45056
    ds_read_b64_tr_b16 v[46:47], v19 offset:47104
    s_waitcnt lgkmcnt(4)
    v_mfma_f32_16x16x32_bf16 v[68:71], v[36:39], a[44:47], v[68:71]
    v_mfma_f32_16x16x32_bf16 v[84:87], v[36:39], a[132:135], v[84:87]
    ds_read_b64_tr_b16 v[32:33], v16 offset:49152
    ds_read_b64_tr_b16 v[34:35], v16 offset:51200
    s_waitcnt lgkmcnt(4)
    v_mfma_f32_16x16x32_bf16 v[72:75], v[40:43], a[44:47], v[72:75]
    v_mfma_f32_16x16x32_bf16 v[88:91], v[40:43], a[132:135], v[88:91]
    ds_read_b64_tr_b16 v[36:37], v17 offset:49152
    ds_read_b64_tr_b16 v[38:39], v17 offset:51200
    s_waitcnt lgkmcnt(4)
    v_mfma_f32_16x16x32_bf16 v[76:79], v[44:47], a[44:47], v[76:79]
    v_mfma_f32_16x16x32_bf16 v[92:95], v[44:47], a[132:135], v[92:95]
    ds_read_b64_tr_b16 v[40:41], v18 offset:49152
    ds_read_b64_tr_b16 v[42:43], v18 offset:51200
    s_waitcnt lgkmcnt(4)
    v_mfma_f32_16x16x32_bf16 v[64:67], v[32:35], a[48:51], v[64:67]
    v_mfma_f32_16x16x32_bf16 v[80:83], v[32:35], a[136:139], v[80:83]
    ds_read_b64_tr_b16 v[44:45], v19 offset:49152
    ds_read_b64_tr_b16 v[46:47], v19 offset:51200
    s_waitcnt lgkmcnt(4)
    v_mfma_f32_16x16x32_bf16 v[68:71], v[36:39], a[48:51], v[68:71]
    v_mfma_f32_16x16x32_bf16 v[84:87], v[36:39], a[136:139], v[84:87]
    ds_read_b64_tr_b16 v[32:33], v16 offset:53248
    ds_read_b64_tr_b16 v[34:35], v16 offset:55296
    s_waitcnt lgkmcnt(4)
    v_mfma_f32_16x16x32_bf16 v[72:75], v[40:43], a[48:51], v[72:75]
    v_mfma_f32_16x16x32_bf16 v[88:91], v[40:43], a[136:139], v[88:91]
    ds_read_b64_tr_b16 v[36:37], v17 offset:53248
    ds_read_b64_tr_b16 v[38:39], v17 offset:55296
    s_waitcnt lgkmcnt(4)
    v_mfma_f32_16x16x32_bf16 v[76:79], v[44:47], a[48:51], v[76:79]
    v_mfma_f32_16x16x32_bf16 v[92:95], v[44:47], a[136:139], v[92:95]
    ds_read_b64_tr_b16 v[40:41], v18 offset:53248
    ds_read_b64_tr_b16 v[42:43], v18 offset:55296
    s_waitcnt lgkmcnt(4)
    v_mfma_f32_16x16x32_bf16 v[64:67], v[32:35], a[52:55], v[64:67]
    v_mfma_f32_16x16x32_bf16 v[80:83], v[32:35], a[140:143], v[80:83]
    ds_read_b64_tr_b16 v[44:45], v19 offset:53248
    ds_read_b64_tr_b16 v[46:47], v19 offset:55296
    s_waitcnt lgkmcnt(4)
    v_mfma_f32_16x16x32_bf16 v[68:71], v[36:39], a[52:55], v[68:71]
    v_mfma_f32_16x16x32_bf16 v[84:87], v[36:39], a[140:143], v[84:87]
    ds_read_b64_tr_b16 v[32:33], v16 offset:57344
    ds_read_b64_tr_b16 v[34:35], v16 offset:59392
    s_waitcnt lgkmcnt(4)
    v_mfma_f32_16x16x32_bf16 v[72:75], v[40:43], a[52:55], v[72:75]
    v_mfma_f32_16x16x32_bf16 v[88:91], v[40:43], a[140:143], v[88:91]
    ds_read_b64_tr_b16 v[36:37], v17 offset:57344
    ds_read_b64_tr_b16 v[38:39], v17 offset:59392
    s_waitcnt lgkmcnt(4)
    v_mfma_f32_16x16x32_bf16 v[76:79], v[44:47], a[52:55], v[76:79]
    v_mfma_f32_16x16x32_bf16 v[92:95], v[44:47], a[140:143], v[92:95]
    ds_read_b64_tr_b16 v[40:41], v18 offset:57344
    ds_read_b64_tr_b16 v[42:43], v18 offset:59392
    s_waitcnt lgkmcnt(4)
    v_mfma_f32_16x16x32_bf16 v[64:67], v[32:35], a[56:59], v[64:67]
    v_mfma_f32_16x16x32_bf16 v[80:83], v[32:35], a[144:147], v[80:83]
    ds_read_b64_tr_b16 v[44:45], v19 offset:57344
    ds_read_b64_tr_b16 v[46:47], v19 offset:59392
    s_waitcnt lgkmcnt(4)
    v_mfma_f32_16x16x32_bf16 v[68:71], v[36:39], a[56:59], v[68:71]
    v_mfma_f32_16x16x32_bf16 v[84:87], v[36:39], a[144:147], v[84:87]
    ds_read_b64_tr_b16 v[32:33], v16 offset:61440
    ds_read_b64_tr_b16 v[34:35], v16 offset:63488
    s_waitcnt lgkmcnt(4)
    v_mfma_f32_16x16x32_bf16 v[72:75], v[40:43], a[56:59], v[72:75]
    v_mfma_f32_16x16x32_bf16 v[88:91], v[40:43], a[144:147], v[88:91]
    ds_read_b64_tr_b16 v[36:37], v17 offset:61440
    ds_read_b64_tr_b16 v[38:39], v17 offset:63488
    s_waitcnt lgkmcnt(4)
    v_mfma_f32_16x16x32_bf16 v[76:79], v[44:47], a[56:59], v[76:79]
    v_mfma_f32_16x16x32_bf16 v[92:95], v[44:47], a[144:147], v[92:95]
    ds_read_b64_tr_b16 v[40:41], v18 offset:61440
    ds_read_b64_tr_b16 v[42:43], v18 offset:63488
    s_waitcnt lgkmcnt(4)
    v_mfma_f32_16x16x32_bf16 v[64:67], v[32:35], a[60:63], v[64:67]
    v_mfma_f32_16x16x32_bf16 v[80:83], v[32:35], a[148:151], v[80:83]
    ds_read_b64_tr_b16 v[44:45], v19 offset:61440
    ds_read_b64_tr_b16 v[46:47], v19 offset:63488
    s_waitcnt lgkmcnt(4)
    v_mfma_f32_16x16x32_bf16 v[68:71], v[36:39], a[60:63], v[68:71]
    v_mfma_f32_16x16x32_bf16 v[84:87], v[36:39], a[148:151], v[84:87]
    ds_read_b64_tr_b16 v[32:33], v20 offset:0
    ds_read_b64_tr_b16 v[34:35], v20 offset:2048
    s_waitcnt lgkmcnt(4)
    v_mfma_f32_16x16x32_bf16 v[72:75], v[40:43], a[60:63], v[72:75]
    v_mfma_f32_16x16x32_bf16 v[88:91], v[40:43], a[148:151], v[88:91]
    ds_read_b64_tr_b16 v[36:37], v21 offset:0
    ds_read_b64_tr_b16 v[38:39], v21 offset:2048
    s_waitcnt lgkmcnt(4)
    v_mfma_f32_16x16x32_bf16 v[76:79], v[44:47], a[60:63], v[76:79]
    v_mfma_f32_16x16x32_bf16 v[92:95], v[44:47], a[148:151], v[92:95]
    ds_read_b64_tr_b16 v[40:41], v22 offset:0
    ds_read_b64_tr_b16 v[42:43], v22 offset:2048
    s_waitcnt lgkmcnt(4)
    v_mfma_f32_16x16x32_bf16 v[64:67], v[32:35], a[64:67], v[64:67]
    v_mfma_f32_16x16x32_bf16 v[80:83], v[32:35], a[152:155], v[80:83]
    ds_read_b64_tr_b16 v[44:45], v23 offset:0
    ds_read_b64_tr_b16 v[46:47], v23 offset:2048
    s_waitcnt lgkmcnt(4)
    v_mfma_f32_16x16x32_bf16 v[68:71], v[36:39], a[64:67], v[68:71]
    v_mfma_f32_16x16x32_bf16 v[84:87], v[36:39], a[152:155], v[84:87]
    ds_read_b64_tr_b16 v[32:33], v20 offset:4096
    ds_read_b64_tr_b16 v[34:35], v20 offset:6144
    s_waitcnt lgkmcnt(4)
    v_mfma_f32_16x16x32_bf16 v[72:75], v[40:43], a[64:67], v[72:75]
    v_mfma_f32_16x16x32_bf16 v[88:91], v[40:43], a[152:155], v[88:91]
    ds_read_b64_tr_b16 v[36:37], v21 offset:4096
    ds_read_b64_tr_b16 v[38:39], v21 offset:6144
    s_waitcnt lgkmcnt(4)
    v_mfma_f32_16x16x32_bf16 v[76:79], v[44:47], a[64:67], v[76:79]
    v_mfma_f32_16x16x32_bf16 v[92:95], v[44:47], a[152:155], v[92:95]
    ds_read_b64_tr_b16 v[40:41], v22 offset:4096
    ds_read_b64_tr_b16 v[42:43], v22 offset:6144
    s_waitcnt lgkmcnt(4)
    v_mfma_f32_16x16x32_bf16 v[64:67], v[32:35], a[68:71], v[64:67]
    v_mfma_f32_16x16x32_bf16 v[80:83], v[32:35], a[156:159], v[80:83]
    ds_read_b64_tr_b16 v[44:45], v23 offset:4096
    ds_read_b64_tr_b16 v[46:47], v23 offset:6144
    s_waitcnt lgkmcnt(4)
    v_mfma_f32_16x16x32_bf16 v[68:71], v[36:39], a[68:71], v[68:71]
    v_mfma_f32_16x16x32_bf16 v[84:87], v[36:39], a[156:159], v[84:87]
    ds_read_b64_tr_b16 v[32:33], v20 offset:8192
    ds_read_b64_tr_b16 v[34:35], v20 offset:10240
    s_waitcnt lgkmcnt(4)
    v_mfma_f32_16x16x32_bf16 v[72:75], v[40:43], a[68:71], v[72:75]
    v_mfma_f32_16x16x32_bf16 v[88:91], v[40:43], a[156:159], v[88:91]
    ds_read_b64_tr_b16 v[36:37], v21 offset:8192
    ds_read_b64_tr_b16 v[38:39], v21 offset:10240
    s_waitcnt lgkmcnt(4)
    v_mfma_f32_16x16x32_bf16 v[76:79], v[44:47], a[68:71], v[76:79]
    v_mfma_f32_16x16x32_bf16 v[92:95], v[44:47], a[156:159], v[92:95]
    ds_read_b64_tr_b16 v[40:41], v22 offset:8192
    ds_read_b64_tr_b16 v[42:43], v22 offset:10240
    s_waitcnt lgkmcnt(4)
    v_mfma_f32_16x16x32_bf16 v[64:67], v[32:35], a[72:75], v[64:67]
    v_mfma_f32_16x16x32_bf16 v[80:83], v[32:35], a[160:163], v[80:83]
    ds_read_b64_tr_b16 v[44:45], v23 offset:8192
    ds_read_b64_tr_b16 v[46:47], v23 offset:10240
    s_waitcnt lgkmcnt(4)
    v_mfma_f32_16x16x32_bf16 v[68:71], v[36:39], a[72:75], v[68:71]
    v_mfma_f32_16x16x32_bf16 v[84:87], v[36:39], a[160:163], v[84:87]
    ds_read_b64_tr_b16 v[32:33], v20 offset:12288
    ds_read_b64_tr_b16 v[34:35], v20 offset:14336
    s_waitcnt lgkmcnt(4)
    v_mfma_f32_16x16x32_bf16 v[72:75], v[40:43], a[72:75], v[72:75]
    v_mfma_f32_16x16x32_bf16 v[88:91], v[40:43], a[160:163], v[88:91]
    ds_read_b64_tr_b16 v[36:37], v21 offset:12288
    ds_read_b64_tr_b16 v[38:39], v21 offset:14336
    s_waitcnt lgkmcnt(4)
    v_mfma_f32_16x16x32_bf16 v[76:79], v[44:47], a[72:75], v[76:79]
    v_mfma_f32_16x16x32_bf16 v[92:95], v[44:47], a[160:163], v[92:95]
    ds_read_b64_tr_b16 v[40:41], v22 offset:12288
    ds_read_b64_tr_b16 v[42:43], v22 offset:14336
    s_waitcnt lgkmcnt(4)
    v_mfma_f32_16x16x32_bf16 v[64:67], v[32:35], a[76:79], v[64:67]
    v_mfma_f32_16x16x32_bf16 v[80:83], v[32:35], a[164:167], v[80:83]
    ds_read_b64_tr_b16 v[44:45], v23 offset:12288
    ds_read_b64_tr_b16 v[46:47], v23 offset:14336
    s_waitcnt lgkmcnt(4)
    v_mfma_f32_16x16x32_bf16 v[68:71], v[36:39], a[76:79], v[68:71]
    v_mfma_f32_16x16x32_bf16 v[84:87], v[36:39], a[164:167], v[84:87]
    ds_read_b64_tr_b16 v[32:33], v20 offset:16384
    ds_read_b64_tr_b16 v[34:35], v20 offset:18432
    s_waitcnt lgkmcnt(4)
    v_mfma_f32_16x16x32_bf16 v[72:75], v[40:43], a[76:79], v[72:75]
    v_mfma_f32_16x16x32_bf16 v[88:91], v[40:43], a[164:167], v[88:91]
    ds_read_b64_tr_b16 v[36:37], v21 offset:16384
    ds_read_b64_tr_b16 v[38:39], v21 offset:18432
    s_waitcnt lgkmcnt(4)
    v_mfma_f32_16x16x32_bf16 v[76:79], v[44:47], a[76:79], v[76:79]
    v_mfma_f32_16x16x32_bf16 v[92:95], v[44:47], a[164:167], v[92:95]
    ds_read_b64_tr_b16 v[40:41], v22 offset:16384
    ds_read_b64_tr_b16 v[42:43], v22 offset:18432
    s_waitcnt lgkmcnt(4)
    v_mfma_f32_16x16x32_bf16 v[64:67], v[32:35], a[80:83], v[64:67]
    v_mfma_f32_16x16x32_bf16 v[80:83], v[32:35], a[168:171], v[80:83]
    ds_read_b64_tr_b16 v[44:45], v23 offset:16384
    ds_read_b64_tr_b16 v[46:47], v23 offset:18432
    s_waitcnt lgkmcnt(4)
    v_mfma_f32_16x16x32_bf16 v[68:71], v[36:39], a[80:83], v[68:71]
    v_mfma_f32_16x16x32_bf16 v[84:87], v[36:39], a[168:171], v[84:87]
    ds_read_b64_tr_b16 v[32:33], v20 offset:20480
    ds_read_b64_tr_b16 v[34:35], v20 offset:22528
    s_waitcnt lgkmcnt(4)
    v_mfma_f32_16x16x32_bf16 v[72:75], v[40:43], a[80:83], v[72:75]
    v_mfma_f32_16x16x32_bf16 v[88:91], v[40:43], a[168:171], v[88:91]
    ds_read_b64_tr_b16 v[36:37], v21 offset:20480
    ds_read_b64_tr_b16 v[38:39], v21 offset:22528
    s_waitcnt lgkmcnt(4)
    v_mfma_f32_16x16x32_bf16 v[76:79], v[44:47], a[80:83], v[76:79]
    v_mfma_f32_16x16x32_bf16 v[92:95], v[44:47], a[168:171], v[92:95]
    ds_read_b64_tr_b16 v[40:41], v22 offset:20480
    ds_read_b64_tr_b16 v[42:43], v22 offset:22528
    s_waitcnt lgkmcnt(4)
    v_mfma_f32_16x16x32_bf16 v[64:67], v[32:35], a[84:87], v[64:67]
    v_mfma_f32_16x16x32_bf16 v[80:83], v[32:35], a[172:175], v[80:83]
    ds_read_b64_tr_b16 v[44:45], v23 offset:20480
    ds_read_b64_tr_b16 v[46:47], v23 offset:22528
    s_waitcnt lgkmcnt(4)
    v_mfma_f32_16x16x32_bf16 v[68:71], v[36:39], a[84:87], v[68:71]
    v_mfma_f32_16x16x32_bf16 v[84:87], v[36:39], a[172:175], v[84:87]
    s_waitcnt lgkmcnt(2)
    v_mfma_f32_16x16x32_bf16 v[72:75], v[40:43], a[84:87], v[72:75]
    v_mfma_f32_16x16x32_bf16 v[88:91], v[40:43], a[172:175], v[88:91]
    s_waitcnt lgkmcnt(0)
    v_mfma_f32_16x16x32_bf16 v[76:79], v[44:47], a[84:87], v[76:79]
    v_mfma_f32_16x16x32_bf16 v[92:95], v[44:47], a[172:175], v[92:95]
    s_branch DN_EPI
DN_B:
    s_mov_b32 s35, s33
    buffer_load_dwordx4 a[0:3], v9, s[4:7], s35 offen offset:0
    buffer_load_dwordx4 a[4:7], v9, s[4:7], s35 offen offset:1024
    buffer_load_dwordx4 a[8:11], v9, s[4:7], s35 offen offset:2048
    buffer_load_dwordx4 a[12:15], v9, s[4:7], s35 offen offset:3072
    s_add_u32 s35, s35, 4096
    buffer_load_dwordx4 a[16:19], v9, s[4:7], s35 offen offset:0
    buffer_load_dwordx4 a[20:23], v9, s[4:7], s35 offen offset:1024
    buffer_load_dwordx4 a[24:27], v9, s[4:7], s35 offen offset:2048
    buffer_load_dwordx4 a[28:31], v9, s[4:7], s35 offen offset:3072
    s_add_u32 s35, s35, 4096
    buffer_load_dwordx4 a[32:35], v9, s[4:7], s35 offen offset:0
    buffer_load_dwordx4 a[36:39], v9, s[4:7], s35 offen offset:1024
    buffer_load_dwordx4 a[40:43], v9, s[4:7], s35 offen offset:2048
    buffer_load_dwordx4 a[44:47], v9, s[4:7], s35 offen offset:3072
    s_add_u32 s35, s35, 4096
    buffer_load_dwordx4 a[48:51], v9, s[4:7], s35 offen offset:0
    buffer_load_dwordx4 a[52:55], v9, s[4:7], s35 offen offset:1024
    buffer_load_dwordx4 a[56:59], v9, s[4:7], s35 offen offset:2048
    buffer_load_dwordx4 a[60:63], v9, s[4:7], s35 offen offset:3072
    s_add_u32 s35, s35, 4096
    buffer_load_dwordx4 a[64:67], v9, s[4:7], s35 offen offset:0
    buffer_load_dwordx4 a[68:71], v9, s[4:7], s35 offen offset:1024
    buffer_load_dwordx4 a[72:75], v9, s[4:7], s35 offen offset:2048
    buffer_load_dwordx4 a[76:79], v9, s[4:7], s35 offen offset:3072
    s_add_u32 s35, s35, 4096
    buffer_load_dwordx4 a[80:83], v9, s[4:7], s35 offen offset:0
    s_add_u32 s35, s33, 44032
    buffer_load_dwordx4 a[88:91], v9, s[4:7], s35 offen offset:0
    buffer_load_dwordx4 a[92:95], v9, s[4:7], s35 offen offset:1024
    buffer_load_dwordx4 a[96:99], v9, s[4:7], s35 offen offset:2048
    buffer_load_dwordx4 a[100:103], v9, s[4:7], s35 offen offset:3072
    s_add_u32 s35, s35, 4096
    buffer_load_dwordx4 a[104:107], v9, s[4:7], s35 offen offset:0
    buffer_load_dwordx4 a[108:111], v9, s[4:7], s35 offen offset:1024
    buffer_load_dwordx4 a[112:115], v9, s[4:7], s35 offen offset:2048
    buffer_load_dwordx4 a[116:119], v9, s[4:7], s35 offen offset:3072
    s_add_u32 s35, s35, 4096
    buffer_load_dwordx4 a[120:123], v9, s[4:7], s35 offen offset:0
    buffer_load_dwordx4 a[124:127], v9, s[4:7], s35 offen offset:1024
    buffer_load_dwordx4 a[128:131], v9, s[4:7], s35 offen offset:2048
    buffer_load_dwordx4 a[132:135], v9, s[4:7], s35 offen offset:3072
    s_add_u32 s35, s35, 4096
    buffer_load_dwordx4 a[136:139], v9, s[4:7], s35 offen offset:0
    buffer_load_dwordx4 a[140:143], v9, s[4:7], s35 offen offset:1024
    buffer_load_dwordx4 a[144:147], v9, s[4:7], s35 offen offset:2048
    buffer_load_dwordx4 a[148:151], v9, s[4:7], s35 offen offset:3072
    s_add_u32 s35, s35, 4096
    buffer_load_dwordx4 a[152:155], v9, s[4:7], s35 offen offset:0
    buffer_load_dwordx4 a[156:159], v9, s[4:7], s35 offen offset:1024
    buffer_load_dwordx4 a[160:163], v9, s[4:7], s35 offen offset:2048
    buffer_load_dwordx4 a[164:167], v9, s[4:7], s35 offen offset:3072
    s_add_u32 s35, s35, 4096
    buffer_load_dwordx4 a[168:171], v9, s[4:7], s35 offen offset:0
    s_waitcnt vmcnt(0)
    ds_read_b64_tr_b16 v[32:33], v16 offset:0
    ds_read_b64_tr_b16 v[34:35], v16 offset:2048
    ds_read_b64_tr_b16 v[36:37], v17 offset:0
    ds_read_b64_tr_b16 v[38:39], v17 offset:2048
    ds_read_b64_tr_b16 v[40:41], v18 offset:0
    ds_read_b64_tr_b16 v[42:43], v18 offset:2048
    s_waitcnt lgkmcnt(4)
    v_mfma_f32_16x16x32_bf16 v[64:67], v[32:35], a[0:3], 0
    v_mfma_f32_16x16x32_bf16 v[80:83], v[32:35], a[88:91], 0
    ds_read_b64_tr_b16 v[44:45], v19 offset:0
    ds_read_b64_tr_b16 v[46:47], v19 offset:2048
    s_waitcnt lgkmcnt(4)
    v_mfma_f32_16x16x32_bf16 v[68:71], v[36:39], a[0:3], 0
    v_mfma_f32_16x16x32_bf16 v[84:87], v[36:39], a[88:91], 0
    ds_read_b64_tr_b16 v[32:33], v16 offset:4096
    ds_read_b64_tr_b16 v[34:35], v16 offset:6144
    s_waitcnt lgkmcnt(4)
    v_mfma_f32_16x16x32_bf16 v[72:75], v[40:43], a[0:3], 0
    v_mfma_f32_16x16x32_bf16 v[88:91], v[40:43], a[88:91], 0
    ds_read_b64_tr_b16 v[36:37], v17 offset:4096
    ds_read_b64_tr_b16 v[38:39], v17 offset:6144
    s_waitcnt lgkmcnt(4)
    v_mfma_f32_16x16x32_bf16 v[76:79], v[44:47], a[0:3], 0
    v_mfma_f32_16x16x32_bf16 v[92:95], v[44:47], a[88:91], 0
    ds_read_b64_tr_b16 v[40:41], v18 offset:4096
    ds_read_b64_tr_b16 v[42:43], v18 offset:6144
    s_waitcnt lgkmcnt(4)
    v_mfma_f32_16x16x32_bf16 v[64:67], v[32:35], a[4:7], v[64:67]
    v_mfma_f32_16x16x32_bf16 v[80:83], v[32:35], a[92:95], v[80:83]
    ds_read_b64_tr_b16 v[44:45], v19 offset:4096
    ds_read_b64_tr_b16 v[46:47], v19 offset:6144
    s_waitcnt lgkmcnt(4)
    v_mfma_f32_16x16x32_bf16 v[68:71], v[36:39], a[4:7], v[68:71]
    v_mfma_f32_16x16x32_bf16 v[84:87], v[36:39], a[92:95], v[84:87]
    ds_read_b64_tr_b16 v[32:33], v16 offset:8192
    ds_read_b64_tr_b16 v[34:35], v16 offset:10240
    s_waitcnt lgkmcnt(4)
    v_mfma_f32_16x16x32_bf16 v[72:75], v[40:43], a[4:7], v[72:75]
    v_mfma_f32_16x16x32_bf16 v[88:91], v[40:43], a[92:95], v[88:91]
    ds_read_b64_tr_b16 v[36:37], v17 offset:8192
    ds_read_b64_tr_b16 v[38:39], v17 offset:10240
    s_waitcnt lgkmcnt(4)
    v_mfma_f32_16x16x32_bf16 v[76:79], v[44:47], a[4:7], v[76:79]
    v_mfma_f32_16x16x32_bf16 v[92:95], v[44:47], a[92:95], v[92:95]
    ds_read_b64_tr_b16 v[40:41], v18 offset:8192
    ds_read_b64_tr_b16 v[42:43], v18 offset:10240
    s_waitcnt lgkmcnt(4)
    v_mfma_f32_16x16x32_bf16 v[64:67], v[32:35], a[8:11], v[64:67]
    v_mfma_f32_16x16x32_bf16 v[80:83], v[32:35], a[96:99], v[80:83]
    ds_read_b64_tr_b16 v[44:45], v19 offset:8192
    ds_read_b64_tr_b16 v[46:47], v19 offset:10240
    s_waitcnt lgkmcnt(4)
    v_mfma_f32_16x16x32_bf16 v[68:71], v[36:39], a[8:11], v[68:71]
    v_mfma_f32_16x16x32_bf16 v[84:87], v[36:39], a[96:99], v[84:87]
    ds_read_b64_tr_b16 v[32:33], v16 offset:12288
    ds_read_b64_tr_b16 v[34:35], v16 offset:14336
    s_waitcnt lgkmcnt(4)
    v_mfma_f32_16x16x32_bf16 v[72:75], v[40:43], a[8:11], v[72:75]
    v_mfma_f32_16x16x32_bf16 v[88:91], v[40:43], a[96:99], v[88:91]
    ds_read_b64_tr_b16 v[36:37], v17 offset:12288
    ds_read_b64_tr_b16 v[38:39], v17 offset:14336
    s_waitcnt lgkmcnt(4)
    v_mfma_f32_16x16x32_bf16 v[76:79], v[44:47], a[8:11], v[76:79]
    v_mfma_f32_16x16x32_bf16 v[92:95], v[44:47], a[96:99], v[92:95]
    ds_read_b64_tr_b16 v[40:41], v18 offset:12288
    ds_read_b64_tr_b16 v[42:43], v18 offset:14336
    s_waitcnt lgkmcnt(4)
    v_mfma_f32_16x16x32_bf16 v[64:67], v[32:35], a[12:15], v[64:67]
    v_mfma_f32_16x16x32_bf16 v[80:83], v[32:35], a[100:103], v[80:83]
    ds_read_b64_tr_b16 v[44:45], v19 offset:12288
    ds_read_b64_tr_b16 v[46:47], v19 offset:14336
    s_waitcnt lgkmcnt(4)
    v_mfma_f32_16x16x32_bf16 v[68:71], v[36:39], a[12:15], v[68:71]
    v_mfma_f32_16x16x32_bf16 v[84:87], v[36:39], a[100:103], v[84:87]
    ds_read_b64_tr_b16 v[32:33], v16 offset:16384
    ds_read_b64_tr_b16 v[34:35], v16 offset:18432
    s_waitcnt lgkmcnt(4)
    v_mfma_f32_16x16x32_bf16 v[72:75], v[40:43], a[12:15], v[72:75]
    v_mfma_f32_16x16x32_bf16 v[88:91], v[40:43], a[100:103], v[88:91]
    ds_read_b64_tr_b16 v[36:37], v17 offset:16384
    ds_read_b64_tr_b16 v[38:39], v17 offset:18432
    s_waitcnt lgkmcnt(4)
    v_mfma_f32_16x16x32_bf16 v[76:79], v[44:47], a[12:15], v[76:79]
    v_mfma_f32_16x16x32_bf16 v[92:95], v[44:47], a[100:103], v[92:95]
    ds_read_b64_tr_b16 v[40:41], v18 offset:16384
    ds_read_b64_tr_b16 v[42:43], v18 offset:18432
    s_waitcnt lgkmcnt(4)
    v_mfma_f32_16x16x32_bf16 v[64:67], v[32:35], a[16:19], v[64:67]
    v_mfma_f32_16x16x32_bf16 v[80:83], v[32:35], a[104:107], v[80:83]
    ds_read_b64_tr_b16 v[44:45], v19 offset:16384
    ds_read_b64_tr_b16 v[46:47], v19 offset:18432
    s_waitcnt lgkmcnt(4)
    v_mfma_f32_16x16x32_bf16 v[68:71], v[36:39], a[16:19], v[68:71]
    v_mfma_f32_16x16x32_bf16 v[84:87], v[36:39], a[104:107], v[84:87]
    ds_read_b64_tr_b16 v[32:33], v16 offset:20480
    ds_read_b64_tr_b16 v[34:35], v16 offset:22528
    s_waitcnt lgkmcnt(4)
    v_mfma_f32_16x16x32_bf16 v[72:75], v[40:43], a[16:19], v[72:75]
    v_mfma_f32_16x16x32_bf16 v[88:91], v[40:43], a[104:107], v[88:91]
    ds_read_b64_tr_b16 v[36:37], v17 offset:20480
    ds_read_b64_tr_b16 v[38:39], v17 offset:22528
    s_waitcnt lgkmcnt(4)
    v_mfma_f32_16x16x32_bf16 v[76:79], v[44:47], a[16:19], v[76:79]
    v_mfma_f32_16x16x32_bf16 v[92:95], v[44:47], a[104:107], v[92:95]
    ds_read_b64_tr_b16 v[40:41], v18 offset:20480
    ds_read_b64_tr_b16 v[42:43], v18 offset:22528
    s_waitcnt lgkmcnt(4)
    v_mfma_f32_16x16x32_bf16 v[64:67], v[32:35], a[20:23], v[64:67]
    v_mfma_f32_16x16x32_bf16 v[80:83], v[32:35], a[108:111], v[80:83]
    ds_read_b64_tr_b16 v[44:45], v19 offset:20480
    ds_read_b64_tr_b16 v[46:47], v19 offset:22528
    s_waitcnt lgkmcnt(4)
    v_mfma_f32_16x16x32_bf16 v[68:71], v[36:39], a[20:23], v[68:71]
    v_mfma_f32_16x16x32_bf16 v[84:87], v[36:39], a[108:111], v[84:87]
    ds_read_b64_tr_b16 v[32:33], v16 offset:24576
    ds_read_b64_tr_b16 v[34:35], v16 offset:26624
    s_waitcnt lgkmcnt(4)
    v_mfma_f32_16x16x32_bf16 v[72:75], v[40:43], a[20:23], v[72:75]
    v_mfma_f32_16x16x32_bf16 v[88:91], v[40:43], a[108:111], v[88:91]
    ds_read_b64_tr_b16 v[36:37], v17 offset:24576
    ds_read_b64_tr_b16 v[38:39], v17 offset:26624
    s_waitcnt lgkmcnt(4)
    v_mfma_f32_16x16x32_bf16 v[76:79], v[44:47], a[20:23], v[76:79]
    v_mfma_f32_16x16x32_bf16 v[92:95], v[44:47], a[108:111], v[92:95]
    ds_read_b64_tr_b16 v[40:41], v18 offset:24576
    ds_read_b64_tr_b16 v[42:43], v18 offset:26624
    s_waitcnt lgkmcnt(4)
    v_mfma_f32_16x16x32_bf16 v[64:67], v[32:35], a[24:27], v[64:67]
    v_mfma_f32_16x16x32_bf16 v[80:83], v[32:35], a[112:115], v[80:83]
    ds_read_b64_tr_b16 v[44:45], v19 offset:24576
    ds_read_b64_tr_b16 v[46:47], v19 offset:26624
    s_waitcnt lgkmcnt(4)
    v_mfma_f32_16x16x32_bf16 v[68:71], v[36:39], a[24:27], v[68:71]
    v_mfma_f32_16x16x32_bf16 v[84:87], v[36:39], a[112:115], v[84:87]
    ds_read_b64_tr_b16 v[32:33], v16 offset:28672
    ds_read_b64_tr_b16 v[34:35], v16 offset:30720
    s_waitcnt lgkmcnt(4)
    v_mfma_f32_16x16x32_bf16 v[72:75], v[40:43], a[24:27], v[72:75]
    v_mfma_f32_16x16x32_bf16 v[88:91], v[40:43], a[112:115], v[88:91]
    ds_read_b64_tr_b16 v[36:37], v17 offset:28672
    ds_read_b64_tr_b16 v[38:39], v17 offset:30720
    s_waitcnt lgkmcnt(4)
    v_mfma_f32_16x16x32_bf16 v[76:79], v[44:47], a[24:27], v[76:79]
    v_mfma_f32_16x16x32_bf16 v[92:95], v[44:47], a[112:115], v[92:95]
    ds_read_b64_tr_b16 v[40:41], v18 offset:28672
    ds_read_b64_tr_b16 v[42:43], v18 offset:30720
    s_waitcnt lgkmcnt(4)
    v_mfma_f32_16x16x32_bf16 v[64:67], v[32:35], a[28:31], v[64:67]
    v_mfma_f32_16x16x32_bf16 v[80:83], v[32:35], a[116:119], v[80:83]
    ds_read_b64_tr_b16 v[44:45], v19 offset:28672
    ds_read_b64_tr_b16 v[46:47], v19 offset:30720
    s_waitcnt lgkmcnt(4)
    v_mfma_f32_16x16x32_bf16 v[68:71], v[36:39], a[28:31], v[68:71]
    v_mfma_f32_16x16x32_bf16 v[84:87], v[36:39], a[116:119], v[84:87]
    ds_read_b64_tr_b16 v[32:33], v16 offset:32768
    ds_read_b64_tr_b16 v[34:35], v16 offset:34816
    s_waitcnt lgkmcnt(4)
    v_mfma_f32_16x16x32_bf16 v[72:75], v[40:43], a[28:31], v[72:75]
    v_mfma_f32_16x16x32_bf16 v[88:91], v[40:43], a[116:119], v[88:91]
    ds_read_b64_tr_b16 v[36:37], v17 offset:32768
    ds_read_b64_tr_b16 v[38:39], v17 offset:34816
    s_waitcnt lgkmcnt(4)
    v_mfma_f32_16x16x32_bf16 v[76:79], v[44:47], a[28:31], v[76:79]
    v_mfma_f32_16x16x32_bf16 v[92:95], v[44:47], a[116:119], v[92:95]
    ds_read_b64_tr_b16 v[40:41], v18 offset:32768
    ds_read_b64_tr_b16 v[42:43], v18 offset:34816
    s_waitcnt lgkmcnt(4)
    v_mfma_f32_16x16x32_bf16 v[64:67], v[32:35], a[32:35], v[64:67]
    v_mfma_f32_16x16x32_bf16 v[80:83], v[32:35], a[120:123], v[80:83]
    ds_read_b64_tr_b16 v[44:45], v19 offset:32768
    ds_read_b64_tr_b16 v[46:47], v19 offset:34816
    s_waitcnt lgkmcnt(4)
    v_mfma_f32_16x16x32_bf16 v[68:71], v[36:39], a[32:35], v[68:71]
    v_mfma_f32_16x16x32_bf16 v[84:87], v[36:39], a[120:123], v[84:87]
    ds_read_b64_tr_b16 v[32:33], v16 offset:36864
    ds_read_b64_tr_b16 v[34:35], v16 offset:38912
    s_waitcnt lgkmcnt(4)
    v_mfma_f32_16x16x32_bf16 v[72:75], v[40:43], a[32:35], v[72:75]
    v_mfma_f32_16x16x32_bf16 v[88:91], v[40:43], a[120:123], v[88:91]
    ds_read_b64_tr_b16 v[36:37], v17 offset:36864
    ds_read_b64_tr_b16 v[38:39], v17 offset:38912
    s_waitcnt lgkmcnt(4)
    v_mfma_f32_16x16x32_bf16 v[76:79], v[44:47], a[32:35], v[76:79]
    v_mfma_f32_16x16x32_bf16 v[92:95], v[44:47], a[120:123], v[92:95]
    ds_read_b64_tr_b16 v[40:41], v18 offset:36864
    ds_read_b64_tr_b16 v[42:43], v18 offset:38912
    s_waitcnt lgkmcnt(4)
    v_mfma_f32_16x16x32_bf16 v[64:67], v[32:35], a[36:39], v[64:67]
    v_mfma_f32_16x16x32_bf16 v[80:83], v[32:35], a[124:127], v[80:83]
    ds_read_b64_tr_b16 v[44:45], v19 offset:36864
    ds_read_b64_tr_b16 v[46:47], v19 offset:38912
    s_waitcnt lgkmcnt(4)
    v_mfma_f32_16x16x32_bf16 v[68:71], v[36:39], a[36:39], v[68:71]
    v_mfma_f32_16x16x32_bf16 v[84:87], v[36:39], a[124:127], v[84:87]
    ds_read_b64_tr_b16 v[32:33], v16 offset:40960
    ds_read_b64_tr_b16 v[34:35], v16 offset:43008
    s_waitcnt lgkmcnt(4)
    v_mfma_f32_16x16x32_bf16 v[72:75], v[40:43], a[36:39], v[72:75]
    v_mfma_f32_16x16x32_bf16 v[88:91], v[40:43], a[124:127], v[88:91]
    ds_read_b64_tr_b16 v[36:37], v17 offset:40960
    ds_read_b64_tr_b16 v[38:39], v17 offset:43008
    s_waitcnt lgkmcnt(4)
    v_mfma_f32_16x16x32_bf16 v[76:79], v[44:47], a[36:39], v[76:79]
    v_mfma_f32_16x16x32_bf16 v[92:95], v[44:47], a[124:127], v[92:95]
    ds_read_b64_tr_b16 v[40:41], v18 offset:40960
    ds_read_b64_tr_b16 v[42:43], v18 offset:43008
    s_waitcnt lgkmcnt(4)
    v_mfma_f32_16x16x32_bf16 v[64:67], v[32:35], a[40:43], v[64:67]
    v_mfma_f32_16x16x32_bf16 v[80:83], v[32:35], a[128:131], v[80:83]
    ds_read_b64_tr_b16 v[44:45], v19 offset:40960
    ds_read_b64_tr_b16 v[46:47], v19 offset:43008
    s_waitcnt lgkmcnt(4)
    v_mfma_f32_16x16x32_bf16 v[68:71], v[36:39], a[40:43], v[68:71]
    v_mfma_f32_16x16x32_bf16 v[84:87], v[36:39], a[128:131], v[84:87]
    ds_read_b64_tr_b16 v[32:33], v16 offset:45056
    ds_read_b64_tr_b16 v[34:35], v16 offset:47104
    s_waitcnt lgkmcnt(4)
    v_mfma_f32_16x16x32_bf16 v[72:75], v[40:43], a[40:43], v[72:75]
    v_mfma_f32_16x16x32_bf16 v[88:91], v[40:43], a[128:131], v[88:91]
    ds_read_b64_tr_b16 v[36:37], v17 offset:45056
    ds_read_b64_tr_b16 v[38:39], v17 offset:47104
    s_waitcnt lgkmcnt(4)
    v_mfma_f32_16x16x32_bf16 v[76:79], v[44:47], a[40:43], v[76:79]
    v_mfma_f32_16x16x32_bf16 v[92:95], v[44:47], a[128:131], v[92:95]
    ds_read_b64_tr_b16 v[40:41], v18 offset:45056
    ds_read_b64_tr_b16 v[42:43], v18 offset:47104
    s_waitcnt lgkmcnt(4)
    v_mfma_f32_16x16x32_bf16 v[64:67], v[32:35], a[44:47], v[64:67]
    v_mfma_f32_16x16x32_bf16 v[80:83], v[32:35], a[132:135], v[80:83]
    ds_read_b64_tr_b16 v[44:45], v19 offset:45056
    ds_read_b64_tr_b16 v[46:47], v19 offset:47104
    s_waitcnt lgkmcnt(4)
    v_mfma_f32_16x16x32_bf16 v[68:71], v[36:39], a[44:47], v[68:71]
    v_mfma_f32_16x16x32_bf16 v[84:87], v[36:39], a[132:135], v[84:87]
    ds_read_b64_tr_b16 v[32:33], v16 offset:49152
    ds_read_b64_tr_b16 v[34:35], v16 offset:51200
    s_waitcnt lgkmcnt(4)
    v_mfma_f32_16x16x32_bf16 v[72:75], v[40:43], a[44:47], v[72:75]
    v_mfma_f32_16x16x32_bf16 v[88:91], v[40:43], a[132:135], v[88:91]
    ds_read_b64_tr_b16 v[36:37], v17 offset:49152
    ds_read_b64_tr_b16 v[38:39], v17 offset:51200
    s_waitcnt lgkmcnt(4)
    v_mfma_f32_16x16x32_bf16 v[76:79], v[44:47], a[44:47], v[76:79]
    v_mfma_f32_16x16x32_bf16 v[92:95], v[44:47], a[132:135], v[92:95]
    ds_read_b64_tr_b16 v[40:41], v18 offset:49152
    ds_read_b64_tr_b16 v[42:43], v18 offset:51200
    s_waitcnt lgkmcnt(4)
    v_mfma_f32_16x16x32_bf16 v[64:67], v[32:35], a[48:51], v[64:67]
    v_mfma_f32_16x16x32_bf16 v[80:83], v[32:35], a[136:139], v[80:83]
    ds_read_b64_tr_b16 v[44:45], v19 offset:49152
    ds_read_b64_tr_b16 v[46:47], v19 offset:51200
    s_waitcnt lgkmcnt(4)
    v_mfma_f32_16x16x32_bf16 v[68:71], v[36:39], a[48:51], v[68:71]
    v_mfma_f32_16x16x32_bf16 v[84:87], v[36:39], a[136:139], v[84:87]
    ds_read_b64_tr_b16 v[32:33], v16 offset:53248
    ds_read_b64_tr_b16 v[34:35], v16 offset:55296
    s_waitcnt lgkmcnt(4)
    v_mfma_f32_16x16x32_bf16 v[72:75], v[40:43], a[48:51], v[72:75]
    v_mfma_f32_16x16x32_bf16 v[88:91], v[40:43], a[136:139], v[88:91]
    ds_read_b64_tr_b16 v[36:37], v17 offset:53248
    ds_read_b64_tr_b16 v[38:39], v17 offset:55296
    s_waitcnt lgkmcnt(4)
    v_mfma_f32_16x16x32_bf16 v[76:79], v[44:47], a[48:51], v[76:79]
    v_mfma_f32_16x16x32_bf16 v[92:95], v[44:47], a[136:139], v[92:95]
    ds_read_b64_tr_b16 v[40:41], v18 offset:53248
    ds_read_b64_tr_b16 v[42:43], v18 offset:55296
    s_waitcnt lgkmcnt(4)
    v_mfma_f32_16x16x32_bf16 v[64:67], v[32:35], a[52:55], v[64:67]
    v_mfma_f32_16x16x32_bf16 v[80:83], v[32:35], a[140:143], v[80:83]
    ds_read_b64_tr_b16 v[44:45], v19 offset:53248
    ds_read_b64_tr_b16 v[46:47], v19 offset:55296
    s_waitcnt lgkmcnt(4)
    v_mfma_f32_16x16x32_bf16 v[68:71], v[36:39], a[52:55], v[68:71]
    v_mfma_f32_16x16x32_bf16 v[84:87], v[36:39], a[140:143], v[84:87]
    ds_read_b64_tr_b16 v[32:33], v16 offset:57344
    ds_read_b64_tr_b16 v[34:35], v16 offset:59392
    s_waitcnt lgkmcnt(4)
    v_mfma_f32_16x16x32_bf16 v[72:75], v[40:43], a[52:55], v[72:75]
    v_mfma_f32_16x16x32_bf16 v[88:91], v[40:43], a[140:143], v[88:91]
    ds_read_b64_tr_b16 v[36:37], v17 offset:57344
    ds_read_b64_tr_b16 v[38:39], v17 offset:59392
    s_waitcnt lgkmcnt(4)
    v_mfma_f32_16x16x32_bf16 v[76:79], v[44:47], a[52:55], v[76:79]
    v_mfma_f32_16x16x32_bf16 v[92:95], v[44:47], a[140:143], v[92:95]
    ds_read_b64_tr_b16 v[40:41], v18 offset:57344
    ds_read_b64_tr_b16 v[42:43], v18 offset:59392
    s_waitcnt lgkmcnt(4)
    v_mfma_f32_16x16x32_bf16 v[64:67], v[32:35], a[56:59], v[64:67]
    v_mfma_f32_16x16x32_bf16 v[80:83], v[32:35], a[144:147], v[80:83]
    ds_read_b64_tr_b16 v[44:45], v19 offset:57344
    ds_read_b64_tr_b16 v[46:47], v19 offset:59392
    s_waitcnt lgkmcnt(4)
    v_mfma_f32_16x16x32_bf16 v[68:71], v[36:39], a[56:59], v[68:71]
    v_mfma_f32_16x16x32_bf16 v[84:87], v[36:39], a[144:147], v[84:87]
    ds_read_b64_tr_b16 v[32:33], v16 offset:61440
    ds_read_b64_tr_b16 v[34:35], v16 offset:63488
    s_waitcnt lgkmcnt(4)
    v_mfma_f32_16x16x32_bf16 v[72:75], v[40:43], a[56:59], v[72:75]
    v_mfma_f32_16x16x32_bf16 v[88:91], v[40:43], a[144:147], v[88:91]
    ds_read_b64_tr_b16 v[36:37], v17 offset:61440
    ds_read_b64_tr_b16 v[38:39], v17 offset:63488
    s_waitcnt lgkmcnt(4)
    v_mfma_f32_16x16x32_bf16 v[76:79], v[44:47], a[56:59], v[76:79]
    v_mfma_f32_16x16x32_bf16 v[92:95], v[44:47], a[144:147], v[92:95]
    ds_read_b64_tr_b16 v[40:41], v18 offset:61440
    ds_read_b64_tr_b16 v[42:43], v18 offset:63488
    s_waitcnt lgkmcnt(4)
    v_mfma_f32_16x16x32_bf16 v[64:67], v[32:35], a[60:63], v[64:67]
    v_mfma_f32_16x16x32_bf16 v[80:83], v[32:35], a[148:151], v[80:83]
    ds_read_b64_tr_b16 v[44:45], v19 offset:61440
    ds_read_b64_tr_b16 v[46:47], v19 offset:63488
    s_waitcnt lgkmcnt(4)
    v_mfma_f32_16x16x32_bf16 v[68:71], v[36:39], a[60:63], v[68:71]
    v_mfma_f32_16x16x32_bf16 v[84:87], v[36:39], a[148:151], v[84:87]
    ds_read_b64_tr_b16 v[32:33], v20 offset:0
    ds_read_b64_tr_b16 v[34:35], v20 offset:2048
    s_waitcnt lgkmcnt(4)
    v_mfma_f32_16x16x32_bf16 v[72:75], v[40:43], a[60:63], v[72:75]
    v_mfma_f32_16x16x32_bf16 v[88:91], v[40:43], a[148:151], v[88:91]
    ds_read_b64_tr_b16 v[36:37], v21 offset:0
    ds_read_b64_tr_b16 v[38:39], v21 offset:2048
    s_waitcnt lgkmcnt(4)
    v_mfma_f32_16x16x32_bf16 v[76:79], v[44:47], a[60:63], v[76:79]
    v_mfma_f32_16x16x32_bf16 v[92:95], v[44:47], a[148:151], v[92:95]
    ds_read_b64_tr_b16 v[40:41], v22 offset:0
    ds_read_b64_tr_b16 v[42:43], v22 offset:2048
    s_waitcnt lgkmcnt(4)
    v_mfma_f32_16x16x32_bf16 v[64:67], v[32:35], a[64:67], v[64:67]
    v_mfma_f32_16x16x32_bf16 v[80:83], v[32:35], a[152:155], v[80:83]
    ds_read_b64_tr_b16 v[44:45], v23 offset:0
    ds_read_b64_tr_b16 v[46:47], v23 offset:2048
    s_waitcnt lgkmcnt(4)
    v_mfma_f32_16x16x32_bf16 v[68:71], v[36:39], a[64:67], v[68:71]
    v_mfma_f32_16x16x32_bf16 v[84:87], v[36:39], a[152:155], v[84:87]
    ds_read_b64_tr_b16 v[32:33], v20 offset:4096
    ds_read_b64_tr_b16 v[34:35], v20 offset:6144
    s_waitcnt lgkmcnt(4)
    v_mfma_f32_16x16x32_bf16 v[72:75], v[40:43], a[64:67], v[72:75]
    v_mfma_f32_16x16x32_bf16 v[88:91], v[40:43], a[152:155], v[88:91]
    ds_read_b64_tr_b16 v[36:37], v21 offset:4096
    ds_read_b64_tr_b16 v[38:39], v21 offset:6144
    s_waitcnt lgkmcnt(4)
    v_mfma_f32_16x16x32_bf16 v[76:79], v[44:47], a[64:67], v[76:79]
    v_mfma_f32_16x16x32_bf16 v[92:95], v[44:47], a[152:155], v[92:95]
    ds_read_b64_tr_b16 v[40:41], v22 offset:4096
    ds_read_b64_tr_b16 v[42:43], v22 offset:6144
    s_waitcnt lgkmcnt(4)
    v_mfma_f32_16x16x32_bf16 v[64:67], v[32:35], a[68:71], v[64:67]
    v_mfma_f32_16x16x32_bf16 v[80:83], v[32:35], a[156:159], v[80:83]
    ds_read_b64_tr_b16 v[44:45], v23 offset:4096
    ds_read_b64_tr_b16 v[46:47], v23 offset:6144
    s_waitcnt lgkmcnt(4)
    v_mfma_f32_16x16x32_bf16 v[68:71], v[36:39], a[68:71], v[68:71]
    v_mfma_f32_16x16x32_bf16 v[84:87], v[36:39], a[156:159], v[84:87]
    ds_read_b64_tr_b16 v[32:33], v20 offset:8192
    ds_read_b64_tr_b16 v[34:35], v20 offset:10240
    s_waitcnt lgkmcnt(4)
    v_mfma_f32_16x16x32_bf16 v[72:75], v[40:43], a[68:71], v[72:75]
    v_mfma_f32_16x16x32_bf16 v[88:91], v[40:43], a[156:159], v[88:91]
    ds_read_b64_tr_b16 v[36:37], v21 offset:8192
    ds_read_b64_tr_b16 v[38:39], v21 offset:10240
    s_waitcnt lgkmcnt(4)
    v_mfma_f32_16x16x32_bf16 v[76:79], v[44:47], a[68:71], v[76:79]
    v_mfma_f32_16x16x32_bf16 v[92:95], v[44:47], a[156:159], v[92:95]
    ds_read_b64_tr_b16 v[40:41], v22 offset:8192
    ds_read_b64_tr_b16 v[42:43], v22 offset:10240
    s_waitcnt lgkmcnt(4)
    v_mfma_f32_16x16x32_bf16 v[64:67], v[32:35], a[72:75], v[64:67]
    v_mfma_f32_16x16x32_bf16 v[80:83], v[32:35], a[160:163], v[80:83]
    ds_read_b64_tr_b16 v[44:45], v23 offset:8192
    ds_read_b64_tr_b16 v[46:47], v23 offset:10240
    s_waitcnt lgkmcnt(4)
    v_mfma_f32_16x16x32_bf16 v[68:71], v[36:39], a[72:75], v[68:71]
    v_mfma_f32_16x16x32_bf16 v[84:87], v[36:39], a[160:163], v[84:87]
    ds_read_b64_tr_b16 v[32:33], v20 offset:12288
    ds_read_b64_tr_b16 v[34:35], v20 offset:14336
    s_waitcnt lgkmcnt(4)
    v_mfma_f32_16x16x32_bf16 v[72:75], v[40:43], a[72:75], v[72:75]
    v_mfma_f32_16x16x32_bf16 v[88:91], v[40:43], a[160:163], v[88:91]
    ds_read_b64_tr_b16 v[36:37], v21 offset:12288
    ds_read_b64_tr_b16 v[38:39], v21 offset:14336
    s_waitcnt lgkmcnt(4)
    v_mfma_f32_16x16x32_bf16 v[76:79], v[44:47], a[72:75], v[76:79]
    v_mfma_f32_16x16x32_bf16 v[92:95], v[44:47], a[160:163], v[92:95]
    ds_read_b64_tr_b16 v[40:41], v22 offset:12288
    ds_read_b64_tr_b16 v[42:43], v22 offset:14336
    s_waitcnt lgkmcnt(4)
    v_mfma_f32_16x16x32_bf16 v[64:67], v[32:35], a[76:79], v[64:67]
    v_mfma_f32_16x16x32_bf16 v[80:83], v[32:35], a[164:167], v[80:83]
    ds_read_b64_tr_b16 v[44:45], v23 offset:12288
    ds_read_b64_tr_b16 v[46:47], v23 offset:14336
    s_waitcnt lgkmcnt(4)
    v_mfma_f32_16x16x32_bf16 v[68:71], v[36:39], a[76:79], v[68:71]
    v_mfma_f32_16x16x32_bf16 v[84:87], v[36:39], a[164:167], v[84:87]
    ds_read_b64_tr_b16 v[32:33], v20 offset:16384
    ds_read_b64_tr_b16 v[34:35], v20 offset:18432
    s_waitcnt lgkmcnt(4)
    v_mfma_f32_16x16x32_bf16 v[72:75], v[40:43], a[76:79], v[72:75]
    v_mfma_f32_16x16x32_bf16 v[88:91], v[40:43], a[164:167], v[88:91]
    ds_read_b64_tr_b16 v[36:37], v21 offset:16384
    ds_read_b64_tr_b16 v[38:39], v21 offset:18432
    s_waitcnt lgkmcnt(4)
    v_mfma_f32_16x16x32_bf16 v[76:79], v[44:47], a[76:79], v[76:79]
    v_mfma_f32_16x16x32_bf16 v[92:95], v[44:47], a[164:167], v[92:95]
    ds_read_b64_tr_b16 v[40:41], v22 offset:16384
    ds_read_b64_tr_b16 v[42:43], v22 offset:18432
    s_waitcnt lgkmcnt(4)
    v_mfma_f32_16x16x32_bf16 v[64:67], v[32:35], a[80:83], v[64:67]
    v_mfma_f32_16x16x32_bf16 v[80:83], v[32:35], a[168:171], v[80:83]
    ds_read_b64_tr_b16 v[44:45], v23 offset:16384
    ds_read_b64_tr_b16 v[46:47], v23 offset:18432
    s_waitcnt lgkmcnt(4)
    v_mfma_f32_16x16x32_bf16 v[68:71], v[36:39], a[80:83], v[68:71]
    v_mfma_f32_16x16x32_bf16 v[84:87], v[36:39], a[168:171], v[84:87]
    s_waitcnt lgkmcnt(2)
    v_mfma_f32_16x16x32_bf16 v[72:75], v[40:43], a[80:83], v[72:75]
    v_mfma_f32_16x16x32_bf16 v[88:91], v[40:43], a[168:171], v[88:91]
    s_waitcnt lgkmcnt(0)
    v_mfma_f32_16x16x32_bf16 v[76:79], v[44:47], a[80:83], v[76:79]
    v_mfma_f32_16x16x32_bf16 v[92:95], v[44:47], a[168:171], v[92:95]
DN_EPI:
    s_lshl_b32 s33, s38, 22
    s_lshl_b32 s34, s31, 16
    s_add_u32 s33, s33, s34
    s_lshl_b32 s34, s39, 12
    s_add_u32 s33, s33, s34
    s_add_u32 s33, s33, 0x5000000
    buffer_store_dwordx4 v[64:67], v9, s[4:7], s33 offen offset:0 sc1
    buffer_store_dwordx4 v[68:71], v9, s[4:7], s33 offen offset:1024 sc1
    buffer_store_dwordx4 v[72:75], v9, s[4:7], s33 offen offset:2048 sc1
    buffer_store_dwordx4 v[76:79], v9, s[4:7], s33 offen offset:3072 sc1
    s_add_u32 s33, s33, 0x8000
    buffer_store_dwordx4 v[80:83], v9, s[4:7], s33 offen offset:0 sc1
    buffer_store_dwordx4 v[84:87], v9, s[4:7], s33 offen offset:1024 sc1
    buffer_store_dwordx4 v[88:91], v9, s[4:7], s33 offen offset:2048 sc1
    buffer_store_dwordx4 v[92:95], v9, s[4:7], s33 offen offset:3072 sc1
    s_add_u32 s32, s32, 1
    s_waitcnt vmcnt(0)
    v_mov_b32 v3, s32
    s_mov_b64 exec, 1
    buffer_store_dword v3, v8, s[4:7], 0 offen sc1
    s_mov_b64 exec, -1
    s_add_u32 s31, s31, 4
    s_cmp_lt_u32 s31, 64
    s_cbranch_scc1 DN_LOOP
    s_endpgm
ROLE_OUT:
    s_and_b32 s23, s21, 31
    s_lshl_b32 s23, s23, 7
    s_add_u32 s23, s23, 0x9000
    v_mov_b32 v2, s23
    s_mov_b32 s25, 1
    s_mov_b32 s24, 32768
WF_46:
    buffer_load_dword v3, v2, s[4:7], 0 offen sc1
    s_waitcnt vmcnt(0)
    v_cmp_gt_u32 vcc, s25, v3
    s_sub_u32 s24, s24, 1
    s_cbranch_scc1 WFE_47
    s_nop 2
    s_cbranch_vccz WFE_47
    s_sleep 32
    s_branch WF_46
WFE_47:
    s_load_dwordx2 s[8:9], s[0:1], 40
    s_mov_b32 s10, 0x400000
    s_mov_b32 s11, 0x20000
    s_waitcnt lgkmcnt(0)
    s_lshr_b32 s38, s21, 3
    s_and_b32 s39, s21, 7
    s_lshl_b32 s30, s38, 20
    s_lshl_b32 s23, s39, 7
    s_add_u32 s30, s30, s23
    v_lshrrev_b32 v2, 3, v0
    v_bfe_u32 v3, v0, 4, 2
    v_bfe_u32 v4, v0, 1, 2
    v_xor_b32 v4, v4, v3
    v_lshlrev_b32 v4, 5, v4
    v_and_b32 v3, 1, v0
    v_lshl_add_u32 v4, v3, 4, v4
    s_mov_b32 s23, 1024
    v_mul_lo_u32 v2, v2, s23
    v_add_u32 v2, v2, v4
    s_mul_i32 s24, s20, 8192
    s_add_u32 s24, s24, s30
    s_lshl_b32 s25, s20, 10
    s_add_u32 s25, s25, 0
    s_mov_b32 s27, 32
DMA_48:
    s_mov_b32 m0, s25
    s_add_u32 s25, s25, 4096
    buffer_load_dwordx4 v2, s[8:11], s24 offen lds
    s_add_u32 s24, s24, 32768
    s_sub_u32 s27, s27, 1
    s_cmp_lg_u32 s27, 0
    s_cbranch_scc1 DMA_48
    v_bfe_u32 v2, v0, 2, 2
    v_lshrrev_b32 v3, 4, v0
    v_lshl_add_u32 v4, v3, 2, v2
    v_lshlrev_b32 v5, 7, v4
    v_bfe_u32 v4, v4, 1, 2
    v_and_b32 v6, 3, v0
    v_lshl_add_u32 v5, v6, 3, v5
    v_xor_b32 v7, 0, v4
    v_lshl_add_u32 v16, v7, 5, v5
    v_add_u32 v20, 0x10000, v16
    v_xor_b32 v7, 1, v4
    v_lshl_add_u32 v17, v7, 5, v5
    v_add_u32 v21, 0x10000, v17
    v_xor_b32 v7, 2, v4
    v_lshl_add_u32 v18, v7, 5, v5
    v_add_u32 v22, 0x10000, v18
    v_xor_b32 v7, 3, v4
    v_lshl_add_u32 v19, v7, 5, v5
    v_add_u32 v23, 0x10000, v19
    s_lshl_b32 s24, s20, 2
    s_add_u32 s24, s24, 0x7000
    s_lshl_b32 s23, s21, 7
    s_add_u32 s24, s24, s23
    v_mov_b32 v8, s24
    v_lshlrev_b32 v9, 4, v0
    v_and_b32 v2, 7, v0
    s_lshl_b32 s23, s38, 3
    v_add_u32 v2, s23, v2
    s_lshl_b32 s24, s20, 2
    s_add_u32 s24, s24, 0x4000
    v_lshlrev_b32 v10, 7, v2
    v_add_u32 v10, s24, v10
    s_waitcnt vmcnt(0)
    s_barrier
    s_cmp_ge_u32 s20, 2
    s_cbranch_scc0 OUT_NOCLR
    v_mov_b32 v64, -1
    v_mov_b32 v65, -1
    v_mov_b32 v66, -1
    v_mov_b32 v67, -1
    v_mov_b32 v68, -1
    v_mov_b32 v69, -1
    v_mov_b32 v70, -1
    v_mov_b32 v71, -1
    v_mov_b32 v72, -1
    v_mov_b32 v73, -1
    v_mov_b32 v74, -1
    v_mov_b32 v75, -1
    v_mov_b32 v76, -1
    v_mov_b32 v77, -1
    v_mov_b32 v78, -1
    v_mov_b32 v79, -1
    v_mov_b32 v80, -1
    v_mov_b32 v81, -1
    v_mov_b32 v82, -1
    v_mov_b32 v83, -1
    v_mov_b32 v84, -1
    v_mov_b32 v85, -1
    v_mov_b32 v86, -1
    v_mov_b32 v87, -1
    v_mov_b32 v88, -1
    v_mov_b32 v89, -1
    v_mov_b32 v90, -1
    v_mov_b32 v91, -1
    v_mov_b32 v92, -1
    v_mov_b32 v93, -1
    v_mov_b32 v94, -1
    v_mov_b32 v95, -1
    s_add_u32 s31, s20, 60
    s_lshl_b32 s33, s38, 22
    s_lshl_b32 s34, s31, 16
    s_add_u32 s33, s33, s34
    s_lshl_b32 s34, s39, 12
    s_add_u32 s33, s33, s34
    s_add_u32 s33, s33, 0x5000000
    buffer_store_dwordx4 v[64:67], v9, s[4:7], s33 offen offset:0 sc1
    buffer_store_dwordx4 v[68:71], v9, s[4:7], s33 offen offset:1024 sc1
    buffer_store_dwordx4 v[72:75], v9, s[4:7], s33 offen offset:2048 sc1
    buffer_store_dwordx4 v[76:79], v9, s[4:7], s33 offen offset:3072 sc1
    s_add_u32 s33, s33, 0x8000
    buffer_store_dwordx4 v[80:83], v9, s[4:7], s33 offen offset:0 sc1
    buffer_store_dwordx4 v[84:87], v9, s[4:7], s33 offen offset:1024 sc1
    buffer_store_dwordx4 v[88:91], v9, s[4:7], s33 offen offset:2048 sc1
    buffer_store_dwordx4 v[92:95], v9, s[4:7], s33 offen offset:3072 sc1
OUT_NOCLR:
    s_mov_b32 s31, s20
    s_mov_b32 s32, 0
OUT_LOOP:
    s_add_u32 s34, s32, 1
    s_mov_b32 s24, 32768
WF_49:
    buffer_load_dword v3, v10, s[4:7], 0 offen sc1
    s_waitcnt vmcnt(0)
    v_cmp_gt_u32 vcc, s34, v3
    s_sub_u32 s24, s24, 1
    s_cbranch_scc1 WFE_50
    s_nop 2
    s_cbranch_vccz WFE_50
    s_sleep 1
    s_branch WF_49
WFE_50:
    s_lshl_b32 s33, s31, 18
    s_lshl_b32 s34, s38, 15
    s_add_u32 s33, s33, s34
    s_add_u32 s33, s33, 0x3000000
    s_add_u32 s35, s33, 0x20000
    buffer_load_dwordx4 a[0:3], v9, s[4:7], s33 offen offset:0
    buffer_load_dwordx4 a[128:131], v9, s[4:7], s35 offen offset:0
    buffer_load_dwordx4 a[4:7], v9, s[4:7], s33 offen offset:1024
    buffer_load_dwordx4 a[132:135], v9, s[4:7], s35 offen offset:1024
    buffer_load_dwordx4 a[8:11], v9, s[4:7], s33 offen offset:2048
    buffer_load_dwordx4 a[136:139], v9, s[4:7], s35 offen offset:2048
    buffer_load_dwordx4 a[12:15], v9, s[4:7], s33 offen offset:3072
    buffer_load_dwordx4 a[140:143], v9, s[4:7], s35 offen offset:3072
    s_add_u32 s33, s33, 4096
    s_add_u32 s35, s35, 4096
    buffer_load_dwordx4 a[16:19], v9, s[4:7], s33 offen offset:0
    buffer_load_dwordx4 a[144:147], v9, s[4:7], s35 offen offset:0
    buffer_load_dwordx4 a[20:23], v9, s[4:7], s33 offen offset:1024
    buffer_load_dwordx4 a[148:151], v9, s[4:7], s35 offen offset:1024
    buffer_load_dwordx4 a[24:27], v9, s[4:7], s33 offen offset:2048
    buffer_load_dwordx4 a[152:155], v9, s[4:7], s35 offen offset:2048
    buffer_load_dwordx4 a[28:31], v9, s[4:7], s33 offen offset:3072
    buffer_load_dwordx4 a[156:159], v9, s[4:7], s35 offen offset:3072
    s_add_u32 s33, s33, 4096
    s_add_u32 s35, s35, 4096
    buffer_load_dwordx4 a[32:35], v9, s[4:7], s33 offen offset:0
    buffer_load_dwordx4 a[160:163], v9, s[4:7], s35 offen offset:0
    buffer_load_dwordx4 a[36:39], v9, s[4:7], s33 offen offset:1024
    buffer_load_dwordx4 a[164:167], v9, s[4:7], s35 offen offset:1024
    buffer_load_dwordx4 a[40:43], v9, s[4:7], s33 offen offset:2048
    buffer_load_dwordx4 a[168:171], v9, s[4:7], s35 offen offset:2048
    buffer_load_dwordx4 a[44:47], v9, s[4:7], s33 offen offset:3072
    buffer_load_dwordx4 a[172:175], v9, s[4:7], s35 offen offset:3072
    s_add_u32 s33, s33, 4096
    s_add_u32 s35, s35, 4096
    buffer_load_dwordx4 a[48:51], v9, s[4:7], s33 offen offset:0
    buffer_load_dwordx4 a[176:179], v9, s[4:7], s35 offen offset:0
    buffer_load_dwordx4 a[52:55], v9, s[4:7], s33 offen offset:1024
    buffer_load_dwordx4 a[180:183], v9, s[4:7], s35 offen offset:1024
    buffer_load_dwordx4 a[56:59], v9, s[4:7], s33 offen offset:2048
    buffer_load_dwordx4 a[184:187], v9, s[4:7], s35 offen offset:2048
    buffer_load_dwordx4 a[60:63], v9, s[4:7], s33 offen offset:3072
    buffer_load_dwordx4 a[188:191], v9, s[4:7], s35 offen offset:3072
    ds_read_b64_tr_b16 v[32:33], v16 offset:0
    ds_read_b64_tr_b16 v[34:35], v16 offset:2048
    ds_read_b64_tr_b16 v[36:37], v17 offset:0
    ds_read_b64_tr_b16 v[38:39], v17 offset:2048
    ds_read_b64_tr_b16 v[40:41], v18 offset:0
    ds_read_b64_tr_b16 v[42:43], v18 offset:2048
    s_waitcnt vmcnt(30)
    s_add_u32 s33, s33, 4096
    s_add_u32 s35, s35, 4096
    buffer_load_dwordx4 a[64:67], v9, s[4:7], s33 offen offset:0
    buffer_load_dwordx4 a[192:195], v9, s[4:7], s35 offen offset:0
    buffer_load_dwordx4 a[68:71], v9, s[4:7], s33 offen offset:1024
    buffer_load_dwordx4 a[196:199], v9, s[4:7], s35 offen offset:1024
    buffer_load_dwordx4 a[72:75], v9, s[4:7], s33 offen offset:2048
    buffer_load_dwordx4 a[200:203], v9, s[4:7], s35 offen offset:2048
    buffer_load_dwordx4 a[76:79], v9, s[4:7], s33 offen offset:3072
    buffer_load_dwordx4 a[204:207], v9, s[4:7], s35 offen offset:3072
    s_add_u32 s33, s33, 4096
    s_add_u32 s35, s35, 4096
    buffer_load_dwordx4 a[80:83], v9, s[4:7], s33 offen offset:0
    buffer_load_dwordx4 a[208:211], v9, s[4:7], s35 offen offset:0
    buffer_load_dwordx4 a[84:87], v9, s[4:7], s33 offen offset:1024
    buffer_load_dwordx4 a[212:215], v9, s[4:7], s35 offen offset:1024
    buffer_load_dwordx4 a[88:91], v9, s[4:7], s33 offen offset:2048
    buffer_load_dwordx4 a[216:219], v9, s[4:7], s35 offen offset:2048
    buffer_load_dwordx4 a[92:95], v9, s[4:7], s33 offen offset:3072
    buffer_load_dwordx4 a[220:223], v9, s[4:7], s35 offen offset:3072
    s_add_u32 s33, s33, 4096
    s_add_u32 s35, s35, 4096
    buffer_load_dwordx4 a[96:99], v9, s[4:7], s33 offen offset:0
    buffer_load_dwordx4 a[224:227], v9, s[4:7], s35 offen offset:0
    buffer_load_dwordx4 a[100:103], v9, s[4:7], s33 offen offset:1024
    buffer_load_dwordx4 a[228:231], v9, s[4:7], s35 offen offset:1024
    buffer_load_dwordx4 a[104:107], v9, s[4:7], s33 offen offset:2048
    buffer_load_dwordx4 a[232:235], v9, s[4:7], s35 offen offset:2048
    buffer_load_dwordx4 a[108:111], v9, s[4:7], s33 offen offset:3072
    buffer_load_dwordx4 a[236:239], v9, s[4:7], s35 offen offset:3072
    s_add_u32 s33, s33, 4096
    s_add_u32 s35, s35, 4096
    buffer_load_dwordx4 a[112:115], v9, s[4:7], s33 offen offset:0
    buffer_load_dwordx4 a[240:243], v9, s[4:7], s35 offen offset:0
    buffer_load_dwordx4 a[116:119], v9, s[4:7], s33 offen offset:1024
    buffer_load_dwordx4 a[244:247], v9, s[4:7], s35 offen offset:1024
    buffer_load_dwordx4 a[120:123], v9, s[4:7], s33 offen offset:2048
    buffer_load_dwordx4 a[248:251], v9, s[4:7], s35 offen offset:2048
    buffer_load_dwordx4 a[124:127], v9, s[4:7], s33 offen offset:3072
    buffer_load_dwordx4 a[252:255], v9, s[4:7], s35 offen offset:3072
    s_waitcnt lgkmcnt(4)
    v_mfma_f32_16x16x32_bf16 v[64:67], v[32:35], a[0:3], 0
    v_mfma_f32_16x16x32_bf16 v[80:83], v[32:35], a[128:131], 0
    ds_read_b64_tr_b16 v[44:45], v19 offset:0
    ds_read_b64_tr_b16 v[46:47], v19 offset:2048
    s_waitcnt lgkmcnt(4)
    v_mfma_f32_16x16x32_bf16 v[68:71], v[36:39], a[0:3], 0
    v_mfma_f32_16x16x32_bf16 v[84:87], v[36:39], a[128:131], 0
    ds_read_b64_tr_b16 v[32:33], v16 offset:4096
    ds_read_b64_tr_b16 v[34:35], v16 offset:6144
    s_waitcnt lgkmcnt(4)
    v_mfma_f32_16x16x32_bf16 v[72:75], v[40:43], a[0:3], 0
    v_mfma_f32_16x16x32_bf16 v[88:91], v[40:43], a[128:131], 0
    ds_read_b64_tr_b16 v[36:37], v17 offset:4096
    ds_read_b64_tr_b16 v[38:39], v17 offset:6144
    s_waitcnt lgkmcnt(4)
    v_mfma_f32_16x16x32_bf16 v[76:79], v[44:47], a[0:3], 0
    v_mfma_f32_16x16x32_bf16 v[92:95], v[44:47], a[128:131], 0
    ds_read_b64_tr_b16 v[40:41], v18 offset:4096
    ds_read_b64_tr_b16 v[42:43], v18 offset:6144
    s_waitcnt vmcnt(60)
    s_waitcnt lgkmcnt(4)
    v_mfma_f32_16x16x32_bf16 v[64:67], v[32:35], a[4:7], v[64:67]
    v_mfma_f32_16x16x32_bf16 v[80:83], v[32:35], a[132:135], v[80:83]
    ds_read_b64_tr_b16 v[44:45], v19 offset:4096
    ds_read_b64_tr_b16 v[46:47], v19 offset:6144
    s_waitcnt lgkmcnt(4)
    v_mfma_f32_16x16x32_bf16 v[68:71], v[36:39], a[4:7], v[68:71]
    v_mfma_f32_16x16x32_bf16 v[84:87], v[36:39], a[132:135], v[84:87]
    ds_read_b64_tr_b16 v[32:33], v16 offset:8192
    ds_read_b64_tr_b16 v[34:35], v16 offset:10240
    s_waitcnt lgkmcnt(4)
    v_mfma_f32_16x16x32_bf16 v[72:75], v[40:43], a[4:7], v[72:75]
    v_mfma_f32_16x16x32_bf16 v[88:91], v[40:43], a[132:135], v[88:91]
    ds_read_b64_tr_b16 v[36:37], v17 offset:8192
    ds_read_b64_tr_b16 v[38:39], v17 offset:10240
    s_waitcnt lgkmcnt(4)
    v_mfma_f32_16x16x32_bf16 v[76:79], v[44:47], a[4:7], v[76:79]
    v_mfma_f32_16x16x32_bf16 v[92:95], v[44:47], a[132:135], v[92:95]
    ds_read_b64_tr_b16 v[40:41], v18 offset:8192
    ds_read_b64_tr_b16 v[42:43], v18 offset:10240
    s_waitcnt vmcnt(58)
    s_waitcnt lgkmcnt(4)
    v_mfma_f32_16x16x32_bf16 v[64:67], v[32:35], a[8:11], v[64:67]
    v_mfma_f32_16x16x32_bf16 v[80:83], v[32:35], a[136:139], v[80:83]
    ds_read_b64_tr_b16 v[44:45], v19 offset:8192
    ds_read_b64_tr_b16 v[46:47], v19 offset:10240
    s_waitcnt lgkmcnt(4)
    v_mfma_f32_16x16x32_bf16 v[68:71], v[36:39], a[8:11], v[68:71]
    v_mfma_f32_16x16x32_bf16 v[84:87], v[36:39], a[136:139], v[84:87]
    ds_read_b64_tr_b16 v[32:33], v16 offset:12288
    ds_read_b64_tr_b16 v[34:35], v16 offset:14336
    s_waitcnt lgkmcnt(4)
    v_mfma_f32_16x16x32_bf16 v[72:75], v[40:43], a[8:11], v[72:75]
    v_mfma_f32_16x16x32_bf16 v[88:91], v[40:43], a[136:139], v[88:91]
    ds_read_b64_tr_b16 v[36:37], v17 offset:12288
    ds_read_b64_tr_b16 v[38:39], v17 offset:14336
    s_waitcnt lgkmcnt(4)
    v_mfma_f32_16x16x32_bf16 v[76:79], v[44:47], a[8:11], v[76:79]
    v_mfma_f32_16x16x32_bf16 v[92:95], v[44:47], a[136:139], v[92:95]
    ds_read_b64_tr_b16 v[40:41], v18 offset:12288
    ds_read_b64_tr_b16 v[42:43], v18 offset:14336
    s_waitcnt vmcnt(56)
    s_waitcnt lgkmcnt(4)
    v_mfma_f32_16x16x32_bf16 v[64:67], v[32:35], a[12:15], v[64:67]
    v_mfma_f32_16x16x32_bf16 v[80:83], v[32:35], a[140:143], v[80:83]
    ds_read_b64_tr_b16 v[44:45], v19 offset:12288
    ds_read_b64_tr_b16 v[46:47], v19 offset:14336
    s_waitcnt lgkmcnt(4)
    v_mfma_f32_16x16x32_bf16 v[68:71], v[36:39], a[12:15], v[68:71]
    v_mfma_f32_16x16x32_bf16 v[84:87], v[36:39], a[140:143], v[84:87]
    ds_read_b64_tr_b16 v[32:33], v16 offset:16384
    ds_read_b64_tr_b16 v[34:35], v16 offset:18432
    s_waitcnt lgkmcnt(4)
    v_mfma_f32_16x16x32_bf16 v[72:75], v[40:43], a[12:15], v[72:75]
    v_mfma_f32_16x16x32_bf16 v[88:91], v[40:43], a[140:143], v[88:91]
    ds_read_b64_tr_b16 v[36:37], v17 offset:16384
    ds_read_b64_tr_b16 v[38:39], v17 offset:18432
    s_waitcnt lgkmcnt(4)
    v_mfma_f32_16x16x32_bf16 v[76:79], v[44:47], a[12:15], v[76:79]
    v_mfma_f32_16x16x32_bf16 v[92:95], v[44:47], a[140:143], v[92:95]
    ds_read_b64_tr_b16 v[40:41], v18 offset:16384
    ds_read_b64_tr_b16 v[42:43], v18 offset:18432
    s_waitcnt vmcnt(54)
    s_waitcnt lgkmcnt(4)
    v_mfma_f32_16x16x32_bf16 v[64:67], v[32:35], a[16:19], v[64:67]
    v_mfma_f32_16x16x32_bf16 v[80:83], v[32:35], a[144:147], v[80:83]
    ds_read_b64_tr_b16 v[44:45], v19 offset:16384
    ds_read_b64_tr_b16 v[46:47], v19 offset:18432
    s_waitcnt lgkmcnt(4)
    v_mfma_f32_16x16x32_bf16 v[68:71], v[36:39], a[16:19], v[68:71]
    v_mfma_f32_16x16x32_bf16 v[84:87], v[36:39], a[144:147], v[84:87]
    ds_read_b64_tr_b16 v[32:33], v16 offset:20480
    ds_read_b64_tr_b16 v[34:35], v16 offset:22528
    s_waitcnt lgkmcnt(4)
    v_mfma_f32_16x16x32_bf16 v[72:75], v[40:43], a[16:19], v[72:75]
    v_mfma_f32_16x16x32_bf16 v[88:91], v[40:43], a[144:147], v[88:91]
    ds_read_b64_tr_b16 v[36:37], v17 offset:20480
    ds_read_b64_tr_b16 v[38:39], v17 offset:22528
    s_waitcnt lgkmcnt(4)
    v_mfma_f32_16x16x32_bf16 v[76:79], v[44:47], a[16:19], v[76:79]
    v_mfma_f32_16x16x32_bf16 v[92:95], v[44:47], a[144:147], v[92:95]
    ds_read_b64_tr_b16 v[40:41], v18 offset:20480
    ds_read_b64_tr_b16 v[42:43], v18 offset:22528
    s_waitcnt vmcnt(52)
    s_waitcnt lgkmcnt(4)
    v_mfma_f32_16x16x32_bf16 v[64:67], v[32:35], a[20:23], v[64:67]
    v_mfma_f32_16x16x32_bf16 v[80:83], v[32:35], a[148:151], v[80:83]
    ds_read_b64_tr_b16 v[44:45], v19 offset:20480
    ds_read_b64_tr_b16 v[46:47], v19 offset:22528
    s_waitcnt lgkmcnt(4)
    v_mfma_f32_16x16x32_bf16 v[68:71], v[36:39], a[20:23], v[68:71]
    v_mfma_f32_16x16x32_bf16 v[84:87], v[36:39], a[148:151], v[84:87]
    ds_read_b64_tr_b16 v[32:33], v16 offset:24576
    ds_read_b64_tr_b16 v[34:35], v16 offset:26624
    s_waitcnt lgkmcnt(4)
    v_mfma_f32_16x16x32_bf16 v[72:75], v[40:43], a[20:23], v[72:75]
    v_mfma_f32_16x16x32_bf16 v[88:91], v[40:43], a[148:151], v[88:91]
    ds_read_b64_tr_b16 v[36:37], v17 offset:24576
    ds_read_b64_tr_b16 v[38:39], v17 offset:26624
    s_waitcnt lgkmcnt(4)
    v_mfma_f32_16x16x32_bf16 v[76:79], v[44:47], a[20:23], v[76:79]
    v_mfma_f32_16x16x32_bf16 v[92:95], v[44:47], a[148:151], v[92:95]
    ds_read_b64_tr_b16 v[40:41], v18 offset:24576
    ds_read_b64_tr_b16 v[42:43], v18 offset:26624
    s_waitcnt vmcnt(50)
    s_waitcnt lgkmcnt(4)
    v_mfma_f32_16x16x32_bf16 v[64:67], v[32:35], a[24:27], v[64:67]
    v_mfma_f32_16x16x32_bf16 v[80:83], v[32:35], a[152:155], v[80:83]
    ds_read_b64_tr_b16 v[44:45], v19 offset:24576
    ds_read_b64_tr_b16 v[46:47], v19 offset:26624
    s_waitcnt lgkmcnt(4)
    v_mfma_f32_16x16x32_bf16 v[68:71], v[36:39], a[24:27], v[68:71]
    v_mfma_f32_16x16x32_bf16 v[84:87], v[36:39], a[152:155], v[84:87]
    ds_read_b64_tr_b16 v[32:33], v16 offset:28672
    ds_read_b64_tr_b16 v[34:35], v16 offset:30720
    s_waitcnt lgkmcnt(4)
    v_mfma_f32_16x16x32_bf16 v[72:75], v[40:43], a[24:27], v[72:75]
    v_mfma_f32_16x16x32_bf16 v[88:91], v[40:43], a[152:155], v[88:91]
    ds_read_b64_tr_b16 v[36:37], v17 offset:28672
    ds_read_b64_tr_b16 v[38:39], v17 offset:30720
    s_waitcnt lgkmcnt(4)
    v_mfma_f32_16x16x32_bf16 v[76:79], v[44:47], a[24:27], v[76:79]
    v_mfma_f32_16x16x32_bf16 v[92:95], v[44:47], a[152:155], v[92:95]
    ds_read_b64_tr_b16 v[40:41], v18 offset:28672
    ds_read_b64_tr_b16 v[42:43], v18 offset:30720
    s_waitcnt vmcnt(48)
    s_waitcnt lgkmcnt(4)
    v_mfma_f32_16x16x32_bf16 v[64:67], v[32:35], a[28:31], v[64:67]
    v_mfma_f32_16x16x32_bf16 v[80:83], v[32:35], a[156:159], v[80:83]
    ds_read_b64_tr_b16 v[44:45], v19 offset:28672
    ds_read_b64_tr_b16 v[46:47], v19 offset:30720
    s_waitcnt lgkmcnt(4)
    v_mfma_f32_16x16x32_bf16 v[68:71], v[36:39], a[28:31], v[68:71]
    v_mfma_f32_16x16x32_bf16 v[84:87], v[36:39], a[156:159], v[84:87]
    ds_read_b64_tr_b16 v[32:33], v16 offset:32768
    ds_read_b64_tr_b16 v[34:35], v16 offset:34816
    s_waitcnt lgkmcnt(4)
    v_mfma_f32_16x16x32_bf16 v[72:75], v[40:43], a[28:31], v[72:75]
    v_mfma_f32_16x16x32_bf16 v[88:91], v[40:43], a[156:159], v[88:91]
    ds_read_b64_tr_b16 v[36:37], v17 offset:32768
    ds_read_b64_tr_b16 v[38:39], v17 offset:34816
    s_waitcnt lgkmcnt(4)
    v_mfma_f32_16x16x32_bf16 v[76:79], v[44:47], a[28:31], v[76:79]
    v_mfma_f32_16x16x32_bf16 v[92:95], v[44:47], a[156:159], v[92:95]
    ds_read_b64_tr_b16 v[40:41], v18 offset:32768
    ds_read_b64_tr_b16 v[42:43], v18 offset:34816
    s_waitcnt vmcnt(46)
    s_waitcnt lgkmcnt(4)
    v_mfma_f32_16x16x32_bf16 v[64:67], v[32:35], a[32:35], v[64:67]
    v_mfma_f32_16x16x32_bf16 v[80:83], v[32:35], a[160:163], v[80:83]
    ds_read_b64_tr_b16 v[44:45], v19 offset:32768
    ds_read_b64_tr_b16 v[46:47], v19 offset:34816
    s_waitcnt lgkmcnt(4)
    v_mfma_f32_16x16x32_bf16 v[68:71], v[36:39], a[32:35], v[68:71]
    v_mfma_f32_16x16x32_bf16 v[84:87], v[36:39], a[160:163], v[84:87]
    ds_read_b64_tr_b16 v[32:33], v16 offset:36864
    ds_read_b64_tr_b16 v[34:35], v16 offset:38912
    s_waitcnt lgkmcnt(4)
    v_mfma_f32_16x16x32_bf16 v[72:75], v[40:43], a[32:35], v[72:75]
    v_mfma_f32_16x16x32_bf16 v[88:91], v[40:43], a[160:163], v[88:91]
    ds_read_b64_tr_b16 v[36:37], v17 offset:36864
    ds_read_b64_tr_b16 v[38:39], v17 offset:38912
    s_waitcnt lgkmcnt(4)
    v_mfma_f32_16x16x32_bf16 v[76:79], v[44:47], a[32:35], v[76:79]
    v_mfma_f32_16x16x32_bf16 v[92:95], v[44:47], a[160:163], v[92:95]
    ds_read_b64_tr_b16 v[40:41], v18 offset:36864
    ds_read_b64_tr_b16 v[42:43], v18 offset:38912
    s_waitcnt vmcnt(44)
    s_waitcnt lgkmcnt(4)
    v_mfma_f32_16x16x32_bf16 v[64:67], v[32:35], a[36:39], v[64:67]
    v_mfma_f32_16x16x32_bf16 v[80:83], v[32:35], a[164:167], v[80:83]
    ds_read_b64_tr_b16 v[44:45], v19 offset:36864
    ds_read_b64_tr_b16 v[46:47], v19 offset:38912
    s_waitcnt lgkmcnt(4)
    v_mfma_f32_16x16x32_bf16 v[68:71], v[36:39], a[36:39], v[68:71]
    v_mfma_f32_16x16x32_bf16 v[84:87], v[36:39], a[164:167], v[84:87]
    ds_read_b64_tr_b16 v[32:33], v16 offset:40960
    ds_read_b64_tr_b16 v[34:35], v16 offset:43008
    s_waitcnt lgkmcnt(4)
    v_mfma_f32_16x16x32_bf16 v[72:75], v[40:43], a[36:39], v[72:75]
    v_mfma_f32_16x16x32_bf16 v[88:91], v[40:43], a[164:167], v[88:91]
    ds_read_b64_tr_b16 v[36:37], v17 offset:40960
    ds_read_b64_tr_b16 v[38:39], v17 offset:43008
    s_waitcnt lgkmcnt(4)
    v_mfma_f32_16x16x32_bf16 v[76:79], v[44:47], a[36:39], v[76:79]
    v_mfma_f32_16x16x32_bf16 v[92:95], v[44:47], a[164:167], v[92:95]
    ds_read_b64_tr_b16 v[40:41], v18 offset:40960
    ds_read_b64_tr_b16 v[42:43], v18 offset:43008
    s_waitcnt vmcnt(42)
    s_waitcnt lgkmcnt(4)
    v_mfma_f32_16x16x32_bf16 v[64:67], v[32:35], a[40:43], v[64:67]
    v_mfma_f32_16x16x32_bf16 v[80:83], v[32:35], a[168:171], v[80:83]
    ds_read_b64_tr_b16 v[44:45], v19 offset:40960
    ds_read_b64_tr_b16 v[46:47], v19 offset:43008
    s_waitcnt lgkmcnt(4)
    v_mfma_f32_16x16x32_bf16 v[68:71], v[36:39], a[40:43], v[68:71]
    v_mfma_f32_16x16x32_bf16 v[84:87], v[36:39], a[168:171], v[84:87]
    ds_read_b64_tr_b16 v[32:33], v16 offset:45056
    ds_read_b64_tr_b16 v[34:35], v16 offset:47104
    s_waitcnt lgkmcnt(4)
    v_mfma_f32_16x16x32_bf16 v[72:75], v[40:43], a[40:43], v[72:75]
    v_mfma_f32_16x16x32_bf16 v[88:91], v[40:43], a[168:171], v[88:91]
    ds_read_b64_tr_b16 v[36:37], v17 offset:45056
    ds_read_b64_tr_b16 v[38:39], v17 offset:47104
    s_waitcnt lgkmcnt(4)
    v_mfma_f32_16x16x32_bf16 v[76:79], v[44:47], a[40:43], v[76:79]
    v_mfma_f32_16x16x32_bf16 v[92:95], v[44:47], a[168:171], v[92:95]
    ds_read_b64_tr_b16 v[40:41], v18 offset:45056
    ds_read_b64_tr_b16 v[42:43], v18 offset:47104
    s_waitcnt vmcnt(40)
    s_waitcnt lgkmcnt(4)
    v_mfma_f32_16x16x32_bf16 v[64:67], v[32:35], a[44:47], v[64:67]
    v_mfma_f32_16x16x32_bf16 v[80:83], v[32:35], a[172:175], v[80:83]
    ds_read_b64_tr_b16 v[44:45], v19 offset:45056
    ds_read_b64_tr_b16 v[46:47], v19 offset:47104
    s_waitcnt lgkmcnt(4)
    v_mfma_f32_16x16x32_bf16 v[68:71], v[36:39], a[44:47], v[68:71]
    v_mfma_f32_16x16x32_bf16 v[84:87], v[36:39], a[172:175], v[84:87]
    ds_read_b64_tr_b16 v[32:33], v16 offset:49152
    ds_read_b64_tr_b16 v[34:35], v16 offset:51200
    s_waitcnt lgkmcnt(4)
    v_mfma_f32_16x16x32_bf16 v[72:75], v[40:43], a[44:47], v[72:75]
    v_mfma_f32_16x16x32_bf16 v[88:91], v[40:43], a[172:175], v[88:91]
    ds_read_b64_tr_b16 v[36:37], v17 offset:49152
    ds_read_b64_tr_b16 v[38:39], v17 offset:51200
    s_waitcnt lgkmcnt(4)
    v_mfma_f32_16x16x32_bf16 v[76:79], v[44:47], a[44:47], v[76:79]
    v_mfma_f32_16x16x32_bf16 v[92:95], v[44:47], a[172:175], v[92:95]
    ds_read_b64_tr_b16 v[40:41], v18 offset:49152
    ds_read_b64_tr_b16 v[42:43], v18 offset:51200
    s_waitcnt vmcnt(38)
    s_waitcnt lgkmcnt(4)
    v_mfma_f32_16x16x32_bf16 v[64:67], v[32:35], a[48:51], v[64:67]
    v_mfma_f32_16x16x32_bf16 v[80:83], v[32:35], a[176:179], v[80:83]
    ds_read_b64_tr_b16 v[44:45], v19 offset:49152
    ds_read_b64_tr_b16 v[46:47], v19 offset:51200
    s_waitcnt lgkmcnt(4)
    v_mfma_f32_16x16x32_bf16 v[68:71], v[36:39], a[48:51], v[68:71]
    v_mfma_f32_16x16x32_bf16 v[84:87], v[36:39], a[176:179], v[84:87]
    ds_read_b64_tr_b16 v[32:33], v16 offset:53248
    ds_read_b64_tr_b16 v[34:35], v16 offset:55296
    s_waitcnt lgkmcnt(4)
    v_mfma_f32_16x16x32_bf16 v[72:75], v[40:43], a[48:51], v[72:75]
    v_mfma_f32_16x16x32_bf16 v[88:91], v[40:43], a[176:179], v[88:91]
    ds_read_b64_tr_b16 v[36:37], v17 offset:53248
    ds_read_b64_tr_b16 v[38:39], v17 offset:55296
    s_waitcnt lgkmcnt(4)
    v_mfma_f32_16x16x32_bf16 v[76:79], v[44:47], a[48:51], v[76:79]
    v_mfma_f32_16x16x32_bf16 v[92:95], v[44:47], a[176:179], v[92:95]
    ds_read_b64_tr_b16 v[40:41], v18 offset:53248
    ds_read_b64_tr_b16 v[42:43], v18 offset:55296
    s_waitcnt vmcnt(36)
    s_waitcnt lgkmcnt(4)
    v_mfma_f32_16x16x32_bf16 v[64:67], v[32:35], a[52:55], v[64:67]
    v_mfma_f32_16x16x32_bf16 v[80:83], v[32:35], a[180:183], v[80:83]
    ds_read_b64_tr_b16 v[44:45], v19 offset:53248
    ds_read_b64_tr_b16 v[46:47], v19 offset:55296
    s_waitcnt lgkmcnt(4)
    v_mfma_f32_16x16x32_bf16 v[68:71], v[36:39], a[52:55], v[68:71]
    v_mfma_f32_16x16x32_bf16 v[84:87], v[36:39], a[180:183], v[84:87]
    ds_read_b64_tr_b16 v[32:33], v16 offset:57344
    ds_read_b64_tr_b16 v[34:35], v16 offset:59392
    s_waitcnt lgkmcnt(4)
    v_mfma_f32_16x16x32_bf16 v[72:75], v[40:43], a[52:55], v[72:75]
    v_mfma_f32_16x16x32_bf16 v[88:91], v[40:43], a[180:183], v[88:91]
    ds_read_b64_tr_b16 v[36:37], v17 offset:57344
    ds_read_b64_tr_b16 v[38:39], v17 offset:59392
    s_waitcnt lgkmcnt(4)
    v_mfma_f32_16x16x32_bf16 v[76:79], v[44:47], a[52:55], v[76:79]
    v_mfma_f32_16x16x32_bf16 v[92:95], v[44:47], a[180:183], v[92:95]
    ds_read_b64_tr_b16 v[40:41], v18 offset:57344
    ds_read_b64_tr_b16 v[42:43], v18 offset:59392
    s_waitcnt vmcnt(34)
    s_waitcnt lgkmcnt(4)
    v_mfma_f32_16x16x32_bf16 v[64:67], v[32:35], a[56:59], v[64:67]
    v_mfma_f32_16x16x32_bf16 v[80:83], v[32:35], a[184:187], v[80:83]
    ds_read_b64_tr_b16 v[44:45], v19 offset:57344
    ds_read_b64_tr_b16 v[46:47], v19 offset:59392
    s_waitcnt lgkmcnt(4)
    v_mfma_f32_16x16x32_bf16 v[68:71], v[36:39], a[56:59], v[68:71]
    v_mfma_f32_16x16x32_bf16 v[84:87], v[36:39], a[184:187], v[84:87]
    ds_read_b64_tr_b16 v[32:33], v16 offset:61440
    ds_read_b64_tr_b16 v[34:35], v16 offset:63488
    s_waitcnt lgkmcnt(4)
    v_mfma_f32_16x16x32_bf16 v[72:75], v[40:43], a[56:59], v[72:75]
    v_mfma_f32_16x16x32_bf16 v[88:91], v[40:43], a[184:187], v[88:91]
    ds_read_b64_tr_b16 v[36:37], v17 offset:61440
    ds_read_b64_tr_b16 v[38:39], v17 offset:63488
    s_waitcnt lgkmcnt(4)
    v_mfma_f32_16x16x32_bf16 v[76:79], v[44:47], a[56:59], v[76:79]
    v_mfma_f32_16x16x32_bf16 v[92:95], v[44:47], a[184:187], v[92:95]
    ds_read_b64_tr_b16 v[40:41], v18 offset:61440
    ds_read_b64_tr_b16 v[42:43], v18 offset:63488
    s_waitcnt vmcnt(32)
    s_waitcnt lgkmcnt(4)
    v_mfma_f32_16x16x32_bf16 v[64:67], v[32:35], a[60:63], v[64:67]
    v_mfma_f32_16x16x32_bf16 v[80:83], v[32:35], a[188:191], v[80:83]
    ds_read_b64_tr_b16 v[44:45], v19 offset:61440
    ds_read_b64_tr_b16 v[46:47], v19 offset:63488
    s_waitcnt lgkmcnt(4)
    v_mfma_f32_16x16x32_bf16 v[68:71], v[36:39], a[60:63], v[68:71]
    v_mfma_f32_16x16x32_bf16 v[84:87], v[36:39], a[188:191], v[84:87]
    ds_read_b64_tr_b16 v[32:33], v20 offset:0
    ds_read_b64_tr_b16 v[34:35], v20 offset:2048
    s_waitcnt lgkmcnt(4)
    v_mfma_f32_16x16x32_bf16 v[72:75], v[40:43], a[60:63], v[72:75]
    v_mfma_f32_16x16x32_bf16 v[88:91], v[40:43], a[188:191], v[88:91]
    ds_read_b64_tr_b16 v[36:37], v21 offset:0
    ds_read_b64_tr_b16 v[38:39], v21 offset:2048
    s_waitcnt lgkmcnt(4)
    v_mfma_f32_16x16x32_bf16 v[76:79], v[44:47], a[60:63], v[76:79]
    v_mfma_f32_16x16x32_bf16 v[92:95], v[44:47], a[188:191], v[92:95]
    ds_read_b64_tr_b16 v[40:41], v22 offset:0
    ds_read_b64_tr_b16 v[42:43], v22 offset:2048
    s_waitcnt vmcnt(30)
    s_waitcnt lgkmcnt(4)
    v_mfma_f32_16x16x32_bf16 v[64:67], v[32:35], a[64:67], v[64:67]
    v_mfma_f32_16x16x32_bf16 v[80:83], v[32:35], a[192:195], v[80:83]
    ds_read_b64_tr_b16 v[44:45], v23 offset:0
    ds_read_b64_tr_b16 v[46:47], v23 offset:2048
    s_waitcnt lgkmcnt(4)
    v_mfma_f32_16x16x32_bf16 v[68:71], v[36:39], a[64:67], v[68:71]
    v_mfma_f32_16x16x32_bf16 v[84:87], v[36:39], a[192:195], v[84:87]
    ds_read_b64_tr_b16 v[32:33], v20 offset:4096
    ds_read_b64_tr_b16 v[34:35], v20 offset:6144
    s_waitcnt lgkmcnt(4)
    v_mfma_f32_16x16x32_bf16 v[72:75], v[40:43], a[64:67], v[72:75]
    v_mfma_f32_16x16x32_bf16 v[88:91], v[40:43], a[192:195], v[88:91]
    ds_read_b64_tr_b16 v[36:37], v21 offset:4096
    ds_read_b64_tr_b16 v[38:39], v21 offset:6144
    s_waitcnt lgkmcnt(4)
    v_mfma_f32_16x16x32_bf16 v[76:79], v[44:47], a[64:67], v[76:79]
    v_mfma_f32_16x16x32_bf16 v[92:95], v[44:47], a[192:195], v[92:95]
    ds_read_b64_tr_b16 v[40:41], v22 offset:4096
    ds_read_b64_tr_b16 v[42:43], v22 offset:6144
    s_waitcnt vmcnt(28)
    s_waitcnt lgkmcnt(4)
    v_mfma_f32_16x16x32_bf16 v[64:67], v[32:35], a[68:71], v[64:67]
    v_mfma_f32_16x16x32_bf16 v[80:83], v[32:35], a[196:199], v[80:83]
    ds_read_b64_tr_b16 v[44:45], v23 offset:4096
    ds_read_b64_tr_b16 v[46:47], v23 offset:6144
    s_waitcnt lgkmcnt(4)
    v_mfma_f32_16x16x32_bf16 v[68:71], v[36:39], a[68:71], v[68:71]
    v_mfma_f32_16x16x32_bf16 v[84:87], v[36:39], a[196:199], v[84:87]
    ds_read_b64_tr_b16 v[32:33], v20 offset:8192
    ds_read_b64_tr_b16 v[34:35], v20 offset:10240
    s_waitcnt lgkmcnt(4)
    v_mfma_f32_16x16x32_bf16 v[72:75], v[40:43], a[68:71], v[72:75]
    v_mfma_f32_16x16x32_bf16 v[88:91], v[40:43], a[196:199], v[88:91]
    ds_read_b64_tr_b16 v[36:37], v21 offset:8192
    ds_read_b64_tr_b16 v[38:39], v21 offset:10240
    s_waitcnt lgkmcnt(4)
    v_mfma_f32_16x16x32_bf16 v[76:79], v[44:47], a[68:71], v[76:79]
    v_mfma_f32_16x16x32_bf16 v[92:95], v[44:47], a[196:199], v[92:95]
    ds_read_b64_tr_b16 v[40:41], v22 offset:8192
    ds_read_b64_tr_b16 v[42:43], v22 offset:10240
    s_waitcnt vmcnt(26)
    s_waitcnt lgkmcnt(4)
    v_mfma_f32_16x16x32_bf16 v[64:67], v[32:35], a[72:75], v[64:67]
    v_mfma_f32_16x16x32_bf16 v[80:83], v[32:35], a[200:203], v[80:83]
    ds_read_b64_tr_b16 v[44:45], v23 offset:8192
    ds_read_b64_tr_b16 v[46:47], v23 offset:10240
    s_waitcnt lgkmcnt(4)
    v_mfma_f32_16x16x32_bf16 v[68:71], v[36:39], a[72:75], v[68:71]
    v_mfma_f32_16x16x32_bf16 v[84:87], v[36:39], a[200:203], v[84:87]
    ds_read_b64_tr_b16 v[32:33], v20 offset:12288
    ds_read_b64_tr_b16 v[34:35], v20 offset:14336
    s_waitcnt lgkmcnt(4)
    v_mfma_f32_16x16x32_bf16 v[72:75], v[40:43], a[72:75], v[72:75]
    v_mfma_f32_16x16x32_bf16 v[88:91], v[40:43], a[200:203], v[88:91]
    ds_read_b64_tr_b16 v[36:37], v21 offset:12288
    ds_read_b64_tr_b16 v[38:39], v21 offset:14336
    s_waitcnt lgkmcnt(4)
    v_mfma_f32_16x16x32_bf16 v[76:79], v[44:47], a[72:75], v[76:79]
    v_mfma_f32_16x16x32_bf16 v[92:95], v[44:47], a[200:203], v[92:95]
    ds_read_b64_tr_b16 v[40:41], v22 offset:12288
    ds_read_b64_tr_b16 v[42:43], v22 offset:14336
    s_waitcnt vmcnt(24)
    s_waitcnt lgkmcnt(4)
    v_mfma_f32_16x16x32_bf16 v[64:67], v[32:35], a[76:79], v[64:67]
    v_mfma_f32_16x16x32_bf16 v[80:83], v[32:35], a[204:207], v[80:83]
    ds_read_b64_tr_b16 v[44:45], v23 offset:12288
    ds_read_b64_tr_b16 v[46:47], v23 offset:14336
    s_waitcnt lgkmcnt(4)
    v_mfma_f32_16x16x32_bf16 v[68:71], v[36:39], a[76:79], v[68:71]
    v_mfma_f32_16x16x32_bf16 v[84:87], v[36:39], a[204:207], v[84:87]
    ds_read_b64_tr_b16 v[32:33], v20 offset:16384
    ds_read_b64_tr_b16 v[34:35], v20 offset:18432
    s_waitcnt lgkmcnt(4)
    v_mfma_f32_16x16x32_bf16 v[72:75], v[40:43], a[76:79], v[72:75]
    v_mfma_f32_16x16x32_bf16 v[88:91], v[40:43], a[204:207], v[88:91]
    ds_read_b64_tr_b16 v[36:37], v21 offset:16384
    ds_read_b64_tr_b16 v[38:39], v21 offset:18432
    s_waitcnt lgkmcnt(4)
    v_mfma_f32_16x16x32_bf16 v[76:79], v[44:47], a[76:79], v[76:79]
    v_mfma_f32_16x16x32_bf16 v[92:95], v[44:47], a[204:207], v[92:95]
    ds_read_b64_tr_b16 v[40:41], v22 offset:16384
    ds_read_b64_tr_b16 v[42:43], v22 offset:18432
    s_waitcnt vmcnt(22)
    s_waitcnt lgkmcnt(4)
    v_mfma_f32_16x16x32_bf16 v[64:67], v[32:35], a[80:83], v[64:67]
    v_mfma_f32_16x16x32_bf16 v[80:83], v[32:35], a[208:211], v[80:83]
    ds_read_b64_tr_b16 v[44:45], v23 offset:16384
    ds_read_b64_tr_b16 v[46:47], v23 offset:18432
    s_waitcnt lgkmcnt(4)
    v_mfma_f32_16x16x32_bf16 v[68:71], v[36:39], a[80:83], v[68:71]
    v_mfma_f32_16x16x32_bf16 v[84:87], v[36:39], a[208:211], v[84:87]
    ds_read_b64_tr_b16 v[32:33], v20 offset:20480
    ds_read_b64_tr_b16 v[34:35], v20 offset:22528
    s_waitcnt lgkmcnt(4)
    v_mfma_f32_16x16x32_bf16 v[72:75], v[40:43], a[80:83], v[72:75]
    v_mfma_f32_16x16x32_bf16 v[88:91], v[40:43], a[208:211], v[88:91]
    ds_read_b64_tr_b16 v[36:37], v21 offset:20480
    ds_read_b64_tr_b16 v[38:39], v21 offset:22528
    s_waitcnt lgkmcnt(4)
    v_mfma_f32_16x16x32_bf16 v[76:79], v[44:47], a[80:83], v[76:79]
    v_mfma_f32_16x16x32_bf16 v[92:95], v[44:47], a[208:211], v[92:95]
    ds_read_b64_tr_b16 v[40:41], v22 offset:20480
    ds_read_b64_tr_b16 v[42:43], v22 offset:22528
    s_waitcnt vmcnt(20)
    s_waitcnt lgkmcnt(4)
    v_mfma_f32_16x16x32_bf16 v[64:67], v[32:35], a[84:87], v[64:67]
    v_mfma_f32_16x16x32_bf16 v[80:83], v[32:35], a[212:215], v[80:83]
    ds_read_b64_tr_b16 v[44:45], v23 offset:20480
    ds_read_b64_tr_b16 v[46:47], v23 offset:22528
    s_waitcnt lgkmcnt(4)
    v_mfma_f32_16x16x32_bf16 v[68:71], v[36:39], a[84:87], v[68:71]
    v_mfma_f32_16x16x32_bf16 v[84:87], v[36:39], a[212:215], v[84:87]
    ds_read_b64_tr_b16 v[32:33], v20 offset:24576
    ds_read_b64_tr_b16 v[34:35], v20 offset:26624
    s_waitcnt lgkmcnt(4)
    v_mfma_f32_16x16x32_bf16 v[72:75], v[40:43], a[84:87], v[72:75]
    v_mfma_f32_16x16x32_bf16 v[88:91], v[40:43], a[212:215], v[88:91]
    ds_read_b64_tr_b16 v[36:37], v21 offset:24576
    ds_read_b64_tr_b16 v[38:39], v21 offset:26624
    s_waitcnt lgkmcnt(4)
    v_mfma_f32_16x16x32_bf16 v[76:79], v[44:47], a[84:87], v[76:79]
    v_mfma_f32_16x16x32_bf16 v[92:95], v[44:47], a[212:215], v[92:95]
    ds_read_b64_tr_b16 v[40:41], v22 offset:24576
    ds_read_b64_tr_b16 v[42:43], v22 offset:26624
    s_waitcnt vmcnt(18)
    s_waitcnt lgkmcnt(4)
    v_mfma_f32_16x16x32_bf16 v[64:67], v[32:35], a[88:91], v[64:67]
    v_mfma_f32_16x16x32_bf16 v[80:83], v[32:35], a[216:219], v[80:83]
    ds_read_b64_tr_b16 v[44:45], v23 offset:24576
    ds_read_b64_tr_b16 v[46:47], v23 offset:26624
    s_waitcnt lgkmcnt(4)
    v_mfma_f32_16x16x32_bf16 v[68:71], v[36:39], a[88:91], v[68:71]
    v_mfma_f32_16x16x32_bf16 v[84:87], v[36:39], a[216:219], v[84:87]
    ds_read_b64_tr_b16 v[32:33], v20 offset:28672
    ds_read_b64_tr_b16 v[34:35], v20 offset:30720
    s_waitcnt lgkmcnt(4)
    v_mfma_f32_16x16x32_bf16 v[72:75], v[40:43], a[88:91], v[72:75]
    v_mfma_f32_16x16x32_bf16 v[88:91], v[40:43], a[216:219], v[88:91]
    ds_read_b64_tr_b16 v[36:37], v21 offset:28672
    ds_read_b64_tr_b16 v[38:39], v21 offset:30720
    s_waitcnt lgkmcnt(4)
    v_mfma_f32_16x16x32_bf16 v[76:79], v[44:47], a[88:91], v[76:79]
    v_mfma_f32_16x16x32_bf16 v[92:95], v[44:47], a[216:219], v[92:95]
    ds_read_b64_tr_b16 v[40:41], v22 offset:28672
    ds_read_b64_tr_b16 v[42:43], v22 offset:30720
    s_waitcnt vmcnt(16)
    s_waitcnt lgkmcnt(4)
    v_mfma_f32_16x16x32_bf16 v[64:67], v[32:35], a[92:95], v[64:67]
    v_mfma_f32_16x16x32_bf16 v[80:83], v[32:35], a[220:223], v[80:83]
    ds_read_b64_tr_b16 v[44:45], v23 offset:28672
    ds_read_b64_tr_b16 v[46:47], v23 offset:30720
    s_waitcnt lgkmcnt(4)
    v_mfma_f32_16x16x32_bf16 v[68:71], v[36:39], a[92:95], v[68:71]
    v_mfma_f32_16x16x32_bf16 v[84:87], v[36:39], a[220:223], v[84:87]
    ds_read_b64_tr_b16 v[32:33], v20 offset:32768
    ds_read_b64_tr_b16 v[34:35], v20 offset:34816
    s_waitcnt lgkmcnt(4)
    v_mfma_f32_16x16x32_bf16 v[72:75], v[40:43], a[92:95], v[72:75]
    v_mfma_f32_16x16x32_bf16 v[88:91], v[40:43], a[220:223], v[88:91]
    ds_read_b64_tr_b16 v[36:37], v21 offset:32768
    ds_read_b64_tr_b16 v[38:39], v21 offset:34816
    s_waitcnt lgkmcnt(4)
    v_mfma_f32_16x16x32_bf16 v[76:79], v[44:47], a[92:95], v[76:79]
    v_mfma_f32_16x16x32_bf16 v[92:95], v[44:47], a[220:223], v[92:95]
    ds_read_b64_tr_b16 v[40:41], v22 offset:32768
    ds_read_b64_tr_b16 v[42:43], v22 offset:34816
    s_waitcnt vmcnt(14)
    s_waitcnt lgkmcnt(4)
    v_mfma_f32_16x16x32_bf16 v[64:67], v[32:35], a[96:99], v[64:67]
    v_mfma_f32_16x16x32_bf16 v[80:83], v[32:35], a[224:227], v[80:83]
    ds_read_b64_tr_b16 v[44:45], v23 offset:32768
    ds_read_b64_tr_b16 v[46:47], v23 offset:34816
    s_waitcnt lgkmcnt(4)
    v_mfma_f32_16x16x32_bf16 v[68:71], v[36:39], a[96:99], v[68:71]
    v_mfma_f32_16x16x32_bf16 v[84:87], v[36:39], a[224:227], v[84:87]
    ds_read_b64_tr_b16 v[32:33], v20 offset:36864
    ds_read_b64_tr_b16 v[34:35], v20 offset:38912
    s_waitcnt lgkmcnt(4)
    v_mfma_f32_16x16x32_bf16 v[72:75], v[40:43], a[96:99], v[72:75]
    v_mfma_f32_16x16x32_bf16 v[88:91], v[40:43], a[224:227], v[88:91]
    ds_read_b64_tr_b16 v[36:37], v21 offset:36864
    ds_read_b64_tr_b16 v[38:39], v21 offset:38912
    s_waitcnt lgkmcnt(4)
    v_mfma_f32_16x16x32_bf16 v[76:79], v[44:47], a[96:99], v[76:79]
    v_mfma_f32_16x16x32_bf16 v[92:95], v[44:47], a[224:227], v[92:95]
    ds_read_b64_tr_b16 v[40:41], v22 offset:36864
    ds_read_b64_tr_b16 v[42:43], v22 offset:38912
    s_waitcnt vmcnt(12)
    s_waitcnt lgkmcnt(4)
    v_mfma_f32_16x16x32_bf16 v[64:67], v[32:35], a[100:103], v[64:67]
    v_mfma_f32_16x16x32_bf16 v[80:83], v[32:35], a[228:231], v[80:83]
    ds_read_b64_tr_b16 v[44:45], v23 offset:36864
    ds_read_b64_tr_b16 v[46:47], v23 offset:38912
    s_waitcnt lgkmcnt(4)
    v_mfma_f32_16x16x32_bf16 v[68:71], v[36:39], a[100:103], v[68:71]
    v_mfma_f32_16x16x32_bf16 v[84:87], v[36:39], a[228:231], v[84:87]
    ds_read_b64_tr_b16 v[32:33], v20 offset:40960
    ds_read_b64_tr_b16 v[34:35], v20 offset:43008
    s_waitcnt lgkmcnt(4)
    v_mfma_f32_16x16x32_bf16 v[72:75], v[40:43], a[100:103], v[72:75]
    v_mfma_f32_16x16x32_bf16 v[88:91], v[40:43], a[228:231], v[88:91]
    ds_read_b64_tr_b16 v[36:37], v21 offset:40960
    ds_read_b64_tr_b16 v[38:39], v21 offset:43008
    s_waitcnt lgkmcnt(4)
    v_mfma_f32_16x16x32_bf16 v[76:79], v[44:47], a[100:103], v[76:79]
    v_mfma_f32_16x16x32_bf16 v[92:95], v[44:47], a[228:231], v[92:95]
    ds_read_b64_tr_b16 v[40:41], v22 offset:40960
    ds_read_b64_tr_b16 v[42:43], v22 offset:43008
    s_waitcnt vmcnt(10)
    s_waitcnt lgkmcnt(4)
    v_mfma_f32_16x16x32_bf16 v[64:67], v[32:35], a[104:107], v[64:67]
    v_mfma_f32_16x16x32_bf16 v[80:83], v[32:35], a[232:235], v[80:83]
    ds_read_b64_tr_b16 v[44:45], v23 offset:40960
    ds_read_b64_tr_b16 v[46:47], v23 offset:43008
    s_waitcnt lgkmcnt(4)
    v_mfma_f32_16x16x32_bf16 v[68:71], v[36:39], a[104:107], v[68:71]
    v_mfma_f32_16x16x32_bf16 v[84:87], v[36:39], a[232:235], v[84:87]
    ds_read_b64_tr_b16 v[32:33], v20 offset:45056
    ds_read_b64_tr_b16 v[34:35], v20 offset:47104
    s_waitcnt lgkmcnt(4)
    v_mfma_f32_16x16x32_bf16 v[72:75], v[40:43], a[104:107], v[72:75]
    v_mfma_f32_16x16x32_bf16 v[88:91], v[40:43], a[232:235], v[88:91]
    ds_read_b64_tr_b16 v[36:37], v21 offset:45056
    ds_read_b64_tr_b16 v[38:39], v21 offset:47104
    s_waitcnt lgkmcnt(4)
    v_mfma_f32_16x16x32_bf16 v[76:79], v[44:47], a[104:107], v[76:79]
    v_mfma_f32_16x16x32_bf16 v[92:95], v[44:47], a[232:235], v[92:95]
    ds_read_b64_tr_b16 v[40:41], v22 offset:45056
    ds_read_b64_tr_b16 v[42:43], v22 offset:47104
    s_waitcnt vmcnt(8)
    s_waitcnt lgkmcnt(4)
    v_mfma_f32_16x16x32_bf16 v[64:67], v[32:35], a[108:111], v[64:67]
    v_mfma_f32_16x16x32_bf16 v[80:83], v[32:35], a[236:239], v[80:83]
    ds_read_b64_tr_b16 v[44:45], v23 offset:45056
    ds_read_b64_tr_b16 v[46:47], v23 offset:47104
    s_waitcnt lgkmcnt(4)
    v_mfma_f32_16x16x32_bf16 v[68:71], v[36:39], a[108:111], v[68:71]
    v_mfma_f32_16x16x32_bf16 v[84:87], v[36:39], a[236:239], v[84:87]
    ds_read_b64_tr_b16 v[32:33], v20 offset:49152
    ds_read_b64_tr_b16 v[34:35], v20 offset:51200
    s_waitcnt lgkmcnt(4)
    v_mfma_f32_16x16x32_bf16 v[72:75], v[40:43], a[108:111], v[72:75]
    v_mfma_f32_16x16x32_bf16 v[88:91], v[40:43], a[236:239], v[88:91]
    ds_read_b64_tr_b16 v[36:37], v21 offset:49152
    ds_read_b64_tr_b16 v[38:39], v21 offset:51200
    s_waitcnt lgkmcnt(4)
    v_mfma_f32_16x16x32_bf16 v[76:79], v[44:47], a[108:111], v[76:79]
    v_mfma_f32_16x16x32_bf16 v[92:95], v[44:47], a[236:239], v[92:95]
    ds_read_b64_tr_b16 v[40:41], v22 offset:49152
    ds_read_b64_tr_b16 v[42:43], v22 offset:51200
    s_waitcnt vmcnt(6)
    s_waitcnt lgkmcnt(4)
    v_mfma_f32_16x16x32_bf16 v[64:67], v[32:35], a[112:115], v[64:67]
    v_mfma_f32_16x16x32_bf16 v[80:83], v[32:35], a[240:243], v[80:83]
    ds_read_b64_tr_b16 v[44:45], v23 offset:49152
    ds_read_b64_tr_b16 v[46:47], v23 offset:51200
    s_waitcnt lgkmcnt(4)
    v_mfma_f32_16x16x32_bf16 v[68:71], v[36:39], a[112:115], v[68:71]
    v_mfma_f32_16x16x32_bf16 v[84:87], v[36:39], a[240:243], v[84:87]
    ds_read_b64_tr_b16 v[32:33], v20 offset:53248
    ds_read_b64_tr_b16 v[34:35], v20 offset:55296
    s_waitcnt lgkmcnt(4)
    v_mfma_f32_16x16x32_bf16 v[72:75], v[40:43], a[112:115], v[72:75]
    v_mfma_f32_16x16x32_bf16 v[88:91], v[40:43], a[240:243], v[88:91]
    ds_read_b64_tr_b16 v[36:37], v21 offset:53248
    ds_read_b64_tr_b16 v[38:39], v21 offset:55296
    s_waitcnt lgkmcnt(4)
    v_mfma_f32_16x16x32_bf16 v[76:79], v[44:47], a[112:115], v[76:79]
    v_mfma_f32_16x16x32_bf16 v[92:95], v[44:47], a[240:243], v[92:95]
    ds_read_b64_tr_b16 v[40:41], v22 offset:53248
    ds_read_b64_tr_b16 v[42:43], v22 offset:55296
    s_waitcnt vmcnt(4)
    s_waitcnt lgkmcnt(4)
    v_mfma_f32_16x16x32_bf16 v[64:67], v[32:35], a[116:119], v[64:67]
    v_mfma_f32_16x16x32_bf16 v[80:83], v[32:35], a[244:247], v[80:83]
    ds_read_b64_tr_b16 v[44:45], v23 offset:53248
    ds_read_b64_tr_b16 v[46:47], v23 offset:55296
    s_waitcnt lgkmcnt(4)
    v_mfma_f32_16x16x32_bf16 v[68:71], v[36:39], a[116:119], v[68:71]
    v_mfma_f32_16x16x32_bf16 v[84:87], v[36:39], a[244:247], v[84:87]
    ds_read_b64_tr_b16 v[32:33], v20 offset:57344
    ds_read_b64_tr_b16 v[34:35], v20 offset:59392
    s_waitcnt lgkmcnt(4)
    v_mfma_f32_16x16x32_bf16 v[72:75], v[40:43], a[116:119], v[72:75]
    v_mfma_f32_16x16x32_bf16 v[88:91], v[40:43], a[244:247], v[88:91]
    ds_read_b64_tr_b16 v[36:37], v21 offset:57344
    ds_read_b64_tr_b16 v[38:39], v21 offset:59392
    s_waitcnt lgkmcnt(4)
    v_mfma_f32_16x16x32_bf16 v[76:79], v[44:47], a[116:119], v[76:79]
    v_mfma_f32_16x16x32_bf16 v[92:95], v[44:47], a[244:247], v[92:95]
    ds_read_b64_tr_b16 v[40:41], v22 offset:57344
    ds_read_b64_tr_b16 v[42:43], v22 offset:59392
    s_waitcnt vmcnt(2)
    s_waitcnt lgkmcnt(4)
    v_mfma_f32_16x16x32_bf16 v[64:67], v[32:35], a[120:123], v[64:67]
    v_mfma_f32_16x16x32_bf16 v[80:83], v[32:35], a[248:251], v[80:83]
    ds_read_b64_tr_b16 v[44:45], v23 offset:57344
    ds_read_b64_tr_b16 v[46:47], v23 offset:59392
    s_waitcnt lgkmcnt(4)
    v_mfma_f32_16x16x32_bf16 v[68:71], v[36:39], a[120:123], v[68:71]
    v_mfma_f32_16x16x32_bf16 v[84:87], v[36:39], a[248:251], v[84:87]
    ds_read_b64_tr_b16 v[32:33], v20 offset:61440
    ds_read_b64_tr_b16 v[34:35], v20 offset:63488
    s_waitcnt lgkmcnt(4)
    v_mfma_f32_16x16x32_bf16 v[72:75], v[40:43], a[120:123], v[72:75]
    v_mfma_f32_16x16x32_bf16 v[88:91], v[40:43], a[248:251], v[88:91]
    ds_read_b64_tr_b16 v[36:37], v21 offset:61440
    ds_read_b64_tr_b16 v[38:39], v21 offset:63488
    s_waitcnt lgkmcnt(4)
    v_mfma_f32_16x16x32_bf16 v[76:79], v[44:47], a[120:123], v[76:79]
    v_mfma_f32_16x16x32_bf16 v[92:95], v[44:47], a[248:251], v[92:95]
    ds_read_b64_tr_b16 v[40:41], v22 offset:61440
    ds_read_b64_tr_b16 v[42:43], v22 offset:63488
    s_waitcnt vmcnt(0)
    s_waitcnt lgkmcnt(4)
    v_mfma_f32_16x16x32_bf16 v[64:67], v[32:35], a[124:127], v[64:67]
    v_mfma_f32_16x16x32_bf16 v[80:83], v[32:35], a[252:255], v[80:83]
    ds_read_b64_tr_b16 v[44:45], v23 offset:61440
    ds_read_b64_tr_b16 v[46:47], v23 offset:63488
    s_waitcnt lgkmcnt(4)
    v_mfma_f32_16x16x32_bf16 v[68:71], v[36:39], a[124:127], v[68:71]
    v_mfma_f32_16x16x32_bf16 v[84:87], v[36:39], a[252:255], v[84:87]
    s_waitcnt lgkmcnt(2)
    v_mfma_f32_16x16x32_bf16 v[72:75], v[40:43], a[124:127], v[72:75]
    v_mfma_f32_16x16x32_bf16 v[88:91], v[40:43], a[252:255], v[88:91]
    s_waitcnt lgkmcnt(0)
    v_mfma_f32_16x16x32_bf16 v[76:79], v[44:47], a[124:127], v[76:79]
    v_mfma_f32_16x16x32_bf16 v[92:95], v[44:47], a[252:255], v[92:95]
    s_lshl_b32 s33, s38, 22
    s_lshl_b32 s34, s31, 16
    s_add_u32 s33, s33, s34
    s_lshl_b32 s34, s39, 12
    s_add_u32 s33, s33, s34
    s_add_u32 s33, s33, 0x5000000
    buffer_store_dwordx4 v[64:67], v9, s[4:7], s33 offen offset:0 sc1
    buffer_store_dwordx4 v[68:71], v9, s[4:7], s33 offen offset:1024 sc1
    buffer_store_dwordx4 v[72:75], v9, s[4:7], s33 offen offset:2048 sc1
    buffer_store_dwordx4 v[76:79], v9, s[4:7], s33 offen offset:3072 sc1
    s_add_u32 s33, s33, 0x8000
    buffer_store_dwordx4 v[80:83], v9, s[4:7], s33 offen offset:0 sc1
    buffer_store_dwordx4 v[84:87], v9, s[4:7], s33 offen offset:1024 sc1
    buffer_store_dwordx4 v[88:91], v9, s[4:7], s33 offen offset:2048 sc1
    buffer_store_dwordx4 v[92:95], v9, s[4:7], s33 offen offset:3072 sc1
    s_add_u32 s32, s32, 1
    s_waitcnt vmcnt(0)
    v_mov_b32 v3, s32
    s_mov_b64 exec, 1
    buffer_store_dword v3, v8, s[4:7], 0 offen sc1
    s_mov_b64 exec, -1
    s_add_u32 s31, s31, 4
    s_cmp_lt_u32 s31, 62
    s_cbranch_scc1 OUT_LOOP
    s_endpgm
ROLE_FIN:
    s_load_dwordx2 s[8:9], s[0:1], 0
    s_mov_b32 s10, 0x200000
    s_mov_b32 s11, 0x20000
    s_load_dwordx2 s[12:13], s[0:1], 88
    s_mov_b32 s14, 0x200000
    s_mov_b32 s15, 0x20000
    s_waitcnt lgkmcnt(0)
    s_lshr_b32 s38, s21, 3
    s_and_b32 s39, s21, 7
    v_lshlrev_b32 v9, 4, v0
    v_and_b32 v2, 7, v0
    v_min_u32 v2, 5, v2
    v_and_b32 v4, 3, v2
    v_lshlrev_b32 v4, 3, v4
    v_add_u32 v4, s39, v4
    v_lshlrev_b32 v4, 7, v4
    v_lshrrev_b32 v5, 2, v2
    s_mov_b32 s23, 0x1000
    v_mul_lo_u32 v5, v5, s23
    v_add_u32 v4, v4, v5
    s_lshl_b32 s23, s20, 2
    s_add_u32 s23, s23, 0x7000
    v_add_u32 v10, s23, v4
    v_and_b32 v2, 15, v0
    v_lshlrev_b32 v2, 10, v2
    v_lshrrev_b32 v3, 4, v0
    v_lshl_add_u32 v11, v3, 3, v2
    v_and_b32 v4, 1, v3
    v_lshl_add_u32 v12, v4, 5, v2
    v_lshrrev_b32 v4, 1, v3
    v_lshl_add_u32 v12, v4, 4, v12
    s_mov_b32 s31, s20
    s_mov_b32 s32, 0
FIN_LOOP:
    s_lshl_b32 s36, s31, 1
    s_add_u32 s36, s36, s38
    s_lshl_b32 s37, s36, 14
    s_lshl_b32 s23, s39, 7
    s_add_u32 s37, s37, s23
    buffer_load_dwordx2 v[16:17], v11, s[8:11], s37 offen offset:0
    buffer_load_dwordx2 v[18:19], v11, s[8:11], s37 offen offset:32
    buffer_load_dwordx2 v[20:21], v11, s[8:11], s37 offen offset:64
    buffer_load_dwordx2 v[22:23], v11, s[8:11], s37 offen offset:96
    s_add_u32 s34, s32, 1
    s_cmp_ge_u32 s31, 62
    s_cbranch_scc1 FIN_LAST
    s_mov_b32 s24, 32768
WF_51:
    buffer_load_dword v3, v10, s[4:7], 0 offen sc1
    s_waitcnt vmcnt(0)
    v_cmp_gt_u32 vcc, s34, v3
    s_sub_u32 s24, s24, 1
    s_cbranch_scc1 WFE_52
    s_nop 2
    s_cbranch_vccz WFE_52
    s_sleep 1
    s_branch WF_51
WFE_52:
    s_lshl_b32 s33, s36, 15
    s_lshl_b32 s23, s39, 12
    s_add_u32 s33, s33, s23
    s_add_u32 s33, s33, 0x5000000
    buffer_load_dwordx4 v[32:35], v9, s[4:7], s33 offen offset:0
    buffer_load_dwordx4 v[36:39], v9, s[4:7], s33 offen offset:1024
    buffer_load_dwordx4 v[40:43], v9, s[4:7], s33 offen offset:2048
    buffer_load_dwordx4 v[44:47], v9, s[4:7], s33 offen offset:3072
    s_add_u32 s33, s33, 0x400000
    buffer_load_dwordx4 v[48:51], v9, s[4:7], s33 offen offset:0
    buffer_load_dwordx4 v[52:55], v9, s[4:7], s33 offen offset:1024
    buffer_load_dwordx4 v[56:59], v9, s[4:7], s33 offen offset:2048
    buffer_load_dwordx4 v[60:63], v9, s[4:7], s33 offen offset:3072
    s_add_u32 s33, s33, 0x400000
    buffer_load_dwordx4 v[64:67], v9, s[4:7], s33 offen offset:0
    buffer_load_dwordx4 v[68:71], v9, s[4:7], s33 offen offset:1024
    buffer_load_dwordx4 v[72:75], v9, s[4:7], s33 offen offset:2048
    buffer_load_dwordx4 v[76:79], v9, s[4:7], s33 offen offset:3072
    s_add_u32 s33, s33, 0x400000
    buffer_load_dwordx4 v[80:83], v9, s[4:7], s33 offen offset:0
    buffer_load_dwordx4 v[84:87], v9, s[4:7], s33 offen offset:1024
    buffer_load_dwordx4 v[88:91], v9, s[4:7], s33 offen offset:2048
    buffer_load_dwordx4 v[92:95], v9, s[4:7], s33 offen offset:3072
    s_add_u32 s33, s33, 0x400000
    buffer_load_dwordx4 v[96:99], v9, s[4:7], s33 offen offset:0
    buffer_load_dwordx4 v[100:103], v9, s[4:7], s33 offen offset:1024
    buffer_load_dwordx4 v[104:107], v9, s[4:7], s33 offen offset:2048
    buffer_load_dwordx4 v[108:111], v9, s[4:7], s33 offen offset:3072
    s_add_u32 s33, s33, 0x400000
    buffer_load_dwordx4 v[112:115], v9, s[4:7], s33 offen offset:0
    buffer_load_dwordx4 v[116:119], v9, s[4:7], s33 offen offset:1024
    buffer_load_dwordx4 v[120:123], v9, s[4:7], s33 offen offset:2048
    buffer_load_dwordx4 v[124:127], v9, s[4:7], s33 offen offset:3072
FIN_GO:
    s_waitcnt vmcnt(16)
    v_pk_add_f32 v[32:33], v[32:33], v[48:49]
    v_pk_add_f32 v[34:35], v[34:35], v[50:51]
    v_pk_add_f32 v[36:37], v[36:37], v[52:53]
    v_pk_add_f32 v[38:39], v[38:39], v[54:55]
    v_pk_add_f32 v[40:41], v[40:41], v[56:57]
    v_pk_add_f32 v[42:43], v[42:43], v[58:59]
    v_pk_add_f32 v[44:45], v[44:45], v[60:61]
    v_pk_add_f32 v[46:47], v[46:47], v[62:63]
    s_waitcnt vmcnt(8)
    v_pk_add_f32 v[64:65], v[64:65], v[80:81]
    v_pk_add_f32 v[66:67], v[66:67], v[82:83]
    v_pk_add_f32 v[68:69], v[68:69], v[84:85]
    v_pk_add_f32 v[70:71], v[70:71], v[86:87]
    v_pk_add_f32 v[72:73], v[72:73], v[88:89]
    v_pk_add_f32 v[74:75], v[74:75], v[90:91]
    v_pk_add_f32 v[76:77], v[76:77], v[92:93]
    v_pk_add_f32 v[78:79], v[78:79], v[94:95]
    v_pk_add_f32 v[32:33], v[32:33], v[64:65]
    v_pk_add_f32 v[34:35], v[34:35], v[66:67]
    v_pk_add_f32 v[36:37], v[36:37], v[68:69]
    v_pk_add_f32 v[38:39], v[38:39], v[70:71]
    v_pk_add_f32 v[40:41], v[40:41], v[72:73]
    v_pk_add_f32 v[42:43], v[42:43], v[74:75]
    v_pk_add_f32 v[44:45], v[44:45], v[76:77]
    v_pk_add_f32 v[46:47], v[46:47], v[78:79]
    s_waitcnt vmcnt(0)
    v_pk_add_f32 v[96:97], v[96:97], v[112:113]
    v_pk_add_f32 v[98:99], v[98:99], v[114:115]
    v_pk_add_f32 v[100:101], v[100:101], v[116:117]
    v_pk_add_f32 v[102:103], v[102:103], v[118:119]
    v_pk_add_f32 v[104:105], v[104:105], v[120:121]
    v_pk_add_f32 v[106:107], v[106:107], v[122:123]
    v_pk_add_f32 v[108:109], v[108:109], v[124:125]
    v_pk_add_f32 v[110:111], v[110:111], v[126:127]
    v_cvt_pk_bf16_f32 v4, v32, v33
    v_cvt_pk_bf16_f32 v5, v96, v97
    v_lshlrev_b32 v32, 16, v4
    v_and_b32 v33, 0xffff0000, v4
    v_lshlrev_b32 v96, 16, v5
    v_and_b32 v97, 0xffff0000, v5
    v_lshlrev_b32 v6, 16, v16
    v_and_b32 v7, 0xffff0000, v16
    v_pk_add_f32 v[6:7], v[6:7], v[32:33]
    v_cvt_pk_bf16_f32 v4, v6, v7
    v_lshlrev_b32 v6, 16, v4
    v_and_b32 v7, 0xffff0000, v4
    v_pk_add_f32 v[6:7], v[6:7], v[96:97]
    v_cvt_pk_bf16_f32 v24, v6, v7
    v_cvt_pk_bf16_f32 v4, v34, v35
    v_cvt_pk_bf16_f32 v5, v98, v99
    v_lshlrev_b32 v34, 16, v4
    v_and_b32 v35, 0xffff0000, v4
    v_lshlrev_b32 v98, 16, v5
    v_and_b32 v99, 0xffff0000, v5
    v_lshlrev_b32 v6, 16, v17
    v_and_b32 v7, 0xffff0000, v17
    v_pk_add_f32 v[6:7], v[6:7], v[34:35]
    v_cvt_pk_bf16_f32 v4, v6, v7
    v_lshlrev_b32 v6, 16, v4
    v_and_b32 v7, 0xffff0000, v4
    v_pk_add_f32 v[6:7], v[6:7], v[98:99]
    v_cvt_pk_bf16_f32 v25, v6, v7
    v_cvt_pk_bf16_f32 v4, v36, v37
    v_cvt_pk_bf16_f32 v5, v100, v101
    v_lshlrev_b32 v36, 16, v4
    v_and_b32 v37, 0xffff0000, v4
    v_lshlrev_b32 v100, 16, v5
    v_and_b32 v101, 0xffff0000, v5
    v_lshlrev_b32 v6, 16, v18
    v_and_b32 v7, 0xffff0000, v18
    v_pk_add_f32 v[6:7], v[6:7], v[36:37]
    v_cvt_pk_bf16_f32 v4, v6, v7
    v_lshlrev_b32 v6, 16, v4
    v_and_b32 v7, 0xffff0000, v4
    v_pk_add_f32 v[6:7], v[6:7], v[100:101]
    v_cvt_pk_bf16_f32 v26, v6, v7
    v_cvt_pk_bf16_f32 v4, v38, v39
    v_cvt_pk_bf16_f32 v5, v102, v103
    v_lshlrev_b32 v38, 16, v4
    v_and_b32 v39, 0xffff0000, v4
    v_lshlrev_b32 v102, 16, v5
    v_and_b32 v103, 0xffff0000, v5
    v_lshlrev_b32 v6, 16, v19
    v_and_b32 v7, 0xffff0000, v19
    v_pk_add_f32 v[6:7], v[6:7], v[38:39]
    v_cvt_pk_bf16_f32 v4, v6, v7
    v_lshlrev_b32 v6, 16, v4
    v_and_b32 v7, 0xffff0000, v4
    v_pk_add_f32 v[6:7], v[6:7], v[102:103]
    v_cvt_pk_bf16_f32 v27, v6, v7
    v_cvt_pk_bf16_f32 v4, v40, v41
    v_cvt_pk_bf16_f32 v5, v104, v105
    v_lshlrev_b32 v40, 16, v4
    v_and_b32 v41, 0xffff0000, v4
    v_lshlrev_b32 v104, 16, v5
    v_and_b32 v105, 0xffff0000, v5
    v_lshlrev_b32 v6, 16, v20
    v_and_b32 v7, 0xffff0000, v20
    v_pk_add_f32 v[6:7], v[6:7], v[40:41]
    v_cvt_pk_bf16_f32 v4, v6, v7
    v_lshlrev_b32 v6, 16, v4
    v_and_b32 v7, 0xffff0000, v4
    v_pk_add_f32 v[6:7], v[6:7], v[104:105]
    v_cvt_pk_bf16_f32 v28, v6, v7
    v_cvt_pk_bf16_f32 v4, v42, v43
    v_cvt_pk_bf16_f32 v5, v106, v107
    v_lshlrev_b32 v42, 16, v4
    v_and_b32 v43, 0xffff0000, v4
    v_lshlrev_b32 v106, 16, v5
    v_and_b32 v107, 0xffff0000, v5
    v_lshlrev_b32 v6, 16, v21
    v_and_b32 v7, 0xffff0000, v21
    v_pk_add_f32 v[6:7], v[6:7], v[42:43]
    v_cvt_pk_bf16_f32 v4, v6, v7
    v_lshlrev_b32 v6, 16, v4
    v_and_b32 v7, 0xffff0000, v4
    v_pk_add_f32 v[6:7], v[6:7], v[106:107]
    v_cvt_pk_bf16_f32 v29, v6, v7
    v_cvt_pk_bf16_f32 v4, v44, v45
    v_cvt_pk_bf16_f32 v5, v108, v109
    v_lshlrev_b32 v44, 16, v4
    v_and_b32 v45, 0xffff0000, v4
    v_lshlrev_b32 v108, 16, v5
    v_and_b32 v109, 0xffff0000, v5
    v_lshlrev_b32 v6, 16, v22
    v_and_b32 v7, 0xffff0000, v22
    v_pk_add_f32 v[6:7], v[6:7], v[44:45]
    v_cvt_pk_bf16_f32 v4, v6, v7
    v_lshlrev_b32 v6, 16, v4
    v_and_b32 v7, 0xffff0000, v4
    v_pk_add_f32 v[6:7], v[6:7], v[108:109]
    v_cvt_pk_bf16_f32 v30, v6, v7
    v_cvt_pk_bf16_f32 v4, v46, v47
    v_cvt_pk_bf16_f32 v5, v110, v111
    v_lshlrev_b32 v46, 16, v4
    v_and_b32 v47, 0xffff0000, v4
    v_lshlrev_b32 v110, 16, v5
    v_and_b32 v111, 0xffff0000, v5
    v_lshlrev_b32 v6, 16, v23
    v_and_b32 v7, 0xffff0000, v23
    v_pk_add_f32 v[6:7], v[6:7], v[46:47]
    v_cvt_pk_bf16_f32 v4, v6, v7
    v_lshlrev_b32 v6, 16, v4
    v_and_b32 v7, 0xffff0000, v4
    v_pk_add_f32 v[6:7], v[6:7], v[110:111]
    v_cvt_pk_bf16_f32 v31, v6, v7
    v_permlane16_swap_b32 v24, v26
    v_permlane16_swap_b32 v25, v27
    v_permlane16_swap_b32 v28, v30
    v_permlane16_swap_b32 v29, v31
    buffer_store_dwordx4 v[24:27], v12, s[12:15], s37 offen offset:0
    buffer_store_dwordx4 v[28:31], v12, s[12:15], s37 offen offset:64
    s_add_u32 s32, s32, 1
    s_add_u32 s31, s31, 4
    s_cmp_lt_u32 s31, 64
    s_cbranch_scc1 FIN_LOOP
    s_waitcnt vmcnt(0)
    s_endpgm
FIN_LAST:
    v_and_b32 v2, 7, v0
    v_cmp_gt_u32 vcc, 4, v2
    s_nop 1
    v_cndmask_b32 v2, 0, 8, vcc
    v_sub_u32 v13, v10, v2
    s_mov_b32 s24, 32768
WF_53:
    buffer_load_dword v3, v13, s[4:7], 0 offen sc1
    s_waitcnt vmcnt(0)
    v_cmp_gt_u32 vcc, s34, v3
    s_sub_u32 s24, s24, 1
    s_cbranch_scc1 WFE_54
    s_nop 2
    s_cbranch_vccz WFE_54
    s_sleep 1
    s_branch WF_53
WFE_54:
    s_lshl_b32 s33, s36, 15
    s_lshl_b32 s23, s39, 12
    s_add_u32 s33, s33, s23
    s_add_u32 s33, s33, 0x6000000
    buffer_load_dwordx4 v[96:99], v9, s[4:7], s33 offen offset:0
    buffer_load_dwordx4 v[100:103], v9, s[4:7], s33 offen offset:1024
    buffer_load_dwordx4 v[104:107], v9, s[4:7], s33 offen offset:2048
    buffer_load_dwordx4 v[108:111], v9, s[4:7], s33 offen offset:3072
    s_add_u32 s33, s33, 0x400000
    buffer_load_dwordx4 v[112:115], v9, s[4:7], s33 offen offset:0
    buffer_load_dwordx4 v[116:119], v9, s[4:7], s33 offen offset:1024
    buffer_load_dwordx4 v[120:123], v9, s[4:7], s33 offen offset:2048
    buffer_load_dwordx4 v[124:127], v9, s[4:7], s33 offen offset:3072
    s_mov_b32 s34, 32768
FIN_LPOLL:
    s_lshl_b32 s33, s36, 15
    s_lshl_b32 s23, s39, 12
    s_add_u32 s33, s33, s23
    s_add_u32 s33, s33, 0x5000000
    buffer_load_dwordx4 v[32:35], v9, s[4:7], s33 offen offset:0 sc1
    buffer_load_dwordx4 v[36:39], v9, s[4:7], s33 offen offset:1024 sc1
    buffer_load_dwordx4 v[40:43], v9, s[4:7], s33 offen offset:2048 sc1
    buffer_load_dwordx4 v[44:47], v9, s[4:7], s33 offen offset:3072 sc1
    s_add_u32 s33, s33, 0x400000
    buffer_load_dwordx4 v[48:51], v9, s[4:7], s33 offen offset:0 sc1
    buffer_load_dwordx4 v[52:55], v9, s[4:7], s33 offen offset:1024 sc1
    buffer_load_dwordx4 v[56:59], v9, s[4:7], s33 offen offset:2048 sc1
    buffer_load_dwordx4 v[60:63], v9, s[4:7], s33 offen offset:3072 sc1
    s_add_u32 s33, s33, 0x400000
    buffer_load_dwordx4 v[64:67], v9, s[4:7], s33 offen offset:0 sc1
    buffer_load_dwordx4 v[68:71], v9, s[4:7], s33 offen offset:1024 sc1
    buffer_load_dwordx4 v[72:75], v9, s[4:7], s33 offen offset:2048 sc1
    buffer_load_dwordx4 v[76:79], v9, s[4:7], s33 offen offset:3072 sc1
    s_add_u32 s33, s33, 0x400000
    buffer_load_dwordx4 v[80:83], v9, s[4:7], s33 offen offset:0 sc1
    buffer_load_dwordx4 v[84:87], v9, s[4:7], s33 offen offset:1024 sc1
    buffer_load_dwordx4 v[88:91], v9, s[4:7], s33 offen offset:2048 sc1
    buffer_load_dwordx4 v[92:95], v9, s[4:7], s33 offen offset:3072 sc1
    s_waitcnt vmcnt(0)
    v_max3_u32 v2, v32, v33, v34
    v_max3_u32 v2, v2, v35, v36
    v_max3_u32 v2, v2, v37, v38
    v_max3_u32 v2, v2, v39, v40
    v_max3_u32 v2, v2, v41, v42
    v_max3_u32 v2, v2, v43, v44
    v_max3_u32 v2, v2, v45, v46
    v_max3_u32 v2, v2, v47, v48
    v_max3_u32 v2, v2, v49, v50
    v_max3_u32 v2, v2, v51, v52
    v_max3_u32 v2, v2, v53, v54
    v_max3_u32 v2, v2, v55, v56
    v_max3_u32 v2, v2, v57, v58
    v_max3_u32 v2, v2, v59, v60
    v_max3_u32 v2, v2, v61, v62
    v_max_u32 v2, v2, v63
    v_max3_u32 v3, v64, v65, v66
    v_max3_u32 v3, v3, v67, v68
    v_max3_u32 v3, v3, v69, v70
    v_max3_u32 v3, v3, v71, v72
    v_max3_u32 v3, v3, v73, v74
    v_max3_u32 v3, v3, v75, v76
    v_max3_u32 v3, v3, v77, v78
    v_max3_u32 v3, v3, v79, v80
    v_max3_u32 v3, v3, v81, v82
    v_max3_u32 v3, v3, v83, v84
    v_max3_u32 v3, v3, v85, v86
    v_max3_u32 v3, v3, v87, v88
    v_max3_u32 v3, v3, v89, v90
    v_max3_u32 v3, v3, v91, v92
    v_max3_u32 v3, v3, v93, v94
    v_max_u32 v3, v3, v95
    v_max_u32 v2, v2, v3
    v_cmp_eq_u32 vcc, -1, v2
    s_sub_u32 s34, s34, 1
    s_cbranch_scc1 FIN_LEND
    s_nop 2
    s_cbranch_vccnz FIN_LPOLL
FIN_LEND:
    s_branch FIN_GO
ROLE_SPARE:
    s_mov_b32 s23, 32768
    v_mov_b32 v2, 0
SPL_55:
    buffer_load_dwordx2 v[4:5], v2, s[16:19], 0 offen sc1
    s_waitcnt vmcnt(0)
    v_sad_u8 v6, v4, 0, 0
    v_sad_u8 v6, v5, 0, v6
    v_readfirstlane_b32 s28, v4
    v_readfirstlane_b32 s29, v5
    v_readfirstlane_b32 s27, v6
    s_lshr_b64 s[24:25], s[28:29], 56
    s_and_b32 s24, s24, 0xff
    s_min_u32 s24, s24, 32
    s_cmp_ge_u32 s24, 32
    s_cbranch_scc1 SP_DECIDE
    s_cmp_ge_u32 s27, 256
    s_cbranch_scc1 SP_DECIDE
    s_sub_u32 s23, s23, 1
    s_cbranch_scc1 SPE_56
    s_sleep 4
    s_branch SPL_55
SP_DECIDE:
    s_add_u32 s21, s21, s24
    s_mov_b32 s66, 0
    s_cmp_lt_u32 s21, 32
    s_cbranch_scc1 ROLE_CHAIN
    s_sub_u32 s21, s21, 32
    s_cmp_lt_u32 s21, 32
    s_cbranch_scc1 ROLE_OUT2
SPE_56:
    s_endpgm
ROLE_OUT2:
    s_load_dwordx2 s[8:9], s[0:1], 40
    s_mov_b32 s10, 0x400000
    s_mov_b32 s11, 0x20000
    s_lshl_b32 s23, s21, 7
    s_add_u32 s23, s23, 0x7008
    v_and_b32 v10, 1, v0
    v_lshlrev_b32 v10, 2, v10
    v_add_u32 v10, s23, v10
    s_mov_b32 s34, 2
    s_mov_b32 s24, 32768
WF_57:
    buffer_load_dword v3, v10, s[4:7], 0 offen sc1
    s_waitcnt vmcnt(0)
    v_cmp_gt_u32 vcc, s34, v3
    s_sub_u32 s24, s24, 1
    s_cbranch_scc1 WFE_58
    s_nop 2
    s_cbranch_vccz WFE_58
    s_sleep 100
    s_branch WF_57
WFE_58:
    s_waitcnt lgkmcnt(0)
    s_lshr_b32 s38, s21, 3
    s_and_b32 s39, s21, 7
    s_lshl_b32 s30, s38, 20
    s_lshl_b32 s23, s39, 7
    s_add_u32 s30, s30, s23
    v_lshrrev_b32 v2, 3, v0
    v_bfe_u32 v3, v0, 4, 2
    v_bfe_u32 v4, v0, 1, 2
    v_xor_b32 v4, v4, v3
    v_lshlrev_b32 v4, 5, v4
    v_and_b32 v3, 1, v0
    v_lshl_add_u32 v4, v3, 4, v4
    s_mov_b32 s23, 1024
    v_mul_lo_u32 v2, v2, s23
    v_add_u32 v2, v2, v4
    s_mul_i32 s24, s20, 8192
    s_add_u32 s24, s24, s30
    s_lshl_b32 s25, s20, 10
    s_add_u32 s25, s25, 0
    s_mov_b32 s27, 32
DMA_59:
    s_mov_b32 m0, s25
    s_add_u32 s25, s25, 4096
    buffer_load_dwordx4 v2, s[8:11], s24 offen lds
    s_add_u32 s24, s24, 32768
    s_sub_u32 s27, s27, 1
    s_cmp_lg_u32 s27, 0
    s_cbranch_scc1 DMA_59
    v_bfe_u32 v2, v0, 2, 2
    v_lshrrev_b32 v3, 4, v0
    v_lshl_add_u32 v4, v3, 2, v2
    v_lshlrev_b32 v5, 7, v4
    v_bfe_u32 v4, v4, 1, 2
    v_and_b32 v6, 3, v0
    v_lshl_add_u32 v5, v6, 3, v5
    v_xor_b32 v7, 0, v4
    v_lshl_add_u32 v16, v7, 5, v5
    v_xor_b32 v7, 1, v4
    v_lshl_add_u32 v17, v7, 5, v5
    v_xor_b32 v7, 2, v4
    v_lshl_add_u32 v18, v7, 5, v5
    v_xor_b32 v7, 3, v4
    v_lshl_add_u32 v19, v7, 5, v5
    s_lshl_b32 s23, s20, 15
    v_add_u32 v16, s23, v16
    v_add_u32 v17, s23, v17
    v_add_u32 v18, s23, v18
    v_add_u32 v19, s23, v19
    v_lshlrev_b32 v9, 4, v0
    v_and_b32 v2, 1, v0
    s_lshl_b32 s23, s38, 3
    s_lshl_b32 s24, s20, 1
    s_add_u32 s23, s23, s24
    v_add_u32 v2, s23, v2
    v_lshlrev_b32 v10, 7, v2
    v_add_u32 v10, 0x4008, v10
    s_lshl_b32 s23, s20, 13
    s_add_u32 s23, s23, 0x20000
    v_add_u32 v20, s23, v9
    s_lshl_b32 s23, s20, 11
    s_add_u32 s23, s23, 0x20000
    v_add_u32 v21, s23, v9
    s_waitcnt vmcnt(0)
    s_barrier
    ds_read_b64_tr_b16 v[128:129], v16 offset:0
    ds_read_b64_tr_b16 v[130:131], v16 offset:2048
    ds_read_b64_tr_b16 v[132:133], v17 offset:0
    ds_read_b64_tr_b16 v[134:135], v17 offset:2048
    ds_read_b64_tr_b16 v[136:137], v18 offset:0
    ds_read_b64_tr_b16 v[138:139], v18 offset:2048
    ds_read_b64_tr_b16 v[140:141], v19 offset:0
    ds_read_b64_tr_b16 v[142:143], v19 offset:2048
    s_waitcnt lgkmcnt(0)
    ds_read_b64_tr_b16 v[144:145], v16 offset:4096
    ds_read_b64_tr_b16 v[146:147], v16 offset:6144
    ds_read_b64_tr_b16 v[148:149], v17 offset:4096
    ds_read_b64_tr_b16 v[150:151], v17 offset:6144
    ds_read_b64_tr_b16 v[152:153], v18 offset:4096
    ds_read_b64_tr_b16 v[154:155], v18 offset:6144
    ds_read_b64_tr_b16 v[156:157], v19 offset:4096
    ds_read_b64_tr_b16 v[158:159], v19 offset:6144
    s_waitcnt lgkmcnt(0)
    ds_read_b64_tr_b16 v[160:161], v16 offset:8192
    ds_read_b64_tr_b16 v[162:163], v16 offset:10240
    ds_read_b64_tr_b16 v[164:165], v17 offset:8192
    ds_read_b64_tr_b16 v[166:167], v17 offset:10240
    ds_read_b64_tr_b16 v[168:169], v18 offset:8192
    ds_read_b64_tr_b16 v[170:171], v18 offset:10240
    ds_read_b64_tr_b16 v[172:173], v19 offset:8192
    ds_read_b64_tr_b16 v[174:175], v19 offset:10240
    s_waitcnt lgkmcnt(0)
    ds_read_b64_tr_b16 v[176:177], v16 offset:12288
    ds_read_b64_tr_b16 v[178:179], v16 offset:14336
    ds_read_b64_tr_b16 v[180:181], v17 offset:12288
    ds_read_b64_tr_b16 v[182:183], v17 offset:14336
    ds_read_b64_tr_b16 v[184:185], v18 offset:12288
    ds_read_b64_tr_b16 v[186:187], v18 offset:14336
    ds_read_b64_tr_b16 v[188:189], v19 offset:12288
    ds_read_b64_tr_b16 v[190:191], v19 offset:14336
    s_waitcnt lgkmcnt(0)
    ds_read_b64_tr_b16 v[192:193], v16 offset:16384
    ds_read_b64_tr_b16 v[194:195], v16 offset:18432
    ds_read_b64_tr_b16 v[196:197], v17 offset:16384
    ds_read_b64_tr_b16 v[198:199], v17 offset:18432
    ds_read_b64_tr_b16 v[200:201], v18 offset:16384
    ds_read_b64_tr_b16 v[202:203], v18 offset:18432
    ds_read_b64_tr_b16 v[204:205], v19 offset:16384
    ds_read_b64_tr_b16 v[206:207], v19 offset:18432
    s_waitcnt lgkmcnt(0)
    ds_read_b64_tr_b16 v[208:209], v16 offset:20480
    ds_read_b64_tr_b16 v[210:211], v16 offset:22528
    ds_read_b64_tr_b16 v[212:213], v17 offset:20480
    ds_read_b64_tr_b16 v[214:215], v17 offset:22528
    ds_read_b64_tr_b16 v[216:217], v18 offset:20480
    ds_read_b64_tr_b16 v[218:219], v18 offset:22528
    ds_read_b64_tr_b16 v[220:221], v19 offset:20480
    ds_read_b64_tr_b16 v[222:223], v19 offset:22528
    s_waitcnt lgkmcnt(0)
    ds_read_b64_tr_b16 v[224:225], v16 offset:24576
    ds_read_b64_tr_b16 v[226:227], v16 offset:26624
    ds_read_b64_tr_b16 v[228:229], v17 offset:24576
    ds_read_b64_tr_b16 v[230:231], v17 offset:26624
    ds_read_b64_tr_b16 v[232:233], v18 offset:24576
    ds_read_b64_tr_b16 v[234:235], v18 offset:26624
    ds_read_b64_tr_b16 v[236:237], v19 offset:24576
    ds_read_b64_tr_b16 v[238:239], v19 offset:26624
    s_waitcnt lgkmcnt(0)
    ds_read_b64_tr_b16 v[240:241], v16 offset:28672
    ds_read_b64_tr_b16 v[242:243], v16 offset:30720
    ds_read_b64_tr_b16 v[244:245], v17 offset:28672
    ds_read_b64_tr_b16 v[246:247], v17 offset:30720
    ds_read_b64_tr_b16 v[248:249], v18 offset:28672
    ds_read_b64_tr_b16 v[250:251], v18 offset:30720
    ds_read_b64_tr_b16 v[252:253], v19 offset:28672
    ds_read_b64_tr_b16 v[254:255], v19 offset:30720
    s_waitcnt lgkmcnt(0)
    s_lshl_b32 s36, s38, 22
    s_lshr_b32 s23, s20, 1
    s_lshl_b32 s23, s23, 15
    s_add_u32 s36, s36, s23
    s_lshl_b32 s23, s39, 12
    s_add_u32 s36, s36, s23
    s_and_b32 s23, s20, 1
    s_lshl_b32 s23, s23, 11
    s_add_u32 s36, s36, s23
    s_add_u32 s36, s36, 0x53e0000
    s_mov_b32 s34, 16
    s_mov_b32 s37, 15
    s_mov_b32 s24, 32768
WF_60:
    buffer_load_dword v3, v10, s[4:7], 0 offen sc1
    s_waitcnt vmcnt(0)
    v_cmp_gt_u32 vcc, s37, v3
    s_sub_u32 s24, s24, 1
    s_cbranch_scc1 WFE_61
    s_nop 2
    s_cbranch_vccz WFE_61
    s_sleep 32
    s_branch WF_60
WFE_61:
    s_mov_b32 s31, 62
OUT2_LOOP:
    s_lshl_b32 s33, s38, 15
    s_lshl_b32 s23, s20, 13
    s_add_u32 s33, s33, s23
    s_add_u32 s33, s33, 0x3000000
    s_lshl_b32 s23, s31, 18
    s_add_u32 s33, s33, s23
    s_add_u32 s35, s33, 0x20000
    s_mov_b32 s24, 32768
WF_62:
    buffer_load_dword v3, v10, s[4:7], 0 offen sc1
    s_waitcnt vmcnt(0)
    v_cmp_gt_u32 vcc, s34, v3
    s_sub_u32 s24, s24, 1
    s_cbranch_scc1 WFE_63
    s_nop 2
    s_cbranch_vccz WFE_63
    s_sleep 1
    s_branch WF_62
WFE_63:
    buffer_load_dwordx4 v[64:67], v9, s[4:7], s33 offen offset:0
    buffer_load_dwordx4 v[96:99], v9, s[4:7], s35 offen offset:0
    buffer_load_dwordx4 v[68:71], v9, s[4:7], s33 offen offset:1024
    buffer_load_dwordx4 v[100:103], v9, s[4:7], s35 offen offset:1024
    buffer_load_dwordx4 v[72:75], v9, s[4:7], s33 offen offset:2048
    buffer_load_dwordx4 v[104:107], v9, s[4:7], s35 offen offset:2048
    buffer_load_dwordx4 v[76:79], v9, s[4:7], s33 offen offset:3072
    buffer_load_dwordx4 v[108:111], v9, s[4:7], s35 offen offset:3072
    s_add_u32 s33, s33, 4096
    s_add_u32 s35, s35, 4096
    buffer_load_dwordx4 v[80:83], v9, s[4:7], s33 offen offset:0
    buffer_load_dwordx4 v[112:115], v9, s[4:7], s35 offen offset:0
    buffer_load_dwordx4 v[84:87], v9, s[4:7], s33 offen offset:1024
    buffer_load_dwordx4 v[116:119], v9, s[4:7], s35 offen offset:1024
    buffer_load_dwordx4 v[88:91], v9, s[4:7], s33 offen offset:2048
    buffer_load_dwordx4 v[120:123], v9, s[4:7], s35 offen offset:2048
    buffer_load_dwordx4 v[92:95], v9, s[4:7], s33 offen offset:3072
    buffer_load_dwordx4 v[124:127], v9, s[4:7], s35 offen offset:3072
    s_waitcnt vmcnt(14)
    v_mfma_f32_16x16x32_bf16 v[32:35], v[128:131], v[64:67], 0
    v_mfma_f32_16x16x32_bf16 v[48:51], v[128:131], v[96:99], 0
    v_mfma_f32_16x16x32_bf16 v[36:39], v[132:135], v[64:67], 0
    v_mfma_f32_16x16x32_bf16 v[52:55], v[132:135], v[96:99], 0
    v_mfma_f32_16x16x32_bf16 v[40:43], v[136:139], v[64:67], 0
    v_mfma_f32_16x16x32_bf16 v[56:59], v[136:139], v[96:99], 0
    v_mfma_f32_16x16x32_bf16 v[44:47], v[140:143], v[64:67], 0
    v_mfma_f32_16x16x32_bf16 v[60:63], v[140:143], v[96:99], 0
    s_waitcnt vmcnt(12)
    v_mfma_f32_16x16x32_bf16 v[32:35], v[144:147], v[68:71], v[32:35]
    v_mfma_f32_16x16x32_bf16 v[48:51], v[144:147], v[100:103], v[48:51]
    v_mfma_f32_16x16x32_bf16 v[36:39], v[148:151], v[68:71], v[36:39]
    v_mfma_f32_16x16x32_bf16 v[52:55], v[148:151], v[100:103], v[52:55]
    v_mfma_f32_16x16x32_bf16 v[40:43], v[152:155], v[68:71], v[40:43]
    v_mfma_f32_16x16x32_bf16 v[56:59], v[152:155], v[100:103], v[56:59]
    v_mfma_f32_16x16x32_bf16 v[44:47], v[156:159], v[68:71], v[44:47]
    v_mfma_f32_16x16x32_bf16 v[60:63], v[156:159], v[100:103], v[60:63]
    s_waitcnt vmcnt(10)
    v_mfma_f32_16x16x32_bf16 v[32:35], v[160:163], v[72:75], v[32:35]
    v_mfma_f32_16x16x32_bf16 v[48:51], v[160:163], v[104:107], v[48:51]
    v_mfma_f32_16x16x32_bf16 v[36:39], v[164:167], v[72:75], v[36:39]
    v_mfma_f32_16x16x32_bf16 v[52:55], v[164:167], v[104:107], v[52:55]
    v_mfma_f32_16x16x32_bf16 v[40:43], v[168:171], v[72:75], v[40:43]
    v_mfma_f32_16x16x32_bf16 v[56:59], v[168:171], v[104:107], v[56:59]
    v_mfma_f32_16x16x32_bf16 v[44:47], v[172:175], v[72:75], v[44:47]
    v_mfma_f32_16x16x32_bf16 v[60:63], v[172:175], v[104:107], v[60:63]
    s_waitcnt vmcnt(8)
    v_mfma_f32_16x16x32_bf16 v[32:35], v[176:179], v[76:79], v[32:35]
    v_mfma_f32_16x16x32_bf16 v[48:51], v[176:179], v[108:111], v[48:51]
    v_mfma_f32_16x16x32_bf16 v[36:39], v[180:183], v[76:79], v[36:39]
    v_mfma_f32_16x16x32_bf16 v[52:55], v[180:183], v[108:111], v[52:55]
    v_mfma_f32_16x16x32_bf16 v[40:43], v[184:187], v[76:79], v[40:43]
    v_mfma_f32_16x16x32_bf16 v[56:59], v[184:187], v[108:111], v[56:59]
    v_mfma_f32_16x16x32_bf16 v[44:47], v[188:191], v[76:79], v[44:47]
    v_mfma_f32_16x16x32_bf16 v[60:63], v[188:191], v[108:111], v[60:63]
    s_waitcnt vmcnt(6)
    v_mfma_f32_16x16x32_bf16 v[32:35], v[192:195], v[80:83], v[32:35]
    v_mfma_f32_16x16x32_bf16 v[48:51], v[192:195], v[112:115], v[48:51]
    v_mfma_f32_16x16x32_bf16 v[36:39], v[196:199], v[80:83], v[36:39]
    v_mfma_f32_16x16x32_bf16 v[52:55], v[196:199], v[112:115], v[52:55]
    v_mfma_f32_16x16x32_bf16 v[40:43], v[200:203], v[80:83], v[40:43]
    v_mfma_f32_16x16x32_bf16 v[56:59], v[200:203], v[112:115], v[56:59]
    v_mfma_f32_16x16x32_bf16 v[44:47], v[204:207], v[80:83], v[44:47]
    v_mfma_f32_16x16x32_bf16 v[60:63], v[204:207], v[112:115], v[60:63]
    s_waitcnt vmcnt(4)
    v_mfma_f32_16x16x32_bf16 v[32:35], v[208:211], v[84:87], v[32:35]
    v_mfma_f32_16x16x32_bf16 v[48:51], v[208:211], v[116:119], v[48:51]
    v_mfma_f32_16x16x32_bf16 v[36:39], v[212:215], v[84:87], v[36:39]
    v_mfma_f32_16x16x32_bf16 v[52:55], v[212:215], v[116:119], v[52:55]
    v_mfma_f32_16x16x32_bf16 v[40:43], v[216:219], v[84:87], v[40:43]
    v_mfma_f32_16x16x32_bf16 v[56:59], v[216:219], v[116:119], v[56:59]
    v_mfma_f32_16x16x32_bf16 v[44:47], v[220:223], v[84:87], v[44:47]
    v_mfma_f32_16x16x32_bf16 v[60:63], v[220:223], v[116:119], v[60:63]
    s_waitcnt vmcnt(2)
    v_mfma_f32_16x16x32_bf16 v[32:35], v[224:227], v[88:91], v[32:35]
    v_mfma_f32_16x16x32_bf16 v[48:51], v[224:227], v[120:123], v[48:51]
    v_mfma_f32_16x16x32_bf16 v[36:39], v[228:231], v[88:91], v[36:39]
    v_mfma_f32_16x16x32_bf16 v[52:55], v[228:231], v[120:123], v[52:55]
    v_mfma_f32_16x16x32_bf16 v[40:43], v[232:235], v[88:91], v[40:43]
    v_mfma_f32_16x16x32_bf16 v[56:59], v[232:235], v[120:123], v[56:59]
    v_mfma_f32_16x16x32_bf16 v[44:47], v[236:239], v[88:91], v[44:47]
    v_mfma_f32_16x16x32_bf16 v[60:63], v[236:239], v[120:123], v[60:63]
    s_waitcnt vmcnt(0)
    v_mfma_f32_16x16x32_bf16 v[32:35], v[240:243], v[92:95], v[32:35]
    v_mfma_f32_16x16x32_bf16 v[48:51], v[240:243], v[124:127], v[48:51]
    v_mfma_f32_16x16x32_bf16 v[36:39], v[244:247], v[92:95], v[36:39]
    v_mfma_f32_16x16x32_bf16 v[52:55], v[244:247], v[124:127], v[52:55]
    v_mfma_f32_16x16x32_bf16 v[40:43], v[248:251], v[92:95], v[40:43]
    v_mfma_f32_16x16x32_bf16 v[56:59], v[248:251], v[124:127], v[56:59]
    v_mfma_f32_16x16x32_bf16 v[44:47], v[252:255], v[92:95], v[44:47]
    v_mfma_f32_16x16x32_bf16 v[60:63], v[252:255], v[124:127], v[60:63]
    ds_write_b128 v20, v[32:35] offset:0
    ds_write_b128 v20, v[36:39] offset:1024
    ds_write_b128 v20, v[40:43] offset:2048
    s_nop 0
    ds_write_b128 v20, v[44:47] offset:3072
    ds_write_b128 v20, v[48:51] offset:4096
    ds_write_b128 v20, v[52:55] offset:5120
    ds_write_b128 v20, v[56:59] offset:6144
    s_nop 0
    ds_write_b128 v20, v[60:63] offset:7168
    s_waitcnt lgkmcnt(0)
    s_barrier
    ds_read_b128 v[64:67], v21 offset:0
    ds_read_b128 v[68:71], v21 offset:8192
    ds_read_b128 v[72:75], v21 offset:16384
    ds_read_b128 v[76:79], v21 offset:24576
    ds_read_b128 v[80:83], v21 offset:1024
    ds_read_b128 v[84:87], v21 offset:9216
    ds_read_b128 v[88:91], v21 offset:17408
    ds_read_b128 v[92:95], v21 offset:25600
    s_waitcnt lgkmcnt(4)
    v_pk_add_f32 v[64:65], v[64:65], v[68:69]
    v_pk_add_f32 v[72:73], v[72:73], v[76:77]
    v_pk_add_f32 v[66:67], v[66:67], v[70:71]
    v_pk_add_f32 v[74:75], v[74:75], v[78:79]
    v_pk_add_f32 v[64:65], v[64:65], v[72:73]
    v_pk_add_f32 v[66:67], v[66:67], v[74:75]
    buffer_store_dwordx4 v[64:67], v9, s[4:7], s36 offen offset:0 sc1
    s_waitcnt lgkmcnt(0)
    v_pk_add_f32 v[80:81], v[80:81], v[84:85]
    v_pk_add_f32 v[88:89], v[88:89], v[92:93]
    v_pk_add_f32 v[82:83], v[82:83], v[86:87]
    v_pk_add_f32 v[90:91], v[90:91], v[94:95]
    v_pk_add_f32 v[80:81], v[80:81], v[88:89]
    v_pk_add_f32 v[82:83], v[82:83], v[90:91]
    buffer_store_dwordx4 v[80:83], v9, s[4:7], s36 offen offset:1024 sc1
    v_add_u32 v10, 4, v10
    v_add_u32 v20, 0xfffe0000, v20
    v_add_u32 v21, 0xfffe0000, v21
    s_add_u32 s36, s36, 0x10000
    s_add_u32 s31, s31, 1
    s_cmp_lt_u32 s31, 64
    s_cbranch_scc1 OUT2_LOOP
    s_waitcnt vmcnt(0)
    s_endpgm
EXIT:
    s_endpgm

.section .rodata,"a"
.p2align 6
.amdhsa_kernel parallel_sum__memory_aug_recurrent_mem_tr__glu_gated_bilinear__prompt_kernel
  .amdhsa_next_free_vgpr 512
  .amdhsa_next_free_sgpr 102
  .amdhsa_accum_offset 256
  .amdhsa_group_segment_fixed_size 0
  .amdhsa_kernarg_size 112
  .amdhsa_user_sgpr_count 2
  .amdhsa_user_sgpr_kernarg_segment_ptr 1
  .amdhsa_system_sgpr_workgroup_id_x 1
.end_amdhsa_kernel
```
